```python
import torch

def _softmax(x, axis=-1):
    return torch.softmax(x, dim=axis)
def _gelu(x):
    return torch.nn.functional.gelu(x, approximate="tanh")
def _silu(x):
    return torch.nn.functional.silu(x)
def _sigmoid(x):
    return torch.sigmoid(x)
def _layernorm(x, axis=-1, eps=1e-5):
    m = x.mean(dim=axis, keepdim=True)
    v = x.var(dim=axis, keepdim=True, unbiased=False)
    return (x - m) / torch.sqrt(v + eps)
def _scatter_add(tgt, idx, src, axis=0):
    return tgt.clone().index_add_(axis, idx, src)
def _segment_sum(src, seg, n):
    out = torch.zeros((n,) + src.shape[1:], dtype=src.dtype)
    return out.index_add_(0, seg, src)
def _pad(x, pw):
    flat = tuple(v for pair in reversed(pw) for v in pair)
    return torch.nn.functional.pad(x, flat)

kernel_name = 'concat_heads__gqa_block_cached__gqa_block_cached__near_ridge'

def setup_inputs():

    _w = (lambda a: (lambda t: t.to(torch.bfloat16) if t.is_floating_point() else t)(torch.as_tensor(a)))
    def _A_setup():
        B, Sq, D = 8, 80, 576
        Hq, Hkv, Sk, Dh = 32, 16, 1024, 128
        assert Hq % Hkv == 0, (Hq, Hkv)
        return {
            "x": _w((lambda *s: torch.randn(*s, dtype=torch.bfloat16) * 0.8)(B, Sq, D)),
            "k_cache": _w((lambda *s: torch.randn(*s, dtype=torch.bfloat16) * 0.8)(B, Hkv, Sk, Dh)),
            "v_cache": _w((lambda *s: torch.randn(*s, dtype=torch.bfloat16) * 0.05)(B, Hkv, Sk, Dh)),
            "wq": _w((lambda *s: torch.randn(*s, dtype=torch.bfloat16) * 0.8)(D, Hq * Dh) * (D ** -0.5)),
            "wo": _w((lambda *s: torch.randn(*s, dtype=torch.bfloat16) * 0.05)(Hq * Dh, D) * ((Hq * Dh) ** -0.5)),
        }
    _A_in = _A_setup()

    def _B_setup():
        B, Sq, D = 8, 80, 576
        Hq, Hkv, Sk, Dh = 32, 16, 1024, 128
        assert Hq % Hkv == 0, (Hq, Hkv)
        return {
            "x": _w((lambda *s: torch.randn(*s, dtype=torch.bfloat16) * 0.8)(B, Sq, D)),
            "k_cache": _w((lambda *s: torch.randn(*s, dtype=torch.bfloat16) * 0.8)(B, Hkv, Sk, Dh)),
            "v_cache": _w((lambda *s: torch.randn(*s, dtype=torch.bfloat16) * 0.05)(B, Hkv, Sk, Dh)),
            "wq": _w((lambda *s: torch.randn(*s, dtype=torch.bfloat16) * 0.8)(D, Hq * Dh) * (D ** -0.5)),
            "wo": _w((lambda *s: torch.randn(*s, dtype=torch.bfloat16) * 0.05)(Hq * Dh, D) * ((Hq * Dh) ** -0.5)),
        }
    _B_in = _B_setup()

    return {
        "A_x": _A_in["x"],
        "A_k_cache": _A_in["k_cache"],
        "A_v_cache": _A_in["v_cache"],
        "A_wq": _A_in["wq"],
        "A_wo": _A_in["wo"],
        "B_x": _B_in["x"],
        "B_k_cache": _B_in["k_cache"],
        "B_v_cache": _B_in["v_cache"],
        "B_wq": _B_in["wq"],
        "B_wo": _B_in["wo"],
    }

def reference(A_x, A_k_cache, A_v_cache, A_wq, A_wo, B_x, B_k_cache, B_v_cache, B_wq, B_wo):
    def _A_ref(x, k_cache, v_cache, wq, wo):
        B, Sq, D = x.shape
        Hq, Dh = 32, 128
        Hkv = k_cache.shape[1]
        rep = Hq // Hkv
        q = (lambda x, *d: x.permute(*d))((x @ wq).reshape(B, Sq, Hq, Dh), 0, 2, 1, 3)
        k = (lambda x, n, axis: torch.repeat_interleave(x, n, dim=axis))(k_cache, rep, axis=1)
        v = (lambda x, n, axis: torch.repeat_interleave(x, n, dim=axis))(v_cache, rep, axis=1)
        scores = torch.einsum("bhqd,bhkd->bhqk", q, k) * (Dh ** -0.5)
        p = _softmax(scores, axis=-1)
        o = torch.einsum("bhqk,bhkd->bhqd", p, v)
        return (lambda x, *d: x.permute(*d))(o, 0, 2, 1, 3).reshape(B, Sq, Hq * Dh) @ wo

    def _B_ref(x, k_cache, v_cache, wq, wo):
        B, Sq, D = x.shape
        Hq, Dh = 32, 128
        Hkv = k_cache.shape[1]
        rep = Hq // Hkv
        q = (lambda x, *d: x.permute(*d))((x @ wq).reshape(B, Sq, Hq, Dh), 0, 2, 1, 3)
        k = (lambda x, n, axis: torch.repeat_interleave(x, n, dim=axis))(k_cache, rep, axis=1)
        v = (lambda x, n, axis: torch.repeat_interleave(x, n, dim=axis))(v_cache, rep, axis=1)
        scores = torch.einsum("bhqd,bhkd->bhqk", q, k) * (Dh ** -0.5)
        p = _softmax(scores, axis=-1)
        o = torch.einsum("bhqk,bhkd->bhqd", p, v)
        return (lambda x, *d: x.permute(*d))(o, 0, 2, 1, 3).reshape(B, Sq, Hq * Dh) @ wo

    a = _A_ref(A_x, A_k_cache, A_v_cache, A_wq, A_wo)
    b = _B_ref(B_x, B_k_cache, B_v_cache, B_wq, B_wo)
    return torch.concatenate([a, b], axis=-1)
```

```asm
; @launch grid=(256,1,1) block=(256,1,1) lds=163840
.amdgcn_target "amdgcn-amd-amdhsa--gfx950"
.text
.globl concat_heads__gqa_block_cached__gqa_block_cached__near_ridge_kernel
.p2align 8
.type concat_heads__gqa_block_cached__gqa_block_cached__near_ridge_kernel,@function
concat_heads__gqa_block_cached__gqa_block_cached__near_ridge_kernel:
  s_getpc_b64 s[68:69]
  s_cmp_ge_u32 s2, 256
  s_cbranch_scc1 L_end
  s_lshr_b32 s35, s2, 2
  s_and_b32 s35, s35, 1
  s_mul_i32 s38, s35, 40
  s_add_u32 s38, s0, s38
  s_addc_u32 s39, s1, 0
  s_load_dwordx8 s[44:51], s[38:39], 0
  s_load_dwordx2 s[52:53], s[38:39], 32
  s_load_dwordx4 s[56:59], s[0:1], 80
  s_load_dwordx2 s[54:55], s[0:1], 96
  v_mov_b32 v54, v0
  v_lshlrev_b32 v220, 6, v54
  v_add_u32 v220, 0, v220
  v_min_u32 v220, 47196, v220
  v_mov_b32 v221, s69
  v_add_co_u32 v220, vcc, s68, v220
  s_nop 1
  v_addc_co_u32 v221, vcc, 0, v221, vcc
  global_load_dword v27, v[220:221], off
  v_lshlrev_b32 v220, 6, v54
  v_add_u32 v220, 16384, v220
  v_min_u32 v220, 47196, v220
  v_mov_b32 v221, s69
  v_add_co_u32 v220, vcc, s68, v220
  s_nop 1
  v_addc_co_u32 v221, vcc, 0, v221, vcc
  global_load_dword v27, v[220:221], off
  v_lshlrev_b32 v220, 6, v54
  v_add_u32 v220, 32768, v220
  v_min_u32 v220, 47196, v220
  v_mov_b32 v221, s69
  v_add_co_u32 v220, vcc, s68, v220
  s_nop 1
  v_addc_co_u32 v221, vcc, 0, v221, vcc
  global_load_dword v27, v[220:221], off
  s_and_b32 s38, s2, 3
  s_lshr_b32 s39, s2, 3
  s_and_b32 s36, s39, 7
  s_lshr_b32 s39, s39, 3
  s_lshl_b32 s38, s38, 2
  s_add_u32 s37, s38, s39
  v_lshrrev_b32 v1, 6, v0
  v_and_b32 v0, 63, v0
  v_readfirstlane_b32 s32, v1
  v_and_b32 v1, 15, v0
  v_lshrrev_b32 v2, 4, v0
  s_and_b32 s33, s32, 1
  s_lshr_b32 s34, s32, 1
  s_add_u32 s66, s36, s39
  s_and_b32 s66, s66, 3
  s_lshl_b32 s66, s66, 1
  s_lshl_b32 s38, s33, 2
  v_add_u32 v3, s38, v2
  v_and_b32 v23, 7, v0
  v_xor_b32 v3, v3, v23
  v_lshlrev_b32 v3, 4, v3
  v_lshrrev_b32 v23, 3, v0
  v_mul_u32_u24 v23, 1152, v23
  v_add_u32 v50, v3, v23
  s_lshl_b32 s38, s32, 17
  v_lshlrev_b32 v3, 13, v2
  v_add_u32 v3, s38, v3
  v_lshlrev_b32 v23, 1, v2
  v_xor_b32 v23, v1, v23
  v_lshl_add_u32 v52, v23, 4, v3
  v_xor_b32 v23, 8, v23
  v_lshl_add_u32 v53, v23, 4, v3
  s_cmp_eq_u32 s34, 0
  s_cselect_b64 s[70:71], -1, 0
  s_lshl_b32 s60, s32, 10
  s_lshl_b32 s61, s33, 10
  s_mul_i32 s63, s32, 9216
  s_mul_i32 s65, s33, 9216
  s_lshl_b32 s43, s32, 12
  s_mul_i32 s42, s36, 92160
  s_mov_b32 s6, 92160
  s_mov_b32 s7, 0x20000
  s_lshl_b32 s38, s37, 9
  s_sub_u32 s18, 4718592, s38
  s_mov_b32 s19, 0x20000
  s_waitcnt lgkmcnt(0)
  s_add_u32 s4, s44, s42
  s_addc_u32 s5, s45, 0
  s_add_u32 s16, s50, s38
  s_addc_u32 s17, s51, 0
  s_lshl_b32 s62, s66, 19
  s_lshl_b32 s64, s66, 7
  s_add_u32 s40, s63, s64
  s_add_u32 s41, s65, s64
  s_add_u32 m0, s60, 131072
  s_nop 0
  buffer_load_dwordx4 v50, s[4:7], s40 offen lds
  s_add_u32 s66, s66, 1
  s_cmp_eq_u32 s66, 9
  s_cselect_b32 s66, 0, s66
  s_add_u32 m0, s60, 135168
  s_add_u32 s3, s40, 36864
  buffer_load_dwordx4 v50, s[4:7], s3 offen lds
  s_add_u32 m0, s61, 139264
  s_add_u32 s3, s41, 73728
  s_mov_b64 exec, s[70:71]
  buffer_load_dwordx4 v50, s[4:7], s3 offen lds
  s_mov_b64 exec, -1
  s_add_u32 m0, s43, 65536
  s_add_u32 s3, s62, 0
  buffer_load_dwordx4 v52, s[16:19], s3 offen offset:0 lds
  s_add_u32 s3, s62, 31744
  buffer_load_dwordx4 v52, s[16:19], s3 offen offset:1024 lds
  s_add_u32 s3, s62, 63488
  buffer_load_dwordx4 v53, s[16:19], s3 offen offset:2048 lds
  s_add_u32 s3, s62, 95232
  buffer_load_dwordx4 v53, s[16:19], s3 offen offset:3072 lds
  s_add_u32 m0, s43, 81920
  s_add_u32 s3, s62, 256
  buffer_load_dwordx4 v52, s[16:19], s3 offen offset:0 lds
  s_add_u32 s3, s62, 32000
  buffer_load_dwordx4 v52, s[16:19], s3 offen offset:1024 lds
  s_add_u32 s3, s62, 63744
  buffer_load_dwordx4 v53, s[16:19], s3 offen offset:2048 lds
  s_add_u32 s3, s62, 95488
  buffer_load_dwordx4 v53, s[16:19], s3 offen offset:3072 lds
  v_lshlrev_b32 v22, 4, v0
  v_lshrrev_b32 v3, 1, v1
  v_xor_b32 v3, v3, v2
  v_lshlrev_b32 v23, 7, v1
  v_add_u32 v23, 131072, v23
  v_lshl_add_u32 v48, v3, 4, v23
  v_xor_b32 v3, 4, v3
  v_lshl_add_u32 v49, v3, 4, v23
  v_bfe_u32 v3, v0, 2, 2
  v_lshl_add_u32 v23, v2, 3, v3
  v_lshlrev_b32 v23, 8, v23
  v_and_b32 v24, 3, v0
  v_lshl_add_u32 v23, v24, 3, v23
  s_lshl_b32 s38, s33, 14
  v_add_u32 v23, s38, v23
  v_bfe_u32 v3, v0, 2, 3
  s_lshl_b32 s39, s34, 2
  v_xor_b32 v3, s39, v3
  v_xor_b32 v24, 0, v3
  v_lshl_add_u32 v24, v24, 5, v23
  v_add_u32 v56, 65536, v24
  v_add_u32 v60, 32768, v24
  v_add_u32 v64, 98304, v24
  v_xor_b32 v24, 1, v3
  v_lshl_add_u32 v24, v24, 5, v23
  v_add_u32 v57, 65536, v24
  v_add_u32 v61, 32768, v24
  v_add_u32 v65, 98304, v24
  v_xor_b32 v24, 2, v3
  v_lshl_add_u32 v24, v24, 5, v23
  v_add_u32 v58, 65536, v24
  v_add_u32 v62, 32768, v24
  v_add_u32 v66, 98304, v24
  v_xor_b32 v24, 3, v3
  v_lshl_add_u32 v24, v24, 5, v23
  v_add_u32 v59, 65536, v24
  v_add_u32 v63, 32768, v24
  v_add_u32 v67, 98304, v24
  s_lshl_b32 s38, s36, 4
  s_add_u32 s38, s38, s37
  s_lshl_b32 s38, s38, 18
  s_add_u32 s8, s46, s38
  s_addc_u32 s9, s47, 0
  s_mov_b32 s10, 262144
  s_mov_b32 s11, 0x20000
  s_add_u32 s12, s48, s38
  s_addc_u32 s13, s49, 0
  s_mov_b32 s14, 262144
  s_mov_b32 s15, 0x20000
  s_mul_i32 s38, s37, 294912
  s_add_u32 s20, s52, s38
  s_addc_u32 s21, s53, 0
  s_mov_b32 s22, 294912
  s_mov_b32 s23, 0x20000
  s_lshl_b32 s53, s32, 13
  s_lshl_b32 s52, s35, 3
  s_add_u32 s52, s52, s36
  s_lshr_b32 s52, s52, 1
  s_mul_i32 s38, s52, 3014656
  s_add_u32 s38, s38, 0
  s_add_u32 s28, s54, s38
  s_addc_u32 s29, s55, 0
  s_mov_b32 s30, 3014656
  s_mov_b32 s31, 0x20000
  s_and_b32 s48, s36, 1
  s_lshl_b32 s48, s48, 4
  s_add_u32 s48, s48, s37
  s_mul_i32 s38, s48, 94208
  s_add_u32 s24, s28, s38
  s_addc_u32 s25, s29, 0
  s_mov_b32 s26, 94208
  s_mov_b32 s27, 0x20000
  s_mov_b32 s44, s56
  s_mov_b32 s45, s57
  s_mov_b32 s46, 1474560
  s_mov_b32 s47, 0x20000
  s_mov_b32 s56, s58
  s_mov_b32 s57, s59
  s_mov_b32 s58, 256
  s_mov_b32 s59, 0x20000
  s_mov_b32 s50, 0
  s_lshr_b32 s38, s2, 3
  s_and_b32 s39, s2, 7
  s_lshl_b32 s39, s39, 1
  s_add_u32 s38, s38, s39
  s_and_b32 s38, s38, 15
  s_lshl_b32 s49, s38, 14
  v_lshlrev_b32 v3, 8, v2
  v_add_u32 v3, s43, v3
  v_xor_b32 v23, v1, v2
  v_xor_b32 v24, 0, v23
  v_lshl_add_u32 v16, v24, 4, v3
  v_xor_b32 v24, 4, v23
  v_lshl_add_u32 v17, v24, 4, v3
  v_xor_b32 v24, 8, v23
  v_lshl_add_u32 v18, v24, 4, v3
  v_xor_b32 v24, 12, v23
  v_lshl_add_u32 v19, v24, 4, v3
  v_lshlrev_b32 v23, 1, v2
  v_xor_b32 v23, v1, v23
  v_xor_b32 v24, 0, v23
  v_lshl_add_u32 v20, v24, 4, v3
  v_xor_b32 v24, 8, v23
  v_lshl_add_u32 v21, v24, 4, v3
  s_lshl_b32 s62, s66, 19
  s_lshl_b32 s64, s66, 7
  s_add_u32 s40, s63, s64
  s_add_u32 s41, s65, s64
  s_add_u32 m0, s60, 141312
  s_nop 0
  buffer_load_dwordx4 v50, s[4:7], s40 offen lds
  s_add_u32 s66, s66, 1
  s_cmp_eq_u32 s66, 9
  s_cselect_b32 s66, 0, s66
  s_add_u32 m0, s60, 145408
  s_add_u32 s3, s40, 36864
  buffer_load_dwordx4 v50, s[4:7], s3 offen lds
  s_add_u32 m0, s61, 149504
  s_add_u32 s3, s41, 73728
  s_mov_b64 exec, s[70:71]
  buffer_load_dwordx4 v50, s[4:7], s3 offen lds
  s_mov_b64 exec, -1
  s_add_u32 m0, s43, 32768
  s_add_u32 s3, s62, 0
  buffer_load_dwordx4 v52, s[16:19], s3 offen offset:0 lds
  s_add_u32 s3, s62, 31744
  buffer_load_dwordx4 v52, s[16:19], s3 offen offset:1024 lds
  s_add_u32 s3, s62, 63488
  buffer_load_dwordx4 v53, s[16:19], s3 offen offset:2048 lds
  s_add_u32 s3, s62, 95232
  buffer_load_dwordx4 v53, s[16:19], s3 offen offset:3072 lds
  s_add_u32 m0, s43, 49152
  s_add_u32 s3, s62, 256
  buffer_load_dwordx4 v52, s[16:19], s3 offen offset:0 lds
  s_add_u32 s3, s62, 32000
  buffer_load_dwordx4 v52, s[16:19], s3 offen offset:1024 lds
  s_add_u32 s3, s62, 63744
  buffer_load_dwordx4 v53, s[16:19], s3 offen offset:2048 lds
  s_add_u32 s3, s62, 95488
  buffer_load_dwordx4 v53, s[16:19], s3 offen offset:3072 lds
  s_waitcnt vmcnt(11)
  s_barrier
  ds_read_b128 a[0:3], v48 offset:0
  ds_read_b128 a[4:7], v48 offset:2048
  ds_read_b128 a[8:11], v48 offset:4096
  ds_read_b128 a[12:15], v48 offset:6144
  ds_read_b128 a[16:19], v48 offset:8192
  ds_read_b64_tr_b16 a[40:41], v56 offset:0
  ds_read_b64_tr_b16 a[42:43], v56 offset:1024
  ds_read_b64_tr_b16 a[44:45], v57 offset:0
  ds_read_b64_tr_b16 a[46:47], v57 offset:1024
  ds_read_b64_tr_b16 a[48:49], v58 offset:0
  ds_read_b64_tr_b16 a[50:51], v58 offset:1024
  ds_read_b64_tr_b16 a[52:53], v59 offset:0
  ds_read_b64_tr_b16 a[54:55], v59 offset:1024
  ds_read_b128 a[20:23], v49 offset:0
  ds_read_b128 a[24:27], v49 offset:2048
  ds_read_b128 a[28:31], v49 offset:4096
  ds_read_b128 a[32:35], v49 offset:6144
  ds_read_b128 a[36:39], v49 offset:8192
  ds_read_b64_tr_b16 a[56:57], v56 offset:8192
  ds_read_b64_tr_b16 a[58:59], v56 offset:9216
  ds_read_b64_tr_b16 a[60:61], v57 offset:8192
  ds_read_b64_tr_b16 a[62:63], v57 offset:9216
  ds_read_b64_tr_b16 a[64:65], v58 offset:8192
  ds_read_b64_tr_b16 a[66:67], v58 offset:9216
  ds_read_b64_tr_b16 a[68:69], v59 offset:8192
  ds_read_b64_tr_b16 a[70:71], v59 offset:9216
  s_lshl_b32 s62, s66, 19
  s_lshl_b32 s64, s66, 7
  s_add_u32 s40, s63, s64
  s_add_u32 s41, s65, s64
  s_add_u32 m0, s60, 151552
  s_nop 0
  buffer_load_dwordx4 v50, s[4:7], s40 offen lds
  s_add_u32 s66, s66, 1
  s_cmp_eq_u32 s66, 9
  s_cselect_b32 s66, 0, s66
  s_add_u32 m0, s60, 155648
  s_add_u32 s3, s40, 36864
  buffer_load_dwordx4 v50, s[4:7], s3 offen lds
  s_add_u32 m0, s61, 159744
  s_add_u32 s3, s41, 73728
  s_mov_b64 exec, s[70:71]
  buffer_load_dwordx4 v50, s[4:7], s3 offen lds
  s_mov_b64 exec, -1
  s_add_u32 m0, s43, 98304
  s_add_u32 s3, s62, 0
  buffer_load_dwordx4 v52, s[16:19], s3 offen offset:0 lds
  s_add_u32 s3, s62, 31744
  buffer_load_dwordx4 v52, s[16:19], s3 offen offset:1024 lds
  s_add_u32 s3, s62, 63488
  buffer_load_dwordx4 v53, s[16:19], s3 offen offset:2048 lds
  s_add_u32 s3, s62, 95232
  buffer_load_dwordx4 v53, s[16:19], s3 offen offset:3072 lds
  s_add_u32 m0, s43, 114688
  s_add_u32 s3, s62, 256
  buffer_load_dwordx4 v52, s[16:19], s3 offen offset:0 lds
  s_add_u32 s3, s62, 32000
  buffer_load_dwordx4 v52, s[16:19], s3 offen offset:1024 lds
  s_add_u32 s3, s62, 63744
  buffer_load_dwordx4 v53, s[16:19], s3 offen offset:2048 lds
  s_add_u32 s3, s62, 95488
  buffer_load_dwordx4 v53, s[16:19], s3 offen offset:3072 lds
  s_lshl_b32 s38, s34, 13
  v_lshlrev_b32 v23, 8, v1
  v_add_u32 v23, s38, v23
  v_lshlrev_b32 v3, 1, v2
  v_xor_b32 v3, v3, v1
  v_xor_b32 v24, 0, v3
  v_lshl_add_u32 v4, v24, 4, v23
  v_xor_b32 v24, 1, v3
  v_lshl_add_u32 v5, v24, 4, v23
  v_xor_b32 v24, 8, v3
  v_lshl_add_u32 v6, v24, 4, v23
  v_xor_b32 v24, 9, v3
  v_lshl_add_u32 v7, v24, 4, v23
  v_lshrrev_b32 v3, 2, v0
  v_lshlrev_b32 v23, 8, v3
  v_and_b32 v24, 3, v0
  v_lshl_add_u32 v222, v24, 3, v23
  v_add_u32 v23, s38, v222
  v_add_u32 v23, 65536, v23
  v_and_b32 v223, 7, v3
  s_lshl_b32 s39, s34, 2
  v_xor_b32 v3, s39, v223
  v_xor_b32 v24, 0, v3
  v_lshl_add_u32 v8, v24, 5, v23
  v_xor_b32 v12, 8192, v8
  v_xor_b32 v24, 1, v3
  v_lshl_add_u32 v9, v24, 5, v23
  v_xor_b32 v13, 8192, v9
  v_xor_b32 v24, 2, v3
  v_lshl_add_u32 v10, v24, 5, v23
  v_xor_b32 v14, 8192, v10
  v_xor_b32 v24, 3, v3
  v_lshl_add_u32 v11, v24, 5, v23
  v_xor_b32 v15, 8192, v11
  v_lshrrev_b32 v3, 2, v0
  v_lshlrev_b32 v23, 7, v3
  v_and_b32 v24, 3, v0
  v_lshl_add_u32 v23, v24, 3, v23
  v_bfe_u32 v3, v0, 3, 2
  v_xor_b32 v3, s32, v3
  v_lshl_add_u32 v212, v3, 5, v23
  v_add_u32 v213, 65536, v212
  s_mul_i32 s39, s32, 5120
  v_add_u32 v217, s39, v22
  v_add_u32 v208, 81920, v217
  s_xor_b32 s38, s32, 2
  s_mul_i32 s38, s38, 5120
  s_add_u32 s38, s38, 81920
  v_add_u32 v209, s38, v22
  s_mul_i32 s39, s32, 23552
  v_add_u32 v217, s39, v22
  s_lshl_b32 s39, s32, 9
  s_add_u32 s39, s39, 159744
  v_lshlrev_b32 v248, 4, v1
  v_add_u32 v248, s39, v248
  v_xor_b32 v249, 1024, v248
  v_and_b32 v23, 3, v0
  v_lshlrev_b32 v3, 1, v2
  v_xor_b32 v3, v3, v23
  v_lshlrev_b32 v23, 8, v23
  v_lshl_add_u32 v252, v3, 4, v23
  v_xor_b32 v253, 16, v252
  v_xor_b32 v254, 128, v252
  v_xor_b32 v255, 144, v252
  v_add_u32 v211, 106496, v22
  s_mul_i32 s39, s32, 10240
  v_add_u32 v210, s39, v211
  v_mov_b32 v3, 0x3f803f80
  v_accvgpr_write_b32 a216, v3
  v_accvgpr_write_b32 a217, v3
  v_accvgpr_write_b32 a218, v3
  v_accvgpr_write_b32 a219, v3
  s_lshl_b32 s38, s32, 6
  v_lshrrev_b32 v3, 3, v0
  v_add_u32 v3, s38, v3
  v_mul_u32_u24 v3, 1152, v3
  v_bfe_u32 v23, v0, 1, 2
  v_xor_b32 v23, v23, v2
  v_lshl_add_u32 v3, v23, 5, v3
  v_and_b32_e64 v23, 1, v0
  v_lshl_add_u32 v24, v23, 4, v3
  s_waitcnt vmcnt(11) lgkmcnt(0)
  s_barrier
  v_mfma_f32_16x16x32_bf16 v[128:131], a[40:43], a[0:3], 0
  ds_read_b128 a[72:75], v48 offset:10240
  s_lshl_b32 s62, s66, 19
  s_lshl_b32 s64, s66, 7
  v_mfma_f32_16x16x32_bf16 v[148:151], a[44:47], a[0:3], 0
  s_add_u32 s40, s63, s64
  s_add_u32 s41, s65, s64
  s_add_u32 m0, s60, 131072
  v_mfma_f32_16x16x32_bf16 v[168:171], a[48:51], a[0:3], 0
  ds_read_b128 a[76:79], v48 offset:12288
  buffer_load_dwordx4 v50, s[4:7], s40 offen lds
  v_mfma_f32_16x16x32_bf16 v[188:191], a[52:55], a[0:3], 0
  ds_read_b128 a[80:83], v48 offset:14336
  ds_read_b128 a[84:87], v48 offset:16384
  v_mfma_f32_16x16x32_bf16 v[132:135], a[40:43], a[4:7], 0
  s_nop 0
  s_add_u32 s66, s66, 1
  s_cmp_eq_u32 s66, 9
  s_cselect_b32 s66, 0, s66
  v_mfma_f32_16x16x32_bf16 v[152:155], a[44:47], a[4:7], 0
  ds_read_b128 a[88:91], v48 offset:18432
  ds_read_b64_tr_b16 a[112:113], v60 offset:0
  s_add_u32 m0, s60, 135168
  v_mfma_f32_16x16x32_bf16 v[172:175], a[48:51], a[4:7], 0
  s_add_u32 s3, s40, 36864
  ds_read_b64_tr_b16 a[114:115], v60 offset:1024
  v_mfma_f32_16x16x32_bf16 v[192:195], a[52:55], a[4:7], 0
  buffer_load_dwordx4 v50, s[4:7], s3 offen lds
  ds_read_b64_tr_b16 a[116:117], v61 offset:0
  v_mfma_f32_16x16x32_bf16 v[136:139], a[40:43], a[8:11], 0
  s_add_u32 m0, s61, 139264
  ds_read_b64_tr_b16 a[118:119], v61 offset:1024
  v_mfma_f32_16x16x32_bf16 v[156:159], a[44:47], a[8:11], 0
  s_add_u32 s3, s41, 73728
  v_mfma_f32_16x16x32_bf16 v[176:179], a[48:51], a[8:11], 0
  s_mov_b64 exec, s[70:71]
  buffer_load_dwordx4 v50, s[4:7], s3 offen lds
  s_mov_b64 exec, -1
  v_mfma_f32_16x16x32_bf16 v[196:199], a[52:55], a[8:11], 0
  ds_read_b64_tr_b16 a[120:121], v62 offset:0
  ds_read_b64_tr_b16 a[122:123], v62 offset:1024
  s_add_u32 m0, s43, 65536
  v_mfma_f32_16x16x32_bf16 v[140:143], a[40:43], a[12:15], 0
  s_nop 0
  s_add_u32 s3, s62, 0
  ds_read_b64_tr_b16 a[124:125], v63 offset:0
  v_mfma_f32_16x16x32_bf16 v[160:163], a[44:47], a[12:15], 0
  buffer_load_dwordx4 v52, s[16:19], s3 offen offset:0 lds
  ds_read_b64_tr_b16 a[126:127], v63 offset:1024
  v_mfma_f32_16x16x32_bf16 v[180:183], a[48:51], a[12:15], 0
  ds_read_b128 a[92:95], v49 offset:10240
  v_mfma_f32_16x16x32_bf16 v[200:203], a[52:55], a[12:15], 0
  s_add_u32 s3, s62, 31744
  buffer_load_dwordx4 v52, s[16:19], s3 offen offset:1024 lds
  v_mfma_f32_16x16x32_bf16 v[144:147], a[40:43], a[16:19], 0
  ds_read_b128 a[96:99], v49 offset:12288
  v_mfma_f32_16x16x32_bf16 v[164:167], a[44:47], a[16:19], 0
  ds_read_b128 a[100:103], v49 offset:14336
  s_add_u32 s3, s62, 63488
  v_mfma_f32_16x16x32_bf16 v[184:187], a[48:51], a[16:19], 0
  buffer_load_dwordx4 v53, s[16:19], s3 offen offset:2048 lds
  ds_read_b128 a[104:107], v49 offset:16384
  v_mfma_f32_16x16x32_bf16 v[204:207], a[52:55], a[16:19], 0
  ds_read_b128 a[108:111], v49 offset:18432
  v_mfma_f32_16x16x32_bf16 v[128:131], a[56:59], a[20:23], v[128:131]
  s_add_u32 s3, s62, 95232
  v_mfma_f32_16x16x32_bf16 v[148:151], a[60:63], a[20:23], v[148:151]
  buffer_load_dwordx4 v53, s[16:19], s3 offen offset:3072 lds
  ds_read_b64_tr_b16 a[128:129], v60 offset:8192
  v_mfma_f32_16x16x32_bf16 v[168:171], a[64:67], a[20:23], v[168:171]
  ds_read_b64_tr_b16 a[130:131], v60 offset:9216
  v_mfma_f32_16x16x32_bf16 v[188:191], a[68:71], a[20:23], v[188:191]
  s_add_u32 m0, s43, 81920
  ds_read_b64_tr_b16 a[132:133], v61 offset:8192
  s_add_u32 s3, s62, 256
  v_mfma_f32_16x16x32_bf16 v[132:135], a[56:59], a[24:27], v[132:135]
  buffer_load_dwordx4 v52, s[16:19], s3 offen offset:0 lds
  ds_read_b64_tr_b16 a[134:135], v61 offset:9216
  v_mfma_f32_16x16x32_bf16 v[152:155], a[60:63], a[24:27], v[152:155]
  v_mfma_f32_16x16x32_bf16 v[172:175], a[64:67], a[24:27], v[172:175]
  ds_read_b64_tr_b16 a[136:137], v62 offset:8192
  s_add_u32 s3, s62, 32000
  v_mfma_f32_16x16x32_bf16 v[192:195], a[68:71], a[24:27], v[192:195]
  buffer_load_dwordx4 v52, s[16:19], s3 offen offset:1024 lds
  ds_read_b64_tr_b16 a[138:139], v62 offset:9216
  v_mfma_f32_16x16x32_bf16 v[136:139], a[56:59], a[28:31], v[136:139]
  ds_read_b64_tr_b16 a[140:141], v63 offset:8192
  v_mfma_f32_16x16x32_bf16 v[156:159], a[60:63], a[28:31], v[156:159]
  s_add_u32 s3, s62, 63744
  ds_read_b64_tr_b16 a[142:143], v63 offset:9216
  v_mfma_f32_16x16x32_bf16 v[176:179], a[64:67], a[28:31], v[176:179]
  buffer_load_dwordx4 v53, s[16:19], s3 offen offset:2048 lds
  v_mfma_f32_16x16x32_bf16 v[196:199], a[68:71], a[28:31], v[196:199]
  v_mfma_f32_16x16x32_bf16 v[140:143], a[56:59], a[32:35], v[140:143]
  s_add_u32 s3, s62, 95488
  buffer_load_dwordx4 v53, s[16:19], s3 offen offset:3072 lds
  v_mfma_f32_16x16x32_bf16 v[160:163], a[60:63], a[32:35], v[160:163]
  v_mfma_f32_16x16x32_bf16 v[180:183], a[64:67], a[32:35], v[180:183]
  v_mfma_f32_16x16x32_bf16 v[200:203], a[68:71], a[32:35], v[200:203]
  v_mfma_f32_16x16x32_bf16 v[144:147], a[56:59], a[36:39], v[144:147]
  v_mfma_f32_16x16x32_bf16 v[164:167], a[60:63], a[36:39], v[164:167]
  v_mfma_f32_16x16x32_bf16 v[184:187], a[64:67], a[36:39], v[184:187]
  v_mfma_f32_16x16x32_bf16 v[204:207], a[68:71], a[36:39], v[204:207]
  s_waitcnt vmcnt(11) lgkmcnt(0)
  s_barrier
  v_mfma_f32_16x16x32_bf16 v[128:131], a[112:115], a[72:75], v[128:131]
  ds_read_b128 a[0:3], v48 offset:20480
  s_lshl_b32 s62, s66, 19
  s_lshl_b32 s64, s66, 7
  v_mfma_f32_16x16x32_bf16 v[148:151], a[116:119], a[72:75], v[148:151]
  s_add_u32 s40, s63, s64
  s_add_u32 s41, s65, s64
  s_add_u32 m0, s60, 141312
  v_mfma_f32_16x16x32_bf16 v[168:171], a[120:123], a[72:75], v[168:171]
  ds_read_b128 a[4:7], v48 offset:22528
  buffer_load_dwordx4 v50, s[4:7], s40 offen lds
  v_mfma_f32_16x16x32_bf16 v[188:191], a[124:127], a[72:75], v[188:191]
  ds_read_b128 a[8:11], v48 offset:24576
  ds_read_b128 a[12:15], v48 offset:26624
  v_mfma_f32_16x16x32_bf16 v[132:135], a[112:115], a[76:79], v[132:135]
  s_nop 0
  s_add_u32 s66, s66, 1
  s_cmp_eq_u32 s66, 9
  s_cselect_b32 s66, 0, s66
  v_mfma_f32_16x16x32_bf16 v[152:155], a[116:119], a[76:79], v[152:155]
  ds_read_b128 a[16:19], v48 offset:28672
  ds_read_b64_tr_b16 a[40:41], v64 offset:0
  s_add_u32 m0, s60, 145408
  v_mfma_f32_16x16x32_bf16 v[172:175], a[120:123], a[76:79], v[172:175]
  s_add_u32 s3, s40, 36864
  ds_read_b64_tr_b16 a[42:43], v64 offset:1024
  v_mfma_f32_16x16x32_bf16 v[192:195], a[124:127], a[76:79], v[192:195]
  buffer_load_dwordx4 v50, s[4:7], s3 offen lds
  ds_read_b64_tr_b16 a[44:45], v65 offset:0
  v_mfma_f32_16x16x32_bf16 v[136:139], a[112:115], a[80:83], v[136:139]
  s_add_u32 m0, s61, 149504
  ds_read_b64_tr_b16 a[46:47], v65 offset:1024
  v_mfma_f32_16x16x32_bf16 v[156:159], a[116:119], a[80:83], v[156:159]
  s_add_u32 s3, s41, 73728
  v_mfma_f32_16x16x32_bf16 v[176:179], a[120:123], a[80:83], v[176:179]
  s_mov_b64 exec, s[70:71]
  buffer_load_dwordx4 v50, s[4:7], s3 offen lds
  s_mov_b64 exec, -1
  v_mfma_f32_16x16x32_bf16 v[196:199], a[124:127], a[80:83], v[196:199]
  ds_read_b64_tr_b16 a[48:49], v66 offset:0
  ds_read_b64_tr_b16 a[50:51], v66 offset:1024
  s_add_u32 m0, s43, 32768
  v_mfma_f32_16x16x32_bf16 v[140:143], a[112:115], a[84:87], v[140:143]
  s_nop 0
  s_add_u32 s3, s62, 0
  ds_read_b64_tr_b16 a[52:53], v67 offset:0
  v_mfma_f32_16x16x32_bf16 v[160:163], a[116:119], a[84:87], v[160:163]
  buffer_load_dwordx4 v52, s[16:19], s3 offen offset:0 lds
  ds_read_b64_tr_b16 a[54:55], v67 offset:1024
  v_mfma_f32_16x16x32_bf16 v[180:183], a[120:123], a[84:87], v[180:183]
  ds_read_b128 a[20:23], v49 offset:20480
  v_mfma_f32_16x16x32_bf16 v[200:203], a[124:127], a[84:87], v[200:203]
  s_add_u32 s3, s62, 31744
  buffer_load_dwordx4 v52, s[16:19], s3 offen offset:1024 lds
  v_mfma_f32_16x16x32_bf16 v[144:147], a[112:115], a[88:91], v[144:147]
  ds_read_b128 a[24:27], v49 offset:22528
  v_mfma_f32_16x16x32_bf16 v[164:167], a[116:119], a[88:91], v[164:167]
  ds_read_b128 a[28:31], v49 offset:24576
  s_add_u32 s3, s62, 63488
  v_mfma_f32_16x16x32_bf16 v[184:187], a[120:123], a[88:91], v[184:187]
  buffer_load_dwordx4 v53, s[16:19], s3 offen offset:2048 lds
  ds_read_b128 a[32:35], v49 offset:26624
  v_mfma_f32_16x16x32_bf16 v[204:207], a[124:127], a[88:91], v[204:207]
  ds_read_b128 a[36:39], v49 offset:28672
  v_mfma_f32_16x16x32_bf16 v[128:131], a[128:131], a[92:95], v[128:131]
  s_add_u32 s3, s62, 95232
  v_mfma_f32_16x16x32_bf16 v[148:151], a[132:135], a[92:95], v[148:151]
  buffer_load_dwordx4 v53, s[16:19], s3 offen offset:3072 lds
  ds_read_b64_tr_b16 a[56:57], v64 offset:8192
  v_mfma_f32_16x16x32_bf16 v[168:171], a[136:139], a[92:95], v[168:171]
  ds_read_b64_tr_b16 a[58:59], v64 offset:9216
  v_mfma_f32_16x16x32_bf16 v[188:191], a[140:143], a[92:95], v[188:191]
  s_add_u32 m0, s43, 49152
  ds_read_b64_tr_b16 a[60:61], v65 offset:8192
  s_add_u32 s3, s62, 256
  v_mfma_f32_16x16x32_bf16 v[132:135], a[128:131], a[96:99], v[132:135]
  buffer_load_dwordx4 v52, s[16:19], s3 offen offset:0 lds
  ds_read_b64_tr_b16 a[62:63], v65 offset:9216
  v_mfma_f32_16x16x32_bf16 v[152:155], a[132:135], a[96:99], v[152:155]
  v_mfma_f32_16x16x32_bf16 v[172:175], a[136:139], a[96:99], v[172:175]
  ds_read_b64_tr_b16 a[64:65], v66 offset:8192
  s_add_u32 s3, s62, 32000
  v_mfma_f32_16x16x32_bf16 v[192:195], a[140:143], a[96:99], v[192:195]
  buffer_load_dwordx4 v52, s[16:19], s3 offen offset:1024 lds
  ds_read_b64_tr_b16 a[66:67], v66 offset:9216
  v_mfma_f32_16x16x32_bf16 v[136:139], a[128:131], a[100:103], v[136:139]
  ds_read_b64_tr_b16 a[68:69], v67 offset:8192
  v_mfma_f32_16x16x32_bf16 v[156:159], a[132:135], a[100:103], v[156:159]
  s_add_u32 s3, s62, 63744
  ds_read_b64_tr_b16 a[70:71], v67 offset:9216
  v_mfma_f32_16x16x32_bf16 v[176:179], a[136:139], a[100:103], v[176:179]
  buffer_load_dwordx4 v53, s[16:19], s3 offen offset:2048 lds
  v_mfma_f32_16x16x32_bf16 v[196:199], a[140:143], a[100:103], v[196:199]
  v_mfma_f32_16x16x32_bf16 v[140:143], a[128:131], a[104:107], v[140:143]
  s_add_u32 s3, s62, 95488
  buffer_load_dwordx4 v53, s[16:19], s3 offen offset:3072 lds
  v_mfma_f32_16x16x32_bf16 v[160:163], a[132:135], a[104:107], v[160:163]
  v_mfma_f32_16x16x32_bf16 v[180:183], a[136:139], a[104:107], v[180:183]
  v_mfma_f32_16x16x32_bf16 v[200:203], a[140:143], a[104:107], v[200:203]
  v_mfma_f32_16x16x32_bf16 v[144:147], a[128:131], a[108:111], v[144:147]
  v_mfma_f32_16x16x32_bf16 v[164:167], a[132:135], a[108:111], v[164:167]
  v_mfma_f32_16x16x32_bf16 v[184:187], a[136:139], a[108:111], v[184:187]
  v_mfma_f32_16x16x32_bf16 v[204:207], a[140:143], a[108:111], v[204:207]
  s_waitcnt vmcnt(11) lgkmcnt(0)
  s_barrier
  v_mfma_f32_16x16x32_bf16 v[128:131], a[40:43], a[0:3], v[128:131]
  ds_read_b128 a[72:75], v48 offset:0
  s_lshl_b32 s62, s66, 19
  s_lshl_b32 s64, s66, 7
  v_mfma_f32_16x16x32_bf16 v[148:151], a[44:47], a[0:3], v[148:151]
  s_add_u32 s40, s63, s64
  s_add_u32 s41, s65, s64
  s_add_u32 m0, s60, 151552
  v_mfma_f32_16x16x32_bf16 v[168:171], a[48:51], a[0:3], v[168:171]
  ds_read_b128 a[76:79], v48 offset:2048
  buffer_load_dwordx4 v50, s[4:7], s40 offen lds
  v_mfma_f32_16x16x32_bf16 v[188:191], a[52:55], a[0:3], v[188:191]
  ds_read_b128 a[80:83], v48 offset:4096
  ds_read_b128 a[84:87], v48 offset:6144
  v_mfma_f32_16x16x32_bf16 v[132:135], a[40:43], a[4:7], v[132:135]
  s_nop 0
  s_add_u32 s66, s66, 1
  s_cmp_eq_u32 s66, 9
  s_cselect_b32 s66, 0, s66
  v_mfma_f32_16x16x32_bf16 v[152:155], a[44:47], a[4:7], v[152:155]
  ds_read_b128 a[88:91], v48 offset:8192
  ds_read_b64_tr_b16 a[112:113], v56 offset:0
  s_add_u32 m0, s60, 155648
  v_mfma_f32_16x16x32_bf16 v[172:175], a[48:51], a[4:7], v[172:175]
  s_add_u32 s3, s40, 36864
  ds_read_b64_tr_b16 a[114:115], v56 offset:1024
  v_mfma_f32_16x16x32_bf16 v[192:195], a[52:55], a[4:7], v[192:195]
  buffer_load_dwordx4 v50, s[4:7], s3 offen lds
  ds_read_b64_tr_b16 a[116:117], v57 offset:0
  v_mfma_f32_16x16x32_bf16 v[136:139], a[40:43], a[8:11], v[136:139]
  s_add_u32 m0, s61, 159744
  ds_read_b64_tr_b16 a[118:119], v57 offset:1024
  v_mfma_f32_16x16x32_bf16 v[156:159], a[44:47], a[8:11], v[156:159]
  s_add_u32 s3, s41, 73728
  v_mfma_f32_16x16x32_bf16 v[176:179], a[48:51], a[8:11], v[176:179]
  s_mov_b64 exec, s[70:71]
  buffer_load_dwordx4 v50, s[4:7], s3 offen lds
  s_mov_b64 exec, -1
  v_mfma_f32_16x16x32_bf16 v[196:199], a[52:55], a[8:11], v[196:199]
  ds_read_b64_tr_b16 a[120:121], v58 offset:0
  ds_read_b64_tr_b16 a[122:123], v58 offset:1024
  s_add_u32 m0, s43, 98304
  v_mfma_f32_16x16x32_bf16 v[140:143], a[40:43], a[12:15], v[140:143]
  s_nop 0
  s_add_u32 s3, s62, 0
  ds_read_b64_tr_b16 a[124:125], v59 offset:0
  v_mfma_f32_16x16x32_bf16 v[160:163], a[44:47], a[12:15], v[160:163]
  buffer_load_dwordx4 v52, s[16:19], s3 offen offset:0 lds
  ds_read_b64_tr_b16 a[126:127], v59 offset:1024
  v_mfma_f32_16x16x32_bf16 v[180:183], a[48:51], a[12:15], v[180:183]
  ds_read_b128 a[92:95], v49 offset:0
  v_mfma_f32_16x16x32_bf16 v[200:203], a[52:55], a[12:15], v[200:203]
  s_add_u32 s3, s62, 31744
  buffer_load_dwordx4 v52, s[16:19], s3 offen offset:1024 lds
  v_mfma_f32_16x16x32_bf16 v[144:147], a[40:43], a[16:19], v[144:147]
  ds_read_b128 a[96:99], v49 offset:2048
  v_mfma_f32_16x16x32_bf16 v[164:167], a[44:47], a[16:19], v[164:167]
  ds_read_b128 a[100:103], v49 offset:4096
  s_add_u32 s3, s62, 63488
  v_mfma_f32_16x16x32_bf16 v[184:187], a[48:51], a[16:19], v[184:187]
  buffer_load_dwordx4 v53, s[16:19], s3 offen offset:2048 lds
  ds_read_b128 a[104:107], v49 offset:6144
  v_mfma_f32_16x16x32_bf16 v[204:207], a[52:55], a[16:19], v[204:207]
  ds_read_b128 a[108:111], v49 offset:8192
  v_mfma_f32_16x16x32_bf16 v[128:131], a[56:59], a[20:23], v[128:131]
  s_add_u32 s3, s62, 95232
  v_mfma_f32_16x16x32_bf16 v[148:151], a[60:63], a[20:23], v[148:151]
  buffer_load_dwordx4 v53, s[16:19], s3 offen offset:3072 lds
  ds_read_b64_tr_b16 a[128:129], v56 offset:8192
  v_mfma_f32_16x16x32_bf16 v[168:171], a[64:67], a[20:23], v[168:171]
  ds_read_b64_tr_b16 a[130:131], v56 offset:9216
  v_mfma_f32_16x16x32_bf16 v[188:191], a[68:71], a[20:23], v[188:191]
  s_add_u32 m0, s43, 114688
  ds_read_b64_tr_b16 a[132:133], v57 offset:8192
  s_add_u32 s3, s62, 256
  v_mfma_f32_16x16x32_bf16 v[132:135], a[56:59], a[24:27], v[132:135]
  buffer_load_dwordx4 v52, s[16:19], s3 offen offset:0 lds
  ds_read_b64_tr_b16 a[134:135], v57 offset:9216
  v_mfma_f32_16x16x32_bf16 v[152:155], a[60:63], a[24:27], v[152:155]
  v_mfma_f32_16x16x32_bf16 v[172:175], a[64:67], a[24:27], v[172:175]
  ds_read_b64_tr_b16 a[136:137], v58 offset:8192
  s_add_u32 s3, s62, 32000
  v_mfma_f32_16x16x32_bf16 v[192:195], a[68:71], a[24:27], v[192:195]
  buffer_load_dwordx4 v52, s[16:19], s3 offen offset:1024 lds
  ds_read_b64_tr_b16 a[138:139], v58 offset:9216
  v_mfma_f32_16x16x32_bf16 v[136:139], a[56:59], a[28:31], v[136:139]
  ds_read_b64_tr_b16 a[140:141], v59 offset:8192
  v_mfma_f32_16x16x32_bf16 v[156:159], a[60:63], a[28:31], v[156:159]
  s_add_u32 s3, s62, 63744
  ds_read_b64_tr_b16 a[142:143], v59 offset:9216
  v_mfma_f32_16x16x32_bf16 v[176:179], a[64:67], a[28:31], v[176:179]
  buffer_load_dwordx4 v53, s[16:19], s3 offen offset:2048 lds
  v_mfma_f32_16x16x32_bf16 v[196:199], a[68:71], a[28:31], v[196:199]
  v_mfma_f32_16x16x32_bf16 v[140:143], a[56:59], a[32:35], v[140:143]
  s_add_u32 s3, s62, 95488
  buffer_load_dwordx4 v53, s[16:19], s3 offen offset:3072 lds
  v_mfma_f32_16x16x32_bf16 v[160:163], a[60:63], a[32:35], v[160:163]
  v_mfma_f32_16x16x32_bf16 v[180:183], a[64:67], a[32:35], v[180:183]
  v_mfma_f32_16x16x32_bf16 v[200:203], a[68:71], a[32:35], v[200:203]
  v_mfma_f32_16x16x32_bf16 v[144:147], a[56:59], a[36:39], v[144:147]
  v_mfma_f32_16x16x32_bf16 v[164:167], a[60:63], a[36:39], v[164:167]
  v_mfma_f32_16x16x32_bf16 v[184:187], a[64:67], a[36:39], v[184:187]
  v_mfma_f32_16x16x32_bf16 v[204:207], a[68:71], a[36:39], v[204:207]
  s_waitcnt vmcnt(11) lgkmcnt(0)
  s_barrier
  v_mfma_f32_16x16x32_bf16 v[128:131], a[112:115], a[72:75], v[128:131]
  ds_read_b128 a[0:3], v48 offset:10240
  s_lshl_b32 s62, s66, 19
  s_lshl_b32 s64, s66, 7
  v_mfma_f32_16x16x32_bf16 v[148:151], a[116:119], a[72:75], v[148:151]
  s_add_u32 s40, s63, s64
  s_add_u32 s41, s65, s64
  s_add_u32 m0, s60, 131072
  v_mfma_f32_16x16x32_bf16 v[168:171], a[120:123], a[72:75], v[168:171]
  ds_read_b128 a[4:7], v48 offset:12288
  buffer_load_dwordx4 v50, s[4:7], s40 offen lds
  v_mfma_f32_16x16x32_bf16 v[188:191], a[124:127], a[72:75], v[188:191]
  ds_read_b128 a[8:11], v48 offset:14336
  ds_read_b128 a[12:15], v48 offset:16384
  v_mfma_f32_16x16x32_bf16 v[132:135], a[112:115], a[76:79], v[132:135]
  s_nop 0
  s_add_u32 s66, s66, 1
  s_cmp_eq_u32 s66, 9
  s_cselect_b32 s66, 0, s66
  v_mfma_f32_16x16x32_bf16 v[152:155], a[116:119], a[76:79], v[152:155]
  ds_read_b128 a[16:19], v48 offset:18432
  ds_read_b64_tr_b16 a[40:41], v60 offset:0
  s_add_u32 m0, s60, 135168
  v_mfma_f32_16x16x32_bf16 v[172:175], a[120:123], a[76:79], v[172:175]
  s_add_u32 s3, s40, 36864
  ds_read_b64_tr_b16 a[42:43], v60 offset:1024
  v_mfma_f32_16x16x32_bf16 v[192:195], a[124:127], a[76:79], v[192:195]
  buffer_load_dwordx4 v50, s[4:7], s3 offen lds
  ds_read_b64_tr_b16 a[44:45], v61 offset:0
  v_mfma_f32_16x16x32_bf16 v[136:139], a[112:115], a[80:83], v[136:139]
  s_add_u32 m0, s61, 139264
  ds_read_b64_tr_b16 a[46:47], v61 offset:1024
  v_mfma_f32_16x16x32_bf16 v[156:159], a[116:119], a[80:83], v[156:159]
  s_add_u32 s3, s41, 73728
  v_mfma_f32_16x16x32_bf16 v[176:179], a[120:123], a[80:83], v[176:179]
  s_mov_b64 exec, s[70:71]
  buffer_load_dwordx4 v50, s[4:7], s3 offen lds
  s_mov_b64 exec, -1
  v_mfma_f32_16x16x32_bf16 v[196:199], a[124:127], a[80:83], v[196:199]
  ds_read_b64_tr_b16 a[48:49], v62 offset:0
  ds_read_b64_tr_b16 a[50:51], v62 offset:1024
  s_add_u32 m0, s43, 65536
  v_mfma_f32_16x16x32_bf16 v[140:143], a[112:115], a[84:87], v[140:143]
  s_nop 0
  s_add_u32 s3, s62, 0
  ds_read_b64_tr_b16 a[52:53], v63 offset:0
  v_mfma_f32_16x16x32_bf16 v[160:163], a[116:119], a[84:87], v[160:163]
  buffer_load_dwordx4 v52, s[16:19], s3 offen offset:0 lds
  ds_read_b64_tr_b16 a[54:55], v63 offset:1024
  v_mfma_f32_16x16x32_bf16 v[180:183], a[120:123], a[84:87], v[180:183]
  ds_read_b128 a[20:23], v49 offset:10240
  v_mfma_f32_16x16x32_bf16 v[200:203], a[124:127], a[84:87], v[200:203]
  s_add_u32 s3, s62, 31744
  buffer_load_dwordx4 v52, s[16:19], s3 offen offset:1024 lds
  v_mfma_f32_16x16x32_bf16 v[144:147], a[112:115], a[88:91], v[144:147]
  ds_read_b128 a[24:27], v49 offset:12288
  v_mfma_f32_16x16x32_bf16 v[164:167], a[116:119], a[88:91], v[164:167]
  ds_read_b128 a[28:31], v49 offset:14336
  s_add_u32 s3, s62, 63488
  v_mfma_f32_16x16x32_bf16 v[184:187], a[120:123], a[88:91], v[184:187]
  buffer_load_dwordx4 v53, s[16:19], s3 offen offset:2048 lds
  ds_read_b128 a[32:35], v49 offset:16384
  v_mfma_f32_16x16x32_bf16 v[204:207], a[124:127], a[88:91], v[204:207]
  ds_read_b128 a[36:39], v49 offset:18432
  v_mfma_f32_16x16x32_bf16 v[128:131], a[128:131], a[92:95], v[128:131]
  s_add_u32 s3, s62, 95232
  v_mfma_f32_16x16x32_bf16 v[148:151], a[132:135], a[92:95], v[148:151]
  buffer_load_dwordx4 v53, s[16:19], s3 offen offset:3072 lds
  ds_read_b64_tr_b16 a[56:57], v60 offset:8192
  v_mfma_f32_16x16x32_bf16 v[168:171], a[136:139], a[92:95], v[168:171]
  ds_read_b64_tr_b16 a[58:59], v60 offset:9216
  v_mfma_f32_16x16x32_bf16 v[188:191], a[140:143], a[92:95], v[188:191]
  s_add_u32 m0, s43, 81920
  ds_read_b64_tr_b16 a[60:61], v61 offset:8192
  s_add_u32 s3, s62, 256
  v_mfma_f32_16x16x32_bf16 v[132:135], a[128:131], a[96:99], v[132:135]
  buffer_load_dwordx4 v52, s[16:19], s3 offen offset:0 lds
  ds_read_b64_tr_b16 a[62:63], v61 offset:9216
  v_mfma_f32_16x16x32_bf16 v[152:155], a[132:135], a[96:99], v[152:155]
  v_mfma_f32_16x16x32_bf16 v[172:175], a[136:139], a[96:99], v[172:175]
  ds_read_b64_tr_b16 a[64:65], v62 offset:8192
  s_add_u32 s3, s62, 32000
  v_mfma_f32_16x16x32_bf16 v[192:195], a[140:143], a[96:99], v[192:195]
  buffer_load_dwordx4 v52, s[16:19], s3 offen offset:1024 lds
  ds_read_b64_tr_b16 a[66:67], v62 offset:9216
  v_mfma_f32_16x16x32_bf16 v[136:139], a[128:131], a[100:103], v[136:139]
  ds_read_b64_tr_b16 a[68:69], v63 offset:8192
  v_mfma_f32_16x16x32_bf16 v[156:159], a[132:135], a[100:103], v[156:159]
  s_add_u32 s3, s62, 63744
  ds_read_b64_tr_b16 a[70:71], v63 offset:9216
  v_mfma_f32_16x16x32_bf16 v[176:179], a[136:139], a[100:103], v[176:179]
  buffer_load_dwordx4 v53, s[16:19], s3 offen offset:2048 lds
  v_mfma_f32_16x16x32_bf16 v[196:199], a[140:143], a[100:103], v[196:199]
  v_mfma_f32_16x16x32_bf16 v[140:143], a[128:131], a[104:107], v[140:143]
  s_add_u32 s3, s62, 95488
  buffer_load_dwordx4 v53, s[16:19], s3 offen offset:3072 lds
  v_mfma_f32_16x16x32_bf16 v[160:163], a[132:135], a[104:107], v[160:163]
  v_mfma_f32_16x16x32_bf16 v[180:183], a[136:139], a[104:107], v[180:183]
  v_mfma_f32_16x16x32_bf16 v[200:203], a[140:143], a[104:107], v[200:203]
  v_mfma_f32_16x16x32_bf16 v[144:147], a[128:131], a[108:111], v[144:147]
  v_mfma_f32_16x16x32_bf16 v[164:167], a[132:135], a[108:111], v[164:167]
  v_mfma_f32_16x16x32_bf16 v[184:187], a[136:139], a[108:111], v[184:187]
  v_mfma_f32_16x16x32_bf16 v[204:207], a[140:143], a[108:111], v[204:207]
  s_waitcnt vmcnt(11) lgkmcnt(0)
  s_barrier
  v_mfma_f32_16x16x32_bf16 v[128:131], a[40:43], a[0:3], v[128:131]
  ds_read_b128 a[72:75], v48 offset:20480
  s_lshl_b32 s62, s66, 19
  s_lshl_b32 s64, s66, 7
  v_mfma_f32_16x16x32_bf16 v[148:151], a[44:47], a[0:3], v[148:151]
  s_add_u32 s40, s63, s64
  s_add_u32 s41, s65, s64
  s_add_u32 m0, s60, 141312
  v_mfma_f32_16x16x32_bf16 v[168:171], a[48:51], a[0:3], v[168:171]
  ds_read_b128 a[76:79], v48 offset:22528
  buffer_load_dwordx4 v50, s[4:7], s40 offen lds
  v_mfma_f32_16x16x32_bf16 v[188:191], a[52:55], a[0:3], v[188:191]
  ds_read_b128 a[80:83], v48 offset:24576
  ds_read_b128 a[84:87], v48 offset:26624
  v_mfma_f32_16x16x32_bf16 v[132:135], a[40:43], a[4:7], v[132:135]
  s_nop 0
  s_add_u32 s66, s66, 1
  s_cmp_eq_u32 s66, 9
  s_cselect_b32 s66, 0, s66
  v_mfma_f32_16x16x32_bf16 v[152:155], a[44:47], a[4:7], v[152:155]
  ds_read_b128 a[88:91], v48 offset:28672
  ds_read_b64_tr_b16 a[112:113], v64 offset:0
  s_add_u32 m0, s60, 145408
  v_mfma_f32_16x16x32_bf16 v[172:175], a[48:51], a[4:7], v[172:175]
  s_add_u32 s3, s40, 36864
  ds_read_b64_tr_b16 a[114:115], v64 offset:1024
  v_mfma_f32_16x16x32_bf16 v[192:195], a[52:55], a[4:7], v[192:195]
  buffer_load_dwordx4 v50, s[4:7], s3 offen lds
  ds_read_b64_tr_b16 a[116:117], v65 offset:0
  v_mfma_f32_16x16x32_bf16 v[136:139], a[40:43], a[8:11], v[136:139]
  s_add_u32 m0, s61, 149504
  ds_read_b64_tr_b16 a[118:119], v65 offset:1024
  v_mfma_f32_16x16x32_bf16 v[156:159], a[44:47], a[8:11], v[156:159]
  s_add_u32 s3, s41, 73728
  v_mfma_f32_16x16x32_bf16 v[176:179], a[48:51], a[8:11], v[176:179]
  s_mov_b64 exec, s[70:71]
  buffer_load_dwordx4 v50, s[4:7], s3 offen lds
  s_mov_b64 exec, -1
  v_mfma_f32_16x16x32_bf16 v[196:199], a[52:55], a[8:11], v[196:199]
  ds_read_b64_tr_b16 a[120:121], v66 offset:0
  ds_read_b64_tr_b16 a[122:123], v66 offset:1024
  s_add_u32 m0, s43, 32768
  v_mfma_f32_16x16x32_bf16 v[140:143], a[40:43], a[12:15], v[140:143]
  s_nop 0
  s_add_u32 s3, s62, 0
  ds_read_b64_tr_b16 a[124:125], v67 offset:0
  v_mfma_f32_16x16x32_bf16 v[160:163], a[44:47], a[12:15], v[160:163]
  buffer_load_dwordx4 v52, s[16:19], s3 offen offset:0 lds
  ds_read_b64_tr_b16 a[126:127], v67 offset:1024
  v_mfma_f32_16x16x32_bf16 v[180:183], a[48:51], a[12:15], v[180:183]
  ds_read_b128 a[92:95], v49 offset:20480
  v_mfma_f32_16x16x32_bf16 v[200:203], a[52:55], a[12:15], v[200:203]
  s_add_u32 s3, s62, 31744
  buffer_load_dwordx4 v52, s[16:19], s3 offen offset:1024 lds
  v_mfma_f32_16x16x32_bf16 v[144:147], a[40:43], a[16:19], v[144:147]
  ds_read_b128 a[96:99], v49 offset:22528
  v_mfma_f32_16x16x32_bf16 v[164:167], a[44:47], a[16:19], v[164:167]
  ds_read_b128 a[100:103], v49 offset:24576
  s_add_u32 s3, s62, 63488
  v_mfma_f32_16x16x32_bf16 v[184:187], a[48:51], a[16:19], v[184:187]
  buffer_load_dwordx4 v53, s[16:19], s3 offen offset:2048 lds
  ds_read_b128 a[104:107], v49 offset:26624
  v_mfma_f32_16x16x32_bf16 v[204:207], a[52:55], a[16:19], v[204:207]
  ds_read_b128 a[108:111], v49 offset:28672
  v_mfma_f32_16x16x32_bf16 v[128:131], a[56:59], a[20:23], v[128:131]
  s_add_u32 s3, s62, 95232
  v_mfma_f32_16x16x32_bf16 v[148:151], a[60:63], a[20:23], v[148:151]
  buffer_load_dwordx4 v53, s[16:19], s3 offen offset:3072 lds
  ds_read_b64_tr_b16 a[128:129], v64 offset:8192
  v_mfma_f32_16x16x32_bf16 v[168:171], a[64:67], a[20:23], v[168:171]
  ds_read_b64_tr_b16 a[130:131], v64 offset:9216
  v_mfma_f32_16x16x32_bf16 v[188:191], a[68:71], a[20:23], v[188:191]
  s_add_u32 m0, s43, 49152
  ds_read_b64_tr_b16 a[132:133], v65 offset:8192
  s_add_u32 s3, s62, 256
  v_mfma_f32_16x16x32_bf16 v[132:135], a[56:59], a[24:27], v[132:135]
  buffer_load_dwordx4 v52, s[16:19], s3 offen offset:0 lds
  ds_read_b64_tr_b16 a[134:135], v65 offset:9216
  v_mfma_f32_16x16x32_bf16 v[152:155], a[60:63], a[24:27], v[152:155]
  v_mfma_f32_16x16x32_bf16 v[172:175], a[64:67], a[24:27], v[172:175]
  ds_read_b64_tr_b16 a[136:137], v66 offset:8192
  s_add_u32 s3, s62, 32000
  v_mfma_f32_16x16x32_bf16 v[192:195], a[68:71], a[24:27], v[192:195]
  buffer_load_dwordx4 v52, s[16:19], s3 offen offset:1024 lds
  ds_read_b64_tr_b16 a[138:139], v66 offset:9216
  v_mfma_f32_16x16x32_bf16 v[136:139], a[56:59], a[28:31], v[136:139]
  ds_read_b64_tr_b16 a[140:141], v67 offset:8192
  v_mfma_f32_16x16x32_bf16 v[156:159], a[60:63], a[28:31], v[156:159]
  s_add_u32 s3, s62, 63744
  ds_read_b64_tr_b16 a[142:143], v67 offset:9216
  v_mfma_f32_16x16x32_bf16 v[176:179], a[64:67], a[28:31], v[176:179]
  buffer_load_dwordx4 v53, s[16:19], s3 offen offset:2048 lds
  v_mfma_f32_16x16x32_bf16 v[196:199], a[68:71], a[28:31], v[196:199]
  v_mfma_f32_16x16x32_bf16 v[140:143], a[56:59], a[32:35], v[140:143]
  s_add_u32 s3, s62, 95488
  buffer_load_dwordx4 v53, s[16:19], s3 offen offset:3072 lds
  v_mfma_f32_16x16x32_bf16 v[160:163], a[60:63], a[32:35], v[160:163]
  v_mfma_f32_16x16x32_bf16 v[180:183], a[64:67], a[32:35], v[180:183]
  v_mfma_f32_16x16x32_bf16 v[200:203], a[68:71], a[32:35], v[200:203]
  v_mfma_f32_16x16x32_bf16 v[144:147], a[56:59], a[36:39], v[144:147]
  v_mfma_f32_16x16x32_bf16 v[164:167], a[60:63], a[36:39], v[164:167]
  v_mfma_f32_16x16x32_bf16 v[184:187], a[64:67], a[36:39], v[184:187]
  v_mfma_f32_16x16x32_bf16 v[204:207], a[68:71], a[36:39], v[204:207]
  s_waitcnt vmcnt(11) lgkmcnt(0)
  s_barrier
  v_mfma_f32_16x16x32_bf16 v[128:131], a[112:115], a[72:75], v[128:131]
  ds_read_b128 a[0:3], v48 offset:0
  s_lshl_b32 s62, s66, 19
  s_lshl_b32 s64, s66, 7
  v_mfma_f32_16x16x32_bf16 v[148:151], a[116:119], a[72:75], v[148:151]
  s_add_u32 s40, s63, s64
  s_add_u32 s41, s65, s64
  s_add_u32 m0, s60, 151552
  v_mfma_f32_16x16x32_bf16 v[168:171], a[120:123], a[72:75], v[168:171]
  ds_read_b128 a[4:7], v48 offset:2048
  buffer_load_dwordx4 v50, s[4:7], s40 offen lds
  v_mfma_f32_16x16x32_bf16 v[188:191], a[124:127], a[72:75], v[188:191]
  ds_read_b128 a[8:11], v48 offset:4096
  ds_read_b128 a[12:15], v48 offset:6144
  v_mfma_f32_16x16x32_bf16 v[132:135], a[112:115], a[76:79], v[132:135]
  s_nop 0
  s_add_u32 s66, s66, 1
  s_cmp_eq_u32 s66, 9
  s_cselect_b32 s66, 0, s66
  v_mfma_f32_16x16x32_bf16 v[152:155], a[116:119], a[76:79], v[152:155]
  ds_read_b128 a[16:19], v48 offset:8192
  s_add_u32 m0, s60, 155648
  s_add_u32 s3, s40, 36864
  v_mfma_f32_16x16x32_bf16 v[172:175], a[120:123], a[76:79], v[172:175]
  buffer_load_dwordx4 v50, s[4:7], s3 offen lds
  ds_read_b64_tr_b16 a[40:41], v56 offset:0
  s_add_u32 m0, s61, 159744
  v_mfma_f32_16x16x32_bf16 v[192:195], a[124:127], a[76:79], v[192:195]
  ds_read_b64_tr_b16 a[42:43], v56 offset:1024
  s_add_u32 s3, s41, 73728
  v_mfma_f32_16x16x32_bf16 v[136:139], a[112:115], a[80:83], v[136:139]
  s_mov_b64 exec, s[70:71]
  buffer_load_dwordx4 v50, s[4:7], s3 offen lds
  s_mov_b64 exec, -1
  v_mfma_f32_16x16x32_bf16 v[156:159], a[116:119], a[80:83], v[156:159]
  ds_read_b64_tr_b16 a[44:45], v57 offset:0
  ds_read_b64_tr_b16 a[46:47], v57 offset:1024
  s_add_u32 m0, s43, 98304
  v_mfma_f32_16x16x32_bf16 v[176:179], a[120:123], a[80:83], v[176:179]
  s_nop 0
  s_add_u32 s3, s62, 0
  buffer_load_dwordx4 v52, s[16:19], s3 offen offset:0 lds
  v_mfma_f32_16x16x32_bf16 v[196:199], a[124:127], a[80:83], v[196:199]
  ds_read_b64_tr_b16 a[48:49], v58 offset:0
  ds_read_b64_tr_b16 a[50:51], v58 offset:1024
  s_add_u32 s3, s62, 31744
  v_mfma_f32_16x16x32_bf16 v[140:143], a[112:115], a[84:87], v[140:143]
  buffer_load_dwordx4 v52, s[16:19], s3 offen offset:1024 lds
  ds_read_b64_tr_b16 a[52:53], v59 offset:0
  v_mfma_f32_16x16x32_bf16 v[160:163], a[116:119], a[84:87], v[160:163]
  s_add_u32 s3, s62, 63488
  ds_read_b64_tr_b16 a[54:55], v59 offset:1024
  v_mfma_f32_16x16x32_bf16 v[180:183], a[120:123], a[84:87], v[180:183]
  buffer_load_dwordx4 v53, s[16:19], s3 offen offset:2048 lds
  ds_read_b128 a[20:23], v49 offset:0
  v_mfma_f32_16x16x32_bf16 v[200:203], a[124:127], a[84:87], v[200:203]
  s_add_u32 s3, s62, 95232
  buffer_load_dwordx4 v53, s[16:19], s3 offen offset:3072 lds
  v_mfma_f32_16x16x32_bf16 v[144:147], a[112:115], a[88:91], v[144:147]
  ds_read_b128 a[24:27], v49 offset:2048
  v_mfma_f32_16x16x32_bf16 v[164:167], a[116:119], a[88:91], v[164:167]
  ds_read_b128 a[28:31], v49 offset:4096
  s_add_u32 m0, s43, 114688
  v_mfma_f32_16x16x32_bf16 v[184:187], a[120:123], a[88:91], v[184:187]
  s_add_u32 s3, s62, 256
  buffer_load_dwordx4 v52, s[16:19], s3 offen offset:0 lds
  v_mfma_f32_16x16x32_bf16 v[204:207], a[124:127], a[88:91], v[204:207]
  ds_read_b128 a[32:35], v49 offset:6144
  ds_read_b128 a[36:39], v49 offset:8192
  v_mfma_f32_16x16x32_bf16 v[128:131], a[128:131], a[92:95], v[128:131]
  s_add_u32 s3, s62, 32000
  buffer_load_dwordx4 v52, s[16:19], s3 offen offset:1024 lds
  v_mfma_f32_16x16x32_bf16 v[148:151], a[132:135], a[92:95], v[148:151]
  ds_read_b64_tr_b16 a[56:57], v56 offset:8192
  v_mfma_f32_16x16x32_bf16 v[168:171], a[136:139], a[92:95], v[168:171]
  ds_read_b64_tr_b16 a[58:59], v56 offset:9216
  s_add_u32 s3, s62, 63744
  v_mfma_f32_16x16x32_bf16 v[188:191], a[140:143], a[92:95], v[188:191]
  buffer_load_dwordx4 v53, s[16:19], s3 offen offset:2048 lds
  ds_read_b64_tr_b16 a[60:61], v57 offset:8192
  v_mfma_f32_16x16x32_bf16 v[132:135], a[128:131], a[96:99], v[132:135]
  s_add_u32 s3, s62, 95488
  buffer_load_dwordx4 v53, s[16:19], s3 offen offset:3072 lds
  v_mfma_f32_16x16x32_bf16 v[152:155], a[132:135], a[96:99], v[152:155]
  ds_read_b64_tr_b16 a[62:63], v57 offset:9216
  v_mfma_f32_16x16x32_bf16 v[172:175], a[136:139], a[96:99], v[172:175]
  ds_read_b64_tr_b16 a[64:65], v58 offset:8192
  s_add_u32 m0, s43, 0x0
  s_add_u32 s51, s49, 0
  v_mfma_f32_16x16x32_bf16 v[192:195], a[140:143], a[96:99], v[192:195]
  s_and_b32 s51, s51, 0x3ffff
  ds_read_b64_tr_b16 a[66:67], v58 offset:9216
  v_mfma_f32_16x16x32_bf16 v[136:139], a[128:131], a[100:103], v[136:139]
  buffer_load_dwordx4 v16, s[8:11], s51 offen offset:0 nt lds
  ds_read_b64_tr_b16 a[68:69], v59 offset:8192
  v_mfma_f32_16x16x32_bf16 v[156:159], a[132:135], a[100:103], v[156:159]
  buffer_load_dwordx4 v17, s[8:11], s51 offen offset:1024 nt lds
  ds_read_b64_tr_b16 a[70:71], v59 offset:9216
  v_mfma_f32_16x16x32_bf16 v[176:179], a[136:139], a[100:103], v[176:179]
  v_mfma_f32_16x16x32_bf16 v[196:199], a[140:143], a[100:103], v[196:199]
  buffer_load_dwordx4 v18, s[8:11], s51 offen offset:2048 nt lds
  v_mfma_f32_16x16x32_bf16 v[140:143], a[128:131], a[104:107], v[140:143]
  v_mfma_f32_16x16x32_bf16 v[160:163], a[132:135], a[104:107], v[160:163]
  buffer_load_dwordx4 v19, s[8:11], s51 offen offset:3072 nt lds
  v_mfma_f32_16x16x32_bf16 v[180:183], a[136:139], a[104:107], v[180:183]
  v_mfma_f32_16x16x32_bf16 v[200:203], a[140:143], a[104:107], v[200:203]
  v_mfma_f32_16x16x32_bf16 v[144:147], a[128:131], a[108:111], v[144:147]
  v_mfma_f32_16x16x32_bf16 v[164:167], a[132:135], a[108:111], v[164:167]
  v_mfma_f32_16x16x32_bf16 v[184:187], a[136:139], a[108:111], v[184:187]
  v_mfma_f32_16x16x32_bf16 v[204:207], a[140:143], a[108:111], v[204:207]
  s_waitcnt vmcnt(15) lgkmcnt(0)
  s_barrier
  v_mfma_f32_16x16x32_bf16 v[128:131], a[40:43], a[0:3], v[128:131]
  ds_read_b128 a[72:75], v48 offset:10240
  s_add_u32 m0, s43, 16384
  s_add_u32 s51, s49, 16384
  v_mfma_f32_16x16x32_bf16 v[148:151], a[44:47], a[0:3], v[148:151]
  ds_read_b128 a[76:79], v48 offset:12288
  s_and_b32 s51, s51, 0x3ffff
  v_mfma_f32_16x16x32_bf16 v[168:171], a[48:51], a[0:3], v[168:171]
  ds_read_b128 a[80:83], v48 offset:14336
  buffer_load_dwordx4 v16, s[8:11], s51 offen offset:0 nt lds
  v_mfma_f32_16x16x32_bf16 v[188:191], a[52:55], a[0:3], v[188:191]
  ds_read_b128 a[84:87], v48 offset:16384
  ds_read_b128 a[88:91], v48 offset:18432
  v_mfma_f32_16x16x32_bf16 v[132:135], a[40:43], a[4:7], v[132:135]
  v_mfma_f32_16x16x32_bf16 v[152:155], a[44:47], a[4:7], v[152:155]
  ds_read_b64_tr_b16 a[112:113], v60 offset:0
  v_mfma_f32_16x16x32_bf16 v[172:175], a[48:51], a[4:7], v[172:175]
  ds_read_b64_tr_b16 a[114:115], v60 offset:1024
  v_mfma_f32_16x16x32_bf16 v[192:195], a[52:55], a[4:7], v[192:195]
  ds_read_b64_tr_b16 a[116:117], v61 offset:0
  v_mfma_f32_16x16x32_bf16 v[136:139], a[40:43], a[8:11], v[136:139]
  ds_read_b64_tr_b16 a[118:119], v61 offset:1024
  v_mfma_f32_16x16x32_bf16 v[156:159], a[44:47], a[8:11], v[156:159]
  v_mfma_f32_16x16x32_bf16 v[176:179], a[48:51], a[8:11], v[176:179]
  ds_read_b64_tr_b16 a[120:121], v62 offset:0
  buffer_load_dwordx4 v17, s[8:11], s51 offen offset:1024 nt lds
  v_mfma_f32_16x16x32_bf16 v[196:199], a[52:55], a[8:11], v[196:199]
  ds_read_b64_tr_b16 a[122:123], v62 offset:1024
  v_mfma_f32_16x16x32_bf16 v[140:143], a[40:43], a[12:15], v[140:143]
  ds_read_b64_tr_b16 a[124:125], v63 offset:0
  v_mfma_f32_16x16x32_bf16 v[160:163], a[44:47], a[12:15], v[160:163]
  ds_read_b64_tr_b16 a[126:127], v63 offset:1024
  v_mfma_f32_16x16x32_bf16 v[180:183], a[48:51], a[12:15], v[180:183]
  ds_read_b128 a[92:95], v49 offset:10240
  v_mfma_f32_16x16x32_bf16 v[200:203], a[52:55], a[12:15], v[200:203]
  v_mfma_f32_16x16x32_bf16 v[144:147], a[40:43], a[16:19], v[144:147]
  ds_read_b128 a[96:99], v49 offset:12288
  v_mfma_f32_16x16x32_bf16 v[164:167], a[44:47], a[16:19], v[164:167]
  ds_read_b128 a[100:103], v49 offset:14336
  v_mfma_f32_16x16x32_bf16 v[184:187], a[48:51], a[16:19], v[184:187]
  ds_read_b128 a[104:107], v49 offset:16384
  buffer_load_dwordx4 v18, s[8:11], s51 offen offset:2048 nt lds
  v_mfma_f32_16x16x32_bf16 v[204:207], a[52:55], a[16:19], v[204:207]
  ds_read_b128 a[108:111], v49 offset:18432
  v_mfma_f32_16x16x32_bf16 v[128:131], a[56:59], a[20:23], v[128:131]
  v_mfma_f32_16x16x32_bf16 v[148:151], a[60:63], a[20:23], v[148:151]
  ds_read_b64_tr_b16 a[128:129], v60 offset:8192
  v_mfma_f32_16x16x32_bf16 v[168:171], a[64:67], a[20:23], v[168:171]
  ds_read_b64_tr_b16 a[130:131], v60 offset:9216
  v_mfma_f32_16x16x32_bf16 v[188:191], a[68:71], a[20:23], v[188:191]
  ds_read_b64_tr_b16 a[132:133], v61 offset:8192
  v_mfma_f32_16x16x32_bf16 v[132:135], a[56:59], a[24:27], v[132:135]
  ds_read_b64_tr_b16 a[134:135], v61 offset:9216
  v_mfma_f32_16x16x32_bf16 v[152:155], a[60:63], a[24:27], v[152:155]
  v_mfma_f32_16x16x32_bf16 v[172:175], a[64:67], a[24:27], v[172:175]
  ds_read_b64_tr_b16 a[136:137], v62 offset:8192
  buffer_load_dwordx4 v19, s[8:11], s51 offen offset:3072 nt lds
  v_mfma_f32_16x16x32_bf16 v[192:195], a[68:71], a[24:27], v[192:195]
  ds_read_b64_tr_b16 a[138:139], v62 offset:9216
  v_mfma_f32_16x16x32_bf16 v[136:139], a[56:59], a[28:31], v[136:139]
  ds_read_b64_tr_b16 a[140:141], v63 offset:8192
  v_mfma_f32_16x16x32_bf16 v[156:159], a[60:63], a[28:31], v[156:159]
  ds_read_b64_tr_b16 a[142:143], v63 offset:9216
  v_mfma_f32_16x16x32_bf16 v[176:179], a[64:67], a[28:31], v[176:179]
  v_mfma_f32_16x16x32_bf16 v[196:199], a[68:71], a[28:31], v[196:199]
  v_mfma_f32_16x16x32_bf16 v[140:143], a[56:59], a[32:35], v[140:143]
  v_mfma_f32_16x16x32_bf16 v[160:163], a[60:63], a[32:35], v[160:163]
  v_mfma_f32_16x16x32_bf16 v[180:183], a[64:67], a[32:35], v[180:183]
  v_mfma_f32_16x16x32_bf16 v[200:203], a[68:71], a[32:35], v[200:203]
  v_mfma_f32_16x16x32_bf16 v[144:147], a[56:59], a[36:39], v[144:147]
  v_mfma_f32_16x16x32_bf16 v[164:167], a[60:63], a[36:39], v[164:167]
  v_mfma_f32_16x16x32_bf16 v[184:187], a[64:67], a[36:39], v[184:187]
  v_mfma_f32_16x16x32_bf16 v[204:207], a[68:71], a[36:39], v[204:207]
  s_waitcnt vmcnt(8) lgkmcnt(0)
  s_barrier
  v_mfma_f32_16x16x32_bf16 v[128:131], a[112:115], a[72:75], v[128:131]
  ds_read_b128 a[0:3], v48 offset:20480
  s_add_u32 m0, s43, 65536
  s_mov_b32 s40, 1040356334
  v_mfma_f32_16x16x32_bf16 v[148:151], a[116:119], a[72:75], v[148:151]
  s_nop 0
  s_add_u32 s51, s49, 0
  ds_read_b128 a[4:7], v48 offset:22528
  s_mov_b32 s41, 1040356334
  v_mfma_f32_16x16x32_bf16 v[168:171], a[120:123], a[72:75], v[168:171]
  s_and_b32 s51, s51, 0x3ffff
  ds_read_b128 a[8:11], v48 offset:24576
  s_mul_i32 s42, s33, 20480
  v_mfma_f32_16x16x32_bf16 v[188:191], a[124:127], a[72:75], v[188:191]
  buffer_load_dwordx4 v20, s[12:15], s51 offen offset:0 nt lds
  ds_read_b128 a[12:15], v48 offset:26624
  v_mfma_f32_16x16x32_bf16 v[132:135], a[112:115], a[76:79], v[132:135]
  ds_read_b128 a[16:19], v48 offset:28672
  s_mul_i32 s3, s34, 10240
  v_mfma_f32_16x16x32_bf16 v[152:155], a[116:119], a[76:79], v[152:155]
  ds_read_b64_tr_b16 a[40:41], v64 offset:0
  v_mfma_f32_16x16x32_bf16 v[172:175], a[120:123], a[76:79], v[172:175]
  s_nop 0
  ds_read_b64_tr_b16 a[42:43], v64 offset:1024
  s_add_u32 s3, s42, s3
  v_mfma_f32_16x16x32_bf16 v[192:195], a[124:127], a[76:79], v[192:195]
  ds_read_b64_tr_b16 a[44:45], v65 offset:0
  v_mfma_f32_16x16x32_bf16 v[136:139], a[112:115], a[80:83], v[136:139]
  ds_read_b64_tr_b16 a[46:47], v65 offset:1024
  s_add_u32 s3, s3, 81920
  v_mfma_f32_16x16x32_bf16 v[156:159], a[116:119], a[80:83], v[156:159]
  v_mfma_f32_16x16x32_bf16 v[176:179], a[120:123], a[80:83], v[176:179]
  ds_read_b64_tr_b16 a[48:49], v66 offset:0
  buffer_load_dwordx4 v21, s[12:15], s51 offen offset:1024 nt lds
  v_mfma_f32_16x16x32_bf16 v[196:199], a[124:127], a[80:83], v[196:199]
  ds_read_b64_tr_b16 a[50:51], v66 offset:1024
  v_lshlrev_b32_e64 v3, 4, v1
  v_mfma_f32_16x16x32_bf16 v[140:143], a[112:115], a[84:87], v[140:143]
  ds_read_b64_tr_b16 a[52:53], v67 offset:0
  v_add_u32_e64 v3, s3, v3
  v_mfma_f32_16x16x32_bf16 v[160:163], a[116:119], a[84:87], v[160:163]
  ds_read_b64_tr_b16 a[54:55], v67 offset:1024
  v_mfma_f32_16x16x32_bf16 v[180:183], a[120:123], a[84:87], v[180:183]
  ds_read_b128 a[20:23], v49 offset:20480
  v_bfe_u32 v23, v0, 4, 1
  v_mfma_f32_16x16x32_bf16 v[200:203], a[124:127], a[84:87], v[200:203]
  v_mfma_f32_16x16x32_bf16 v[144:147], a[112:115], a[88:91], v[144:147]
  ds_read_b128 a[24:27], v49 offset:22528
  v_lshl_add_u32 v3, v23, 3, v3
  v_mfma_f32_16x16x32_bf16 v[164:167], a[116:119], a[88:91], v[164:167]
  ds_read_b128 a[28:31], v49 offset:24576
  v_mfma_f32_16x16x32_bf16 v[184:187], a[120:123], a[88:91], v[184:187]
  ds_read_b128 a[32:35], v49 offset:26624
  buffer_load_dwordx4 v20, s[12:15], s51 offen offset:2048 nt lds
  v_mfma_f32_16x16x32_bf16 v[204:207], a[124:127], a[88:91], v[204:207]
  ds_read_b128 a[36:39], v49 offset:28672
  v_lshrrev_b32_e64 v23, 5, v0
  v_mfma_f32_16x16x32_bf16 v[128:131], a[128:131], a[92:95], v[128:131]
  v_mul_u32_u24 v23, 5120, v23
  v_mfma_f32_16x16x32_bf16 v[148:151], a[132:135], a[92:95], v[148:151]
  ds_read_b64_tr_b16 a[56:57], v64 offset:8192
  v_mfma_f32_16x16x32_bf16 v[168:171], a[136:139], a[92:95], v[168:171]
  ds_read_b64_tr_b16 a[58:59], v64 offset:9216
  v_add_u32_e64 v3, v3, v23
  v_mfma_f32_16x16x32_bf16 v[188:191], a[140:143], a[92:95], v[188:191]
  ds_read_b64_tr_b16 a[60:61], v65 offset:8192
  v_mfma_f32_16x16x32_bf16 v[132:135], a[128:131], a[96:99], v[132:135]
  ds_read_b64_tr_b16 a[62:63], v65 offset:9216
  s_add_u32 s42, s42, 81920
  v_mfma_f32_16x16x32_bf16 v[152:155], a[132:135], a[96:99], v[152:155]
  v_mfma_f32_16x16x32_bf16 v[172:175], a[136:139], a[96:99], v[172:175]
  ds_read_b64_tr_b16 a[64:65], v66 offset:8192
  buffer_load_dwordx4 v21, s[12:15], s51 offen offset:3072 nt lds
  v_mfma_f32_16x16x32_bf16 v[192:195], a[140:143], a[96:99], v[192:195]
  ds_read_b64_tr_b16 a[66:67], v66 offset:9216
  v_add_u32_e64 v23, s42, v22
  v_mfma_f32_16x16x32_bf16 v[136:139], a[128:131], a[100:103], v[136:139]
  ds_read_b64_tr_b16 a[68:69], v67 offset:8192
  v_mfma_f32_16x16x32_bf16 v[156:159], a[132:135], a[100:103], v[156:159]
  ds_read_b64_tr_b16 a[70:71], v67 offset:9216
  v_mfma_f32_16x16x32_bf16 v[176:179], a[136:139], a[100:103], v[176:179]
  v_mfma_f32_16x16x32_bf16 v[196:199], a[140:143], a[100:103], v[196:199]
  v_mfma_f32_16x16x32_bf16 v[140:143], a[128:131], a[104:107], v[140:143]
  v_mfma_f32_16x16x32_bf16 v[160:163], a[132:135], a[104:107], v[160:163]
  v_mfma_f32_16x16x32_bf16 v[180:183], a[136:139], a[104:107], v[180:183]
  v_mfma_f32_16x16x32_bf16 v[200:203], a[140:143], a[104:107], v[200:203]
  v_mfma_f32_16x16x32_bf16 v[144:147], a[128:131], a[108:111], v[144:147]
  v_mfma_f32_16x16x32_bf16 v[164:167], a[132:135], a[108:111], v[164:167]
  v_mfma_f32_16x16x32_bf16 v[184:187], a[136:139], a[108:111], v[184:187]
  v_mfma_f32_16x16x32_bf16 v[204:207], a[140:143], a[108:111], v[204:207]
  s_waitcnt vmcnt(4) lgkmcnt(0)
  s_barrier
  v_mfma_f32_16x16x32_bf16 v[128:131], a[40:43], a[0:3], v[128:131]
  s_nop 0
  s_add_u32 m0, s43, 32768
  s_lshl_b32 s38, s52, 12
  s_add_u32 s51, s49, 32768
  v_mfma_f32_16x16x32_bf16 v[148:151], a[44:47], a[0:3], v[148:151]
  ds_read_b128 a[144:147], v252 offset:0
  ds_read_b128 a[148:151], v253 offset:0
  s_add_u32 s38, s38, 67108864
  v_mfma_f32_16x16x32_bf16 v[168:171], a[48:51], a[0:3], v[168:171]
  ds_read_b128 a[152:155], v254 offset:0
  ds_read_b128 a[156:159], v255 offset:0
  s_and_b32 s51, s51, 0x3ffff
  v_mfma_f32_16x16x32_bf16 v[188:191], a[52:55], a[0:3], v[188:191]
  ds_read_b128 a[80:83], v4 offset:0
  ds_read_b128 a[96:99], v4 offset:4096
  s_mov_b32 s66, 4096
  v_mfma_f32_16x16x32_bf16 v[128:131], a[56:59], a[20:23], v[128:131]
  buffer_load_dwordx4 v16, s[8:11], s51 offen offset:0 nt lds
  ds_read_b128 a[84:87], v5 offset:0
  s_mov_b32 s67, 0x20000
  v_mfma_f32_16x16x32_bf16 v[148:151], a[60:63], a[20:23], v[148:151]
  ds_read_b128 a[100:103], v5 offset:4096
  ds_read_b128 a[88:91], v6 offset:0
  v_mfma_f32_16x16x32_bf16 v[168:171], a[64:67], a[20:23], v[168:171]
  ds_read_b128 a[104:107], v6 offset:4096
  ds_read_b128 a[92:95], v7 offset:0
  v_mfma_f32_16x16x32_bf16 v[188:191], a[68:71], a[20:23], v[188:191]
  ds_read_b128 a[108:111], v7 offset:4096
  s_add_u32 s64, s54, s38
  s_addc_u32 s65, s55, 0
  v_mfma_f32_16x16x32_bf16 v[132:135], a[40:43], a[4:7], v[132:135]
  ds_read_b128 a[112:115], v4 offset:16384
  ds_read_b128 a[128:131], v4 offset:20480
  v_mfma_f32_16x16x32_bf16 v[152:155], a[44:47], a[4:7], v[152:155]
  ds_read_b128 a[116:119], v5 offset:16384
  ds_read_b128 a[132:135], v5 offset:20480
  v_mfma_f32_16x16x32_bf16 v[172:175], a[48:51], a[4:7], v[172:175]
  v_mul_f32_e64 v128, s40, v128
  v_mul_f32_e64 v129, s40, v129
  v_mfma_f32_16x16x32_bf16 v[192:195], a[52:55], a[4:7], v[192:195]
  ds_read_b128 a[120:123], v6 offset:16384
  v_mul_f32_e64 v130, s40, v130
  v_mfma_f32_16x16x32_bf16 v[132:135], a[56:59], a[24:27], v[132:135]
  buffer_load_dwordx4 v17, s[8:11], s51 offen offset:1024 nt lds
  v_mul_f32_e64 v131, s40, v131
  v_mfma_f32_16x16x32_bf16 v[152:155], a[60:63], a[24:27], v[152:155]
  ds_read_b128 a[136:139], v6 offset:20480
  v_cvt_pk_bf16_f32 v224, v128, v129
  v_mfma_f32_16x16x32_bf16 v[172:175], a[64:67], a[24:27], v[172:175]
  ds_read_b128 a[124:127], v7 offset:16384
  v_cvt_pk_bf16_f32 v225, v130, v131
  v_mfma_f32_16x16x32_bf16 v[192:195], a[68:71], a[24:27], v[192:195]
  ds_write_b64 v3, v[224:225] offset:0
  v_mfma_f32_16x16x32_bf16 v[136:139], a[40:43], a[8:11], v[136:139]
  ds_read_b128 a[140:143], v7 offset:20480
  v_mul_f32_e64 v148, s40, v148
  v_mfma_f32_16x16x32_bf16 v[156:159], a[44:47], a[8:11], v[156:159]
  v_mul_f32_e64 v149, s40, v149
  v_mul_f32_e64 v150, s40, v150
  v_mfma_f32_16x16x32_bf16 v[176:179], a[48:51], a[8:11], v[176:179]
  v_mul_f32_e64 v151, s40, v151
  v_cvt_pk_bf16_f32 v226, v148, v149
  v_mfma_f32_16x16x32_bf16 v[196:199], a[52:55], a[8:11], v[196:199]
  buffer_load_dwordx4 v18, s[8:11], s51 offen offset:2048 nt lds
  v_cvt_pk_bf16_f32 v227, v150, v151
  v_mfma_f32_16x16x32_bf16 v[136:139], a[56:59], a[28:31], v[136:139]
  ds_write_b64 v3, v[226:227] offset:256
  v_mfma_f32_16x16x32_bf16 v[156:159], a[60:63], a[28:31], v[156:159]
  v_mul_f32_e64 v168, s40, v168
  v_mul_f32_e64 v169, s40, v169
  v_mfma_f32_16x16x32_bf16 v[176:179], a[64:67], a[28:31], v[176:179]
  v_mul_f32_e64 v170, s40, v170
  v_mul_f32_e64 v171, s40, v171
  v_mfma_f32_16x16x32_bf16 v[196:199], a[68:71], a[28:31], v[196:199]
  v_cvt_pk_bf16_f32 v228, v168, v169
  v_cvt_pk_bf16_f32 v229, v170, v171
  v_mfma_f32_16x16x32_bf16 v[140:143], a[40:43], a[12:15], v[140:143]
  ds_write_b64 v3, v[228:229] offset:512
  v_mfma_f32_16x16x32_bf16 v[160:163], a[44:47], a[12:15], v[160:163]
  v_mul_f32_e64 v188, s40, v188
  v_mul_f32_e64 v189, s40, v189
  v_mfma_f32_16x16x32_bf16 v[180:183], a[48:51], a[12:15], v[180:183]
  v_mul_f32_e64 v190, s40, v190
  v_mul_f32_e64 v191, s40, v191
  v_mfma_f32_16x16x32_bf16 v[200:203], a[52:55], a[12:15], v[200:203]
  v_cvt_pk_bf16_f32 v230, v188, v189
  v_cvt_pk_bf16_f32 v231, v190, v191
  v_mfma_f32_16x16x32_bf16 v[140:143], a[56:59], a[32:35], v[140:143]
  ds_write_b64 v3, v[230:231] offset:768
  v_mul_f32_e64 v132, s40, v132
  v_mfma_f32_16x16x32_bf16 v[160:163], a[60:63], a[32:35], v[160:163]
  v_mul_f32_e64 v133, s40, v133
  v_mul_f32_e64 v134, s40, v134
  v_mfma_f32_16x16x32_bf16 v[180:183], a[64:67], a[32:35], v[180:183]
  v_mul_f32_e64 v135, s40, v135
  v_cvt_pk_bf16_f32 v232, v132, v133
  v_mfma_f32_16x16x32_bf16 v[200:203], a[68:71], a[32:35], v[200:203]
  buffer_load_dwordx4 v19, s[8:11], s51 offen offset:3072 nt lds
  v_cvt_pk_bf16_f32 v233, v134, v135
  v_mfma_f32_16x16x32_bf16 v[144:147], a[40:43], a[16:19], v[144:147]
  ds_write_b64 v3, v[232:233] offset:1024
  v_mul_f32_e64 v152, s40, v152
  v_mfma_f32_16x16x32_bf16 v[164:167], a[44:47], a[16:19], v[164:167]
  v_mul_f32_e64 v153, s40, v153
  v_mul_f32_e64 v154, s40, v154
  v_mfma_f32_16x16x32_bf16 v[184:187], a[48:51], a[16:19], v[184:187]
  v_mul_f32_e64 v155, s40, v155
  v_cvt_pk_bf16_f32 v234, v152, v153
  v_mfma_f32_16x16x32_bf16 v[204:207], a[52:55], a[16:19], v[204:207]
  v_cvt_pk_bf16_f32 v235, v154, v155
  v_mfma_f32_16x16x32_bf16 v[144:147], a[56:59], a[36:39], v[144:147]
  ds_write_b64 v3, v[234:235] offset:1280
  v_mul_f32_e64 v172, s40, v172
  v_mfma_f32_16x16x32_bf16 v[164:167], a[60:63], a[36:39], v[164:167]
  v_mul_f32_e64 v173, s40, v173
  v_mul_f32_e64 v174, s40, v174
  v_mfma_f32_16x16x32_bf16 v[184:187], a[64:67], a[36:39], v[184:187]
  v_mul_f32_e64 v175, s40, v175
  v_cvt_pk_bf16_f32 v236, v172, v173
  v_mfma_f32_16x16x32_bf16 v[204:207], a[68:71], a[36:39], v[204:207]
  v_cvt_pk_bf16_f32 v237, v174, v175
  ds_write_b64 v3, v[236:237] offset:1536
  v_mul_f32_e64 v192, s40, v192
  v_mul_f32_e64 v193, s40, v193
  v_mul_f32_e64 v194, s40, v194
  v_mul_f32_e64 v195, s40, v195
  v_cvt_pk_bf16_f32 v238, v192, v193
  v_cvt_pk_bf16_f32 v239, v194, v195
  ds_write_b64 v3, v[238:239] offset:1792
  v_pk_mul_f32 v[136:137], v[136:137], s[40:41]
  v_pk_mul_f32 v[138:139], v[138:139], s[40:41]
  v_cvt_pk_bf16_f32 v224, v136, v137
  v_cvt_pk_bf16_f32 v225, v138, v139
  ds_write_b64 v3, v[224:225] offset:2048
  v_pk_mul_f32 v[156:157], v[156:157], s[40:41]
  v_pk_mul_f32 v[158:159], v[158:159], s[40:41]
  v_cvt_pk_bf16_f32 v226, v156, v157
  v_cvt_pk_bf16_f32 v227, v158, v159
  ds_write_b64 v3, v[226:227] offset:2304
  v_pk_mul_f32 v[176:177], v[176:177], s[40:41]
  v_pk_mul_f32 v[178:179], v[178:179], s[40:41]
  v_cvt_pk_bf16_f32 v228, v176, v177
  v_cvt_pk_bf16_f32 v229, v178, v179
  ds_write_b64 v3, v[228:229] offset:2560
  v_pk_mul_f32 v[196:197], v[196:197], s[40:41]
  v_pk_mul_f32 v[198:199], v[198:199], s[40:41]
  v_cvt_pk_bf16_f32 v230, v196, v197
  v_cvt_pk_bf16_f32 v231, v198, v199
  ds_write_b64 v3, v[230:231] offset:2816
  v_pk_mul_f32 v[140:141], v[140:141], s[40:41]
  v_pk_mul_f32 v[142:143], v[142:143], s[40:41]
  v_cvt_pk_bf16_f32 v232, v140, v141
  v_cvt_pk_bf16_f32 v233, v142, v143
  ds_write_b64 v3, v[232:233] offset:3072
  v_pk_mul_f32 v[160:161], v[160:161], s[40:41]
  v_pk_mul_f32 v[162:163], v[162:163], s[40:41]
  v_cvt_pk_bf16_f32 v234, v160, v161
  v_cvt_pk_bf16_f32 v235, v162, v163
  ds_write_b64 v3, v[234:235] offset:3328
  v_pk_mul_f32 v[180:181], v[180:181], s[40:41]
  v_pk_mul_f32 v[182:183], v[182:183], s[40:41]
  v_cvt_pk_bf16_f32 v236, v180, v181
  v_cvt_pk_bf16_f32 v237, v182, v183
  ds_write_b64 v3, v[236:237] offset:3584
  v_pk_mul_f32 v[200:201], v[200:201], s[40:41]
  v_pk_mul_f32 v[202:203], v[202:203], s[40:41]
  v_cvt_pk_bf16_f32 v238, v200, v201
  v_cvt_pk_bf16_f32 v239, v202, v203
  ds_write_b64 v3, v[238:239] offset:3840
  v_pk_mul_f32 v[144:145], v[144:145], s[40:41]
  v_pk_mul_f32 v[146:147], v[146:147], s[40:41]
  v_cvt_pk_bf16_f32 v224, v144, v145
  v_cvt_pk_bf16_f32 v225, v146, v147
  ds_write_b64 v3, v[224:225] offset:4096
  v_pk_mul_f32 v[164:165], v[164:165], s[40:41]
  v_pk_mul_f32 v[166:167], v[166:167], s[40:41]
  v_cvt_pk_bf16_f32 v226, v164, v165
  v_cvt_pk_bf16_f32 v227, v166, v167
  ds_write_b64 v3, v[226:227] offset:4352
  v_pk_mul_f32 v[184:185], v[184:185], s[40:41]
  v_pk_mul_f32 v[186:187], v[186:187], s[40:41]
  v_cvt_pk_bf16_f32 v228, v184, v185
  v_cvt_pk_bf16_f32 v229, v186, v187
  ds_write_b64 v3, v[228:229] offset:4608
  v_pk_mul_f32 v[204:205], v[204:205], s[40:41]
  v_pk_mul_f32 v[206:207], v[206:207], s[40:41]
  v_cvt_pk_bf16_f32 v230, v204, v205
  v_cvt_pk_bf16_f32 v231, v206, v207
  ds_write_b64 v3, v[230:231] offset:4864
  s_add_u32 m0, s43, 122880
  s_add_u32 s51, s49, 16384
  s_and_b32 s51, s51, 0x3ffff
  buffer_load_dwordx4 v20, s[12:15], s51 offen offset:0 nt lds
  buffer_load_dwordx4 v21, s[12:15], s51 offen offset:1024 nt lds
  buffer_load_dwordx4 v20, s[12:15], s51 offen offset:2048 nt lds
  buffer_load_dwordx4 v21, s[12:15], s51 offen offset:3072 nt lds
  s_waitcnt lgkmcnt(0)
  s_barrier
  ds_read_b128 a[0:3], v23 offset:0
  ds_read_b128 a[20:23], v23 offset:5120
  ds_read_b128 a[40:43], v23 offset:10240
  ds_read_b128 a[60:63], v23 offset:15360
  ds_read_b128 a[4:7], v23 offset:1024
  ds_read_b128 a[24:27], v23 offset:6144
  ds_read_b128 a[44:47], v23 offset:11264
  ds_read_b128 a[64:67], v23 offset:16384
  ds_read_b128 a[8:11], v23 offset:2048
  ds_read_b128 a[28:31], v23 offset:7168
  ds_read_b128 a[48:51], v23 offset:12288
  ds_read_b128 a[68:71], v23 offset:17408
  s_waitcnt lgkmcnt(11)
  s_nop 0
  v_mfma_f32_16x16x32_bf16 v[52:55], a[144:147], a[0:3], 0
  s_nop 0
  ds_read_b128 a[12:15], v23 offset:3072
  ds_read_b128 a[32:35], v23 offset:8192
  s_waitcnt lgkmcnt(12)
  v_mfma_f32_16x16x32_bf16 v[52:55], a[148:151], a[20:23], v[52:55]
  s_nop 0
  ds_read_b128 a[52:55], v23 offset:13312
  ds_read_b128 a[72:75], v23 offset:18432
  s_waitcnt lgkmcnt(13)
  v_mfma_f32_16x16x32_bf16 v[52:55], a[152:155], a[40:43], v[52:55]
  s_nop 0
  ds_read_b128 a[16:19], v23 offset:4096
  ds_read_b128 a[36:39], v23 offset:9216
  s_waitcnt lgkmcnt(14)
  v_mfma_f32_16x16x32_bf16 v[52:55], a[156:159], a[60:63], v[52:55]
  s_nop 0
  ds_read_b128 a[56:59], v23 offset:14336
  ds_read_b128 a[76:79], v23 offset:19456
  s_waitcnt lgkmcnt(15)
  v_mfma_f32_16x16x32_bf16 v[60:63], a[144:147], a[4:7], 0
  s_nop 0
  s_waitcnt lgkmcnt(14)
  v_mfma_f32_16x16x32_bf16 v[60:63], a[148:151], a[24:27], v[60:63]
  s_nop 0
  s_waitcnt lgkmcnt(13)
  v_mfma_f32_16x16x32_bf16 v[60:63], a[152:155], a[44:47], v[60:63]
  s_nop 0
  s_waitcnt lgkmcnt(12)
  v_mfma_f32_16x16x32_bf16 v[60:63], a[156:159], a[64:67], v[60:63]
  s_nop 0
  v_min3_f32 v224, -v52, -v53, -v54
  v_min_f32_e64 v28, v224, -v55
  s_waitcnt lgkmcnt(11)
  v_mfma_f32_16x16x32_bf16 v[68:71], a[144:147], a[8:11], 0
  s_nop 0
  v_min_f32_e64 v29, v224, -v55
  v_min_f32_e64 v30, v224, -v55
  s_waitcnt lgkmcnt(10)
  v_mfma_f32_16x16x32_bf16 v[68:71], a[148:151], a[28:31], v[68:71]
  s_nop 0
  v_min_f32_e64 v31, v224, -v55
  s_waitcnt lgkmcnt(9)
  v_mfma_f32_16x16x32_bf16 v[68:71], a[152:155], a[48:51], v[68:71]
  s_nop 0
  s_waitcnt lgkmcnt(8)
  v_mfma_f32_16x16x32_bf16 v[68:71], a[156:159], a[68:71], v[68:71]
  s_nop 0
  v_min3_f32 v225, -v60, -v61, -v62
  v_min_f32_e64 v32, v225, -v63
  s_waitcnt lgkmcnt(7)
  v_mfma_f32_16x16x32_bf16 v[76:79], a[144:147], a[12:15], 0
  s_nop 0
  v_min_f32_e64 v33, v225, -v63
  v_min_f32_e64 v34, v225, -v63
  s_waitcnt lgkmcnt(6)
  v_mfma_f32_16x16x32_bf16 v[76:79], a[148:151], a[32:35], v[76:79]
  s_nop 0
  v_min_f32_e64 v35, v225, -v63
  s_waitcnt lgkmcnt(5)
  v_mfma_f32_16x16x32_bf16 v[76:79], a[152:155], a[52:55], v[76:79]
  s_nop 0
  s_waitcnt lgkmcnt(4)
  v_mfma_f32_16x16x32_bf16 v[76:79], a[156:159], a[72:75], v[76:79]
  s_nop 0
  v_min3_f32 v226, -v68, -v69, -v70
  v_min_f32_e64 v36, v226, -v71
  s_waitcnt lgkmcnt(3)
  v_mfma_f32_16x16x32_bf16 v[84:87], a[144:147], a[16:19], 0
  s_nop 0
  v_min_f32_e64 v37, v226, -v71
  v_min_f32_e64 v38, v226, -v71
  s_waitcnt lgkmcnt(2)
  v_mfma_f32_16x16x32_bf16 v[84:87], a[148:151], a[36:39], v[84:87]
  s_nop 0
  v_min_f32_e64 v39, v226, -v71
  s_waitcnt lgkmcnt(1)
  v_mfma_f32_16x16x32_bf16 v[84:87], a[152:155], a[56:59], v[84:87]
  s_nop 0
  s_waitcnt lgkmcnt(0)
  v_mfma_f32_16x16x32_bf16 v[84:87], a[156:159], a[76:79], v[84:87]
  v_min3_f32 v227, -v76, -v77, -v78
  v_min_f32_e64 v40, v227, -v79
  v_min_f32_e64 v41, v227, -v79
  v_min_f32_e64 v42, v227, -v79
  v_min_f32_e64 v43, v227, -v79
  s_nop 2
  v_min3_f32 v228, -v84, -v85, -v86
  v_min_f32_e64 v44, v228, -v87
  v_min_f32_e64 v45, v228, -v87
  v_min_f32_e64 v46, v228, -v87
  v_min_f32_e64 v47, v228, -v87
L_att:
  s_nop 0
  v_mfma_f32_16x16x32_bf16 v[48:51], a[80:83], a[0:3], v[28:31]
  s_add_u32 m0, s43, 49152
  s_add_u32 s51, s49, 49152
  s_and_b32 s51, s51, 0x3ffff
  v_mfma_f32_16x16x32_bf16 v[52:55], a[96:99], a[0:3], v[28:31]
  buffer_load_dwordx4 v16, s[8:11], s51 offen offset:0 nt lds
  v_mfma_f32_16x16x32_bf16 v[48:51], a[84:87], a[20:23], v[48:51]
  buffer_load_dwordx4 v17, s[8:11], s51 offen offset:1024 nt lds
  v_mfma_f32_16x16x32_bf16 v[52:55], a[100:103], a[20:23], v[52:55]
  v_mfma_f32_16x16x32_bf16 v[48:51], a[88:91], a[40:43], v[48:51]
  buffer_load_dwordx4 v18, s[8:11], s51 offen offset:2048 nt lds
  v_mfma_f32_16x16x32_bf16 v[52:55], a[104:107], a[40:43], v[52:55]
  v_mfma_f32_16x16x32_bf16 v[48:51], a[92:95], a[60:63], v[48:51]
  buffer_load_dwordx4 v19, s[8:11], s51 offen offset:3072 nt lds
  v_mfma_f32_16x16x32_bf16 v[52:55], a[108:111], a[60:63], v[52:55]
  v_mfma_f32_16x16x32_bf16 v[56:59], a[80:83], a[4:7], v[32:35]
  v_mfma_f32_16x16x32_bf16 v[60:63], a[96:99], a[4:7], v[32:35]
  v_mfma_f32_16x16x32_bf16 v[56:59], a[84:87], a[24:27], v[56:59]
  s_nop 0
  s_nop 2
  v_exp_f32_e64 v48, v48
  v_mfma_f32_16x16x32_bf16 v[60:63], a[100:103], a[24:27], v[60:63]
  v_exp_f32_e64 v49, v49
  v_mfma_f32_16x16x32_bf16 v[56:59], a[88:91], a[44:47], v[56:59]
  v_exp_f32_e64 v50, v50
  v_mfma_f32_16x16x32_bf16 v[60:63], a[104:107], a[44:47], v[60:63]
  v_cvt_pk_bf16_f32 v88, v48, v49
  v_mfma_f32_16x16x32_bf16 v[56:59], a[92:95], a[64:67], v[56:59]
  v_exp_f32_e64 v51, v51
  v_mfma_f32_16x16x32_bf16 v[60:63], a[108:111], a[64:67], v[60:63]
  v_exp_f32_e64 v52, v52
  v_mfma_f32_16x16x32_bf16 v[64:67], a[80:83], a[8:11], v[36:39]
  v_cvt_pk_bf16_f32 v89, v50, v51
  v_mfma_f32_16x16x32_bf16 v[68:71], a[96:99], a[8:11], v[36:39]
  v_exp_f32_e64 v53, v53
  v_mfma_f32_16x16x32_bf16 v[64:67], a[84:87], a[28:31], v[64:67]
  v_exp_f32_e64 v54, v54
  v_mfma_f32_16x16x32_bf16 v[68:71], a[100:103], a[28:31], v[68:71]
  v_cvt_pk_bf16_f32 v90, v52, v53
  v_mfma_f32_16x16x32_bf16 v[64:67], a[88:91], a[48:51], v[64:67]
  v_exp_f32_e64 v55, v55
  v_mfma_f32_16x16x32_bf16 v[68:71], a[104:107], a[48:51], v[68:71]
  v_cvt_pk_bf16_f32 v91, v54, v55
  v_mfma_f32_16x16x32_bf16 v[64:67], a[92:95], a[68:71], v[64:67]
  ds_write_b128 v208, v[88:91] offset:57344
  v_mfma_f32_16x16x32_bf16 v[68:71], a[108:111], a[68:71], v[68:71]
  v_exp_f32_e64 v56, v56
  v_mfma_f32_16x16x32_bf16 v[72:75], a[80:83], a[12:15], v[40:43]
  v_exp_f32_e64 v57, v57
  v_mfma_f32_16x16x32_bf16 v[76:79], a[96:99], a[12:15], v[40:43]
  v_exp_f32_e64 v58, v58
  v_mfma_f32_16x16x32_bf16 v[72:75], a[84:87], a[32:35], v[72:75]
  v_cvt_pk_bf16_f32 v92, v56, v57
  v_mfma_f32_16x16x32_bf16 v[76:79], a[100:103], a[32:35], v[76:79]
  v_exp_f32_e64 v59, v59
  v_exp_f32_e64 v60, v60
  v_mfma_f32_16x16x32_bf16 v[72:75], a[88:91], a[52:55], v[72:75]
  v_cvt_pk_bf16_f32 v93, v58, v59
  v_mfma_f32_16x16x32_bf16 v[76:79], a[104:107], a[52:55], v[76:79]
  v_exp_f32_e64 v61, v61
  v_mfma_f32_16x16x32_bf16 v[72:75], a[92:95], a[72:75], v[72:75]
  v_exp_f32_e64 v62, v62
  v_cvt_pk_bf16_f32 v94, v60, v61
  v_mfma_f32_16x16x32_bf16 v[76:79], a[108:111], a[72:75], v[76:79]
  s_nop 0
  s_add_u32 m0, s43, 0x0
  v_exp_f32_e64 v63, v63
  v_mfma_f32_16x16x32_bf16 v[80:83], a[80:83], a[16:19], v[44:47]
  s_add_u32 s51, s49, 65536
  s_and_b32 s51, s51, 0x3ffff
  v_cvt_pk_bf16_f32 v95, v62, v63
  v_mfma_f32_16x16x32_bf16 v[84:87], a[96:99], a[16:19], v[44:47]
  ds_write_b128 v208, v[92:95] offset:58368
  v_exp_f32_e64 v64, v64
  v_mfma_f32_16x16x32_bf16 v[80:83], a[84:87], a[36:39], v[80:83]
  v_exp_f32_e64 v65, v65
  v_mfma_f32_16x16x32_bf16 v[84:87], a[100:103], a[36:39], v[84:87]
  v_exp_f32_e64 v66, v66
  v_mfma_f32_16x16x32_bf16 v[80:83], a[88:91], a[56:59], v[80:83]
  buffer_load_dwordx4 v16, s[8:11], s51 offen offset:0 nt lds
  v_cvt_pk_bf16_f32 v96, v64, v65
  v_mfma_f32_16x16x32_bf16 v[84:87], a[104:107], a[56:59], v[84:87]
  v_exp_f32_e64 v67, v67
  v_mfma_f32_16x16x32_bf16 v[80:83], a[92:95], a[76:79], v[80:83]
  v_exp_f32_e64 v68, v68
  v_mfma_f32_16x16x32_bf16 v[84:87], a[108:111], a[76:79], v[84:87]
  v_cvt_pk_bf16_f32 v97, v66, v67
  v_exp_f32_e64 v69, v69
  v_mfma_f32_16x16x32_bf16 v[48:51], a[112:115], a[0:3], v[28:31]
  v_exp_f32_e64 v70, v70
  v_mfma_f32_16x16x32_bf16 v[52:55], a[128:131], a[0:3], v[28:31]
  buffer_load_dwordx4 v17, s[8:11], s51 offen offset:1024 nt lds
  v_cvt_pk_bf16_f32 v98, v68, v69
  v_mfma_f32_16x16x32_bf16 v[48:51], a[116:119], a[20:23], v[48:51]
  v_exp_f32_e64 v71, v71
  v_mfma_f32_16x16x32_bf16 v[52:55], a[132:135], a[20:23], v[52:55]
  v_cvt_pk_bf16_f32 v99, v70, v71
  v_mfma_f32_16x16x32_bf16 v[48:51], a[120:123], a[40:43], v[48:51]
  ds_write_b128 v208, v[96:99] offset:59392
  v_exp_f32_e64 v72, v72
  v_mfma_f32_16x16x32_bf16 v[52:55], a[136:139], a[40:43], v[52:55]
  v_exp_f32_e64 v73, v73
  v_mfma_f32_16x16x32_bf16 v[48:51], a[124:127], a[60:63], v[48:51]
  v_exp_f32_e64 v74, v74
  v_mfma_f32_16x16x32_bf16 v[52:55], a[140:143], a[60:63], v[52:55]
  buffer_load_dwordx4 v18, s[8:11], s51 offen offset:2048 nt lds
  v_cvt_pk_bf16_f32 v100, v72, v73
  v_mfma_f32_16x16x32_bf16 v[56:59], a[112:115], a[4:7], v[32:35]
  v_exp_f32_e64 v75, v75
  v_exp_f32_e64 v76, v76
  v_mfma_f32_16x16x32_bf16 v[60:63], a[128:131], a[4:7], v[32:35]
  v_cvt_pk_bf16_f32 v101, v74, v75
  v_mfma_f32_16x16x32_bf16 v[56:59], a[116:119], a[24:27], v[56:59]
  v_exp_f32_e64 v77, v77
  v_mfma_f32_16x16x32_bf16 v[60:63], a[132:135], a[24:27], v[60:63]
  v_exp_f32_e64 v78, v78
  v_cvt_pk_bf16_f32 v102, v76, v77
  v_mfma_f32_16x16x32_bf16 v[56:59], a[120:123], a[44:47], v[56:59]
  v_exp_f32_e64 v79, v79
  v_mfma_f32_16x16x32_bf16 v[60:63], a[136:139], a[44:47], v[60:63]
  buffer_load_dwordx4 v19, s[8:11], s51 offen offset:3072 nt lds
  v_cvt_pk_bf16_f32 v103, v78, v79
  v_mfma_f32_16x16x32_bf16 v[56:59], a[124:127], a[64:67], v[56:59]
  ds_write_b128 v208, v[100:103] offset:60416
  v_exp_f32_e64 v80, v80
  v_mfma_f32_16x16x32_bf16 v[60:63], a[140:143], a[64:67], v[60:63]
  v_exp_f32_e64 v81, v81
  v_mfma_f32_16x16x32_bf16 v[64:67], a[112:115], a[8:11], v[36:39]
  v_exp_f32_e64 v82, v82
  v_mfma_f32_16x16x32_bf16 v[68:71], a[128:131], a[8:11], v[36:39]
  v_cvt_pk_bf16_f32 v104, v80, v81
  v_mfma_f32_16x16x32_bf16 v[64:67], a[116:119], a[28:31], v[64:67]
  v_exp_f32_e64 v83, v83
  v_exp_f32_e64 v84, v84
  v_mfma_f32_16x16x32_bf16 v[68:71], a[132:135], a[28:31], v[68:71]
  v_cvt_pk_bf16_f32 v105, v82, v83
  v_mfma_f32_16x16x32_bf16 v[64:67], a[120:123], a[48:51], v[64:67]
  v_exp_f32_e64 v85, v85
  v_mfma_f32_16x16x32_bf16 v[68:71], a[136:139], a[48:51], v[68:71]
  v_exp_f32_e64 v86, v86
  v_cvt_pk_bf16_f32 v106, v84, v85
  v_mfma_f32_16x16x32_bf16 v[64:67], a[124:127], a[68:71], v[64:67]
  v_exp_f32_e64 v87, v87
  v_mfma_f32_16x16x32_bf16 v[68:71], a[140:143], a[68:71], v[68:71]
  v_cvt_pk_bf16_f32 v107, v86, v87
  ds_write_b128 v208, v[104:107] offset:61440
  s_bitcmp1_b32 s36, 0
  s_cselect_b64 vcc, -1, 0
  s_mov_b32 s16, s36
  s_lshl_b32 s16, s16, 7
  s_waitcnt vmcnt(12) lgkmcnt(0)
  s_barrier
  v_mfma_f32_16x16x32_bf16 v[72:75], a[112:115], a[12:15], v[40:43]
  ds_read_b64_tr_b16 a[144:145], v8 offset:0
  s_add_u32 m0, s43, 106496
  s_add_u32 s51, s49, 32768
  v_mfma_f32_16x16x32_bf16 v[76:79], a[128:131], a[12:15], v[40:43]
  ds_read_b64_tr_b16 a[146:147], v8 offset:4096
  ds_read_b64_tr_b16 a[148:149], v9 offset:0
  s_and_b32 s51, s51, 0x3ffff
  v_mfma_f32_16x16x32_bf16 v[72:75], a[116:119], a[32:35], v[72:75]
  ds_read_b64_tr_b16 a[150:151], v9 offset:4096
  ds_read_b64_tr_b16 a[152:153], v10 offset:0
  v_mfma_f32_16x16x32_bf16 v[76:79], a[132:135], a[32:35], v[76:79]
  ds_read_b64_tr_b16 a[154:155], v10 offset:4096
  ds_read_b64_tr_b16 a[156:157], v11 offset:0
  v_mfma_f32_16x16x32_bf16 v[72:75], a[120:123], a[52:55], v[72:75]
  ds_read_b64_tr_b16 a[158:159], v11 offset:4096
  buffer_load_dwordx4 v20, s[12:15], s51 offen offset:0 nt lds
  v_mfma_f32_16x16x32_bf16 v[76:79], a[136:139], a[52:55], v[76:79]
  ds_read_b128 a[176:179], v209 offset:57344
  ds_read_b64_tr_b16 a[160:161], v12 offset:0
  v_mfma_f32_16x16x32_bf16 v[72:75], a[124:127], a[72:75], v[72:75]
  ds_read_b64_tr_b16 a[162:163], v12 offset:4096
  ds_read_b64_tr_b16 a[164:165], v13 offset:0
  v_mfma_f32_16x16x32_bf16 v[76:79], a[140:143], a[72:75], v[76:79]
  ds_read_b64_tr_b16 a[166:167], v13 offset:4096
  ds_read_b64_tr_b16 a[168:169], v14 offset:0
  v_mfma_f32_16x16x32_bf16 v[80:83], a[112:115], a[16:19], v[44:47]
  ds_read_b64_tr_b16 a[170:171], v14 offset:4096
  ds_read_b64_tr_b16 a[172:173], v15 offset:0
  v_mfma_f32_16x16x32_bf16 v[84:87], a[128:131], a[16:19], v[44:47]
  v_exp_f32_e64 v48, v48
  v_mfma_f32_16x16x32_bf16 v[80:83], a[116:119], a[36:39], v[80:83]
  ds_read_b64_tr_b16 a[174:175], v15 offset:4096
  ds_read_b128 a[180:183], v209 offset:58368
  v_mfma_f32_16x16x32_bf16 v[84:87], a[132:135], a[36:39], v[84:87]
  v_exp_f32_e64 v49, v49
  v_mfma_f32_16x16x32_bf16 v[80:83], a[120:123], a[56:59], v[80:83]
  v_exp_f32_e64 v50, v50
  v_mfma_f32_16x16x32_bf16 v[84:87], a[136:139], a[56:59], v[84:87]
  ds_read_b128 a[184:187], v209 offset:59392
  ds_read_b128 a[188:191], v209 offset:60416
  v_mfma_f32_16x16x32_bf16 v[80:83], a[124:127], a[76:79], v[80:83]
  ds_read_b128 a[192:195], v209 offset:61440
  v_cvt_pk_bf16_f32 v108, v48, v49
  v_exp_f32_e64 v51, v51
  v_mfma_f32_16x16x32_bf16 v[84:87], a[140:143], a[76:79], v[84:87]
  v_exp_f32_e64 v52, v52
  v_mfma_f32_16x16x32_bf16 a[196:199], a[216:219], v[88:91], 0
  s_nop 0
  v_cvt_pk_bf16_f32 v109, v50, v51
  v_exp_f32_e64 v53, v53
  s_waitcnt lgkmcnt(15)
  v_mfma_f32_16x16x32_bf16 v[128:131], a[144:147], v[88:91], 0
  buffer_load_dwordx4 v21, s[12:15], s51 offen offset:1024 nt lds
  s_waitcnt lgkmcnt(0)
  s_nop 0
  v_exp_f32_e64 v54, v54
  v_mfma_f32_16x16x32_bf16 v[148:151], a[148:151], v[88:91], 0
  v_cvt_pk_bf16_f32 v110, v52, v53
  v_exp_f32_e64 v55, v55
  v_mfma_f32_16x16x32_bf16 v[168:171], a[152:155], v[88:91], 0
  ds_read_b128 a[80:83], v4 offset:32768
  v_cvt_pk_bf16_f32 v111, v54, v55
  v_mfma_f32_16x16x32_bf16 v[188:191], a[156:159], v[88:91], 0
  ds_write_b128 v208, v[108:111] offset:0
  v_exp_f32_e64 v56, v56
  v_mfma_f32_16x16x32_bf16 v[128:131], a[160:163], a[176:179], v[128:131]
  v_exp_f32_e64 v57, v57
  v_mfma_f32_16x16x32_bf16 v[148:151], a[164:167], a[176:179], v[148:151]
  v_exp_f32_e64 v58, v58
  v_mfma_f32_16x16x32_bf16 v[168:171], a[168:171], a[176:179], v[168:171]
  v_cvt_pk_bf16_f32 v112, v56, v57
  v_exp_f32_e64 v59, v59
  v_mfma_f32_16x16x32_bf16 v[188:191], a[172:175], a[176:179], v[188:191]
  ds_read_b128 a[96:99], v4 offset:36864
  v_exp_f32_e64 v60, v60
  v_mfma_f32_16x16x32_bf16 a[200:203], a[216:219], v[92:95], 0
  v_cvt_pk_bf16_f32 v113, v58, v59
  v_exp_f32_e64 v61, v61
  v_mfma_f32_16x16x32_bf16 v[132:135], a[144:147], v[92:95], 0
  buffer_load_dwordx4 v20, s[12:15], s51 offen offset:2048 nt lds
  v_exp_f32_e64 v62, v62
  v_mfma_f32_16x16x32_bf16 v[152:155], a[148:151], v[92:95], 0
  v_cvt_pk_bf16_f32 v114, v60, v61
  v_exp_f32_e64 v63, v63
  v_mfma_f32_16x16x32_bf16 v[172:175], a[152:155], v[92:95], 0
  ds_read_b128 a[84:87], v5 offset:32768
  v_cvt_pk_bf16_f32 v115, v62, v63
  v_mfma_f32_16x16x32_bf16 v[192:195], a[156:159], v[92:95], 0
  ds_write_b128 v208, v[112:115] offset:1024
  v_exp_f32_e64 v64, v64
  v_mfma_f32_16x16x32_bf16 v[132:135], a[160:163], a[180:183], v[132:135]
  v_exp_f32_e64 v65, v65
  v_mfma_f32_16x16x32_bf16 v[152:155], a[164:167], a[180:183], v[152:155]
  v_exp_f32_e64 v66, v66
  v_mfma_f32_16x16x32_bf16 v[172:175], a[168:171], a[180:183], v[172:175]
  ds_read_b128 a[100:103], v5 offset:36864
  v_cvt_pk_bf16_f32 v116, v64, v65
  v_mfma_f32_16x16x32_bf16 v[192:195], a[172:175], a[180:183], v[192:195]
  v_exp_f32_e64 v67, v67
  v_exp_f32_e64 v68, v68
  v_mfma_f32_16x16x32_bf16 a[204:207], a[216:219], v[96:99], 0
  buffer_load_dwordx4 v21, s[12:15], s51 offen offset:3072 nt lds
  v_cvt_pk_bf16_f32 v117, v66, v67
  v_mfma_f32_16x16x32_bf16 v[136:139], a[144:147], v[96:99], 0
  ds_read_b128 a[88:91], v6 offset:32768
  v_exp_f32_e64 v69, v69
  v_mfma_f32_16x16x32_bf16 v[156:159], a[148:151], v[96:99], 0
  v_exp_f32_e64 v70, v70
  v_cvt_pk_bf16_f32 v118, v68, v69
  v_mfma_f32_16x16x32_bf16 v[176:179], a[152:155], v[96:99], 0
  v_exp_f32_e64 v71, v71
  v_mfma_f32_16x16x32_bf16 v[196:199], a[156:159], v[96:99], 0
  ds_read_b128 a[104:107], v6 offset:36864
  v_cvt_pk_bf16_f32 v119, v70, v71
  v_mfma_f32_16x16x32_bf16 v[136:139], a[160:163], a[184:187], v[136:139]
  ds_write_b128 v208, v[116:119] offset:2048
  v_exp_f32_e64 v72, v72
  v_mfma_f32_16x16x32_bf16 v[156:159], a[164:167], a[184:187], v[156:159]
  v_exp_f32_e64 v73, v73
  v_mfma_f32_16x16x32_bf16 v[176:179], a[168:171], a[184:187], v[176:179]
  v_exp_f32_e64 v74, v74
  v_mfma_f32_16x16x32_bf16 v[196:199], a[172:175], a[184:187], v[196:199]
  v_cvt_pk_bf16_f32 v120, v72, v73
  v_exp_f32_e64 v75, v75
  v_mfma_f32_16x16x32_bf16 a[208:211], a[216:219], v[100:103], 0
  ds_read_b128 a[92:95], v7 offset:32768
  v_exp_f32_e64 v76, v76
  v_mfma_f32_16x16x32_bf16 v[140:143], a[144:147], v[100:103], 0
  v_cvt_pk_bf16_f32 v121, v74, v75
  v_exp_f32_e64 v77, v77
  v_mfma_f32_16x16x32_bf16 v[160:163], a[148:151], v[100:103], 0
  v_exp_f32_e64 v78, v78
  v_mfma_f32_16x16x32_bf16 v[180:183], a[152:155], v[100:103], 0
  v_cvt_pk_bf16_f32 v122, v76, v77
  v_exp_f32_e64 v79, v79
  v_mfma_f32_16x16x32_bf16 v[200:203], a[156:159], v[100:103], 0
  ds_read_b128 a[108:111], v7 offset:36864
  v_cvt_pk_bf16_f32 v123, v78, v79
  v_mfma_f32_16x16x32_bf16 v[140:143], a[160:163], a[188:191], v[140:143]
  ds_write_b128 v208, v[120:123] offset:3072
  v_exp_f32_e64 v80, v80
  v_mfma_f32_16x16x32_bf16 v[160:163], a[164:167], a[188:191], v[160:163]
  v_exp_f32_e64 v81, v81
  v_mfma_f32_16x16x32_bf16 v[180:183], a[168:171], a[188:191], v[180:183]
  v_exp_f32_e64 v82, v82
  v_mfma_f32_16x16x32_bf16 v[200:203], a[172:175], a[188:191], v[200:203]
  v_cvt_pk_bf16_f32 v124, v80, v81
  v_mfma_f32_16x16x32_bf16 a[212:215], a[216:219], v[104:107], 0
  v_exp_f32_e64 v83, v83
  v_exp_f32_e64 v84, v84
  v_mfma_f32_16x16x32_bf16 v[144:147], a[144:147], v[104:107], 0
  v_cvt_pk_bf16_f32 v125, v82, v83
  v_mfma_f32_16x16x32_bf16 v[164:167], a[148:151], v[104:107], 0
  v_exp_f32_e64 v85, v85
  v_mfma_f32_16x16x32_bf16 v[184:187], a[152:155], v[104:107], 0
  v_exp_f32_e64 v86, v86
  v_cvt_pk_bf16_f32 v126, v84, v85
  v_mfma_f32_16x16x32_bf16 v[204:207], a[156:159], v[104:107], 0
  v_exp_f32_e64 v87, v87
  v_mfma_f32_16x16x32_bf16 v[144:147], a[160:163], a[192:195], v[144:147]
  v_cvt_pk_bf16_f32 v127, v86, v87
  v_mfma_f32_16x16x32_bf16 v[164:167], a[164:167], a[192:195], v[164:167]
  ds_write_b128 v208, v[124:127] offset:4096
  v_mfma_f32_16x16x32_bf16 v[184:187], a[168:171], a[192:195], v[184:187]
  v_mfma_f32_16x16x32_bf16 v[204:207], a[172:175], a[192:195], v[204:207]
  s_waitcnt vmcnt(8) lgkmcnt(0)
  s_barrier
  v_mfma_f32_16x16x32_bf16 v[48:51], a[80:83], a[0:3], v[28:31]
  ds_read_b64_tr_b16 a[144:145], v8 offset:57344
  s_add_u32 m0, s43, 16384
  s_add_u32 s51, s49, 81920
  v_mfma_f32_16x16x32_bf16 v[52:55], a[96:99], a[0:3], v[28:31]
  ds_read_b64_tr_b16 a[146:147], v8 offset:61440
  ds_read_b64_tr_b16 a[148:149], v9 offset:57344
  s_and_b32 s51, s51, 0x3ffff
  v_mfma_f32_16x16x32_bf16 v[48:51], a[84:87], a[20:23], v[48:51]
  ds_read_b64_tr_b16 a[150:151], v9 offset:61440
  ds_read_b64_tr_b16 a[152:153], v10 offset:57344
  v_mfma_f32_16x16x32_bf16 v[52:55], a[100:103], a[20:23], v[52:55]
  buffer_load_dwordx4 v16, s[8:11], s51 offen offset:0 nt lds
  ds_read_b64_tr_b16 a[154:155], v10 offset:61440
  v_mfma_f32_16x16x32_bf16 v[48:51], a[88:91], a[40:43], v[48:51]
  ds_read_b64_tr_b16 a[156:157], v11 offset:57344
  ds_read_b64_tr_b16 a[158:159], v11 offset:61440
  v_mfma_f32_16x16x32_bf16 v[52:55], a[104:107], a[40:43], v[52:55]
  ds_read_b128 a[176:179], v209 offset:0
  ds_read_b64_tr_b16 a[160:161], v12 offset:57344
  v_mfma_f32_16x16x32_bf16 v[48:51], a[92:95], a[60:63], v[48:51]
  ds_read_b64_tr_b16 a[162:163], v12 offset:61440
  ds_read_b64_tr_b16 a[164:165], v13 offset:57344
  v_mfma_f32_16x16x32_bf16 v[52:55], a[108:111], a[60:63], v[52:55]
  ds_read_b64_tr_b16 a[166:167], v13 offset:61440
  ds_read_b64_tr_b16 a[168:169], v14 offset:57344
  v_mfma_f32_16x16x32_bf16 v[56:59], a[80:83], a[4:7], v[32:35]
  ds_read_b64_tr_b16 a[170:171], v14 offset:61440
  buffer_load_dwordx4 v17, s[8:11], s51 offen offset:1024 nt lds
  v_mfma_f32_16x16x32_bf16 v[60:63], a[96:99], a[4:7], v[32:35]
  ds_read_b64_tr_b16 a[172:173], v15 offset:57344
  ds_read_b64_tr_b16 a[174:175], v15 offset:61440
  v_mfma_f32_16x16x32_bf16 v[56:59], a[84:87], a[24:27], v[56:59]
  ds_read_b128 a[180:183], v209 offset:1024
  ds_read_b128 a[184:187], v209 offset:2048
  v_mfma_f32_16x16x32_bf16 v[60:63], a[100:103], a[24:27], v[60:63]
  ds_read_b128 a[188:191], v209 offset:3072
  v_mfma_f32_16x16x32_bf16 v[56:59], a[88:91], a[44:47], v[56:59]
  ds_read_b128 a[192:195], v209 offset:4096
  v_mfma_f32_16x16x32_bf16 v[60:63], a[104:107], a[44:47], v[60:63]
  v_mfma_f32_16x16x32_bf16 v[56:59], a[92:95], a[64:67], v[56:59]
  v_exp_f32_e64 v48, v48
  v_mfma_f32_16x16x32_bf16 v[60:63], a[108:111], a[64:67], v[60:63]
  v_exp_f32_e64 v49, v49
  v_mfma_f32_16x16x32_bf16 v[64:67], a[80:83], a[8:11], v[36:39]
  buffer_load_dwordx4 v18, s[8:11], s51 offen offset:2048 nt lds
  v_mfma_f32_16x16x32_bf16 v[68:71], a[96:99], a[8:11], v[36:39]
  v_exp_f32_e64 v50, v50
  v_mfma_f32_16x16x32_bf16 v[64:67], a[84:87], a[28:31], v[64:67]
  v_cvt_pk_bf16_f32 v88, v48, v49
  v_mfma_f32_16x16x32_bf16 v[68:71], a[100:103], a[28:31], v[68:71]
  v_exp_f32_e64 v51, v51
  v_mfma_f32_16x16x32_bf16 v[64:67], a[88:91], a[48:51], v[64:67]
  v_exp_f32_e64 v52, v52
  v_mfma_f32_16x16x32_bf16 v[68:71], a[104:107], a[48:51], v[68:71]
  s_waitcnt lgkmcnt(0)
  s_nop 0
  v_cvt_pk_bf16_f32 v89, v50, v51
  v_mfma_f32_16x16x32_bf16 v[64:67], a[92:95], a[68:71], v[64:67]
  v_exp_f32_e64 v53, v53
  v_mfma_f32_16x16x32_bf16 v[68:71], a[108:111], a[68:71], v[68:71]
  v_exp_f32_e64 v54, v54
  v_mfma_f32_16x16x32_bf16 a[196:199], a[216:219], v[108:111], a[196:199]
  buffer_load_dwordx4 v19, s[8:11], s51 offen offset:3072 nt lds
  v_cvt_pk_bf16_f32 v90, v52, v53
  v_mfma_f32_16x16x32_bf16 v[128:131], a[144:147], v[108:111], v[128:131]
  v_exp_f32_e64 v55, v55
  v_mfma_f32_16x16x32_bf16 v[148:151], a[148:151], v[108:111], v[148:151]
  ds_read_b128 a[112:115], v4 offset:49152
  v_cvt_pk_bf16_f32 v91, v54, v55
  v_mfma_f32_16x16x32_bf16 v[168:171], a[152:155], v[108:111], v[168:171]
  ds_write_b128 v208, v[88:91] offset:57344
  v_mfma_f32_16x16x32_bf16 v[188:191], a[156:159], v[108:111], v[188:191]
  s_add_u32 m0, s43, 65536
  v_exp_f32_e64 v56, v56
  v_mfma_f32_16x16x32_bf16 v[128:131], a[160:163], a[176:179], v[128:131]
  s_add_u32 s51, s49, 49152
  v_exp_f32_e64 v57, v57
  v_mfma_f32_16x16x32_bf16 v[148:151], a[164:167], a[176:179], v[148:151]
  s_and_b32 s51, s51, 0x3ffff
  v_exp_f32_e64 v58, v58
  v_mfma_f32_16x16x32_bf16 v[168:171], a[168:171], a[176:179], v[168:171]
  ds_read_b128 a[128:131], v4 offset:53248
  v_cvt_pk_bf16_f32 v92, v56, v57
  v_mfma_f32_16x16x32_bf16 v[188:191], a[172:175], a[176:179], v[188:191]
  v_exp_f32_e64 v59, v59
  v_mfma_f32_16x16x32_bf16 v[72:75], a[80:83], a[12:15], v[40:43]
  buffer_load_dwordx4 v20, s[12:15], s51 offen offset:0 nt lds
  v_mfma_f32_16x16x32_bf16 v[76:79], a[96:99], a[12:15], v[40:43]
  v_exp_f32_e64 v60, v60
  v_mfma_f32_16x16x32_bf16 v[72:75], a[84:87], a[32:35], v[72:75]
  ds_read_b128 a[116:119], v5 offset:49152
  v_cvt_pk_bf16_f32 v93, v58, v59
  v_mfma_f32_16x16x32_bf16 v[76:79], a[100:103], a[32:35], v[76:79]
  v_exp_f32_e64 v61, v61
  v_mfma_f32_16x16x32_bf16 v[72:75], a[88:91], a[52:55], v[72:75]
  v_exp_f32_e64 v62, v62
  v_mfma_f32_16x16x32_bf16 v[76:79], a[104:107], a[52:55], v[76:79]
  buffer_load_dwordx4 v21, s[12:15], s51 offen offset:1024 nt lds
  v_cvt_pk_bf16_f32 v94, v60, v61
  v_mfma_f32_16x16x32_bf16 v[72:75], a[92:95], a[72:75], v[72:75]
  v_exp_f32_e64 v63, v63
  v_mfma_f32_16x16x32_bf16 v[76:79], a[108:111], a[72:75], v[76:79]
  ds_read_b128 a[132:135], v5 offset:53248
  v_cvt_pk_bf16_f32 v95, v62, v63
  v_mfma_f32_16x16x32_bf16 a[200:203], a[216:219], v[112:115], a[200:203]
  ds_write_b128 v208, v[92:95] offset:58368
  v_mfma_f32_16x16x32_bf16 v[132:135], a[144:147], v[112:115], v[132:135]
  v_exp_f32_e64 v64, v64
  v_mfma_f32_16x16x32_bf16 v[152:155], a[148:151], v[112:115], v[152:155]
  v_exp_f32_e64 v65, v65
  v_mfma_f32_16x16x32_bf16 v[172:175], a[152:155], v[112:115], v[172:175]
  v_exp_f32_e64 v66, v66
  v_mfma_f32_16x16x32_bf16 v[192:195], a[156:159], v[112:115], v[192:195]
  buffer_load_dwordx4 v20, s[12:15], s51 offen offset:2048 nt lds
  v_cvt_pk_bf16_f32 v96, v64, v65
  v_mfma_f32_16x16x32_bf16 v[132:135], a[160:163], a[180:183], v[132:135]
  v_exp_f32_e64 v67, v67
  v_mfma_f32_16x16x32_bf16 v[152:155], a[164:167], a[180:183], v[152:155]
  v_exp_f32_e64 v68, v68
  v_mfma_f32_16x16x32_bf16 v[172:175], a[168:171], a[180:183], v[172:175]
  ds_read_b128 a[120:123], v6 offset:49152
  v_cvt_pk_bf16_f32 v97, v66, v67
  v_mfma_f32_16x16x32_bf16 v[192:195], a[172:175], a[180:183], v[192:195]
  v_exp_f32_e64 v69, v69
  v_mfma_f32_16x16x32_bf16 v[80:83], a[80:83], a[16:19], v[44:47]
  v_exp_f32_e64 v70, v70
  v_mfma_f32_16x16x32_bf16 v[84:87], a[96:99], a[16:19], v[44:47]
  buffer_load_dwordx4 v21, s[12:15], s51 offen offset:3072 nt lds
  v_cvt_pk_bf16_f32 v98, v68, v69
  v_mfma_f32_16x16x32_bf16 v[80:83], a[84:87], a[36:39], v[80:83]
  v_exp_f32_e64 v71, v71
  v_mfma_f32_16x16x32_bf16 v[84:87], a[100:103], a[36:39], v[84:87]
  ds_read_b128 a[136:139], v6 offset:53248
  v_cvt_pk_bf16_f32 v99, v70, v71
  v_mfma_f32_16x16x32_bf16 v[80:83], a[88:91], a[56:59], v[80:83]
  ds_write_b128 v208, v[96:99] offset:59392
  v_mfma_f32_16x16x32_bf16 v[84:87], a[104:107], a[56:59], v[84:87]
  v_exp_f32_e64 v72, v72
  v_mfma_f32_16x16x32_bf16 v[80:83], a[92:95], a[76:79], v[80:83]
  v_exp_f32_e64 v73, v73
  v_mfma_f32_16x16x32_bf16 v[84:87], a[108:111], a[76:79], v[84:87]
  v_exp_f32_e64 v74, v74
  v_mfma_f32_16x16x32_bf16 a[204:207], a[216:219], v[116:119], a[204:207]
  ds_read_b128 a[124:127], v7 offset:49152
  v_cvt_pk_bf16_f32 v100, v72, v73
  v_mfma_f32_16x16x32_bf16 v[136:139], a[144:147], v[116:119], v[136:139]
  v_exp_f32_e64 v75, v75
  v_mfma_f32_16x16x32_bf16 v[156:159], a[148:151], v[116:119], v[156:159]
  v_mov_b32 v224, 0
  v_mov_b32 v225, 0
  v_mov_b32 v226, 0
  v_mov_b32 v227, 0
  s_or_b32 s38, s48, s32
  s_or_b32 s38, s38, s50
  s_cselect_b32 s38, 0x10000000, 0
  buffer_store_dwordx4 v[224:227], v22, s[64:67], s38 offen offset:0 sc1
  buffer_store_dwordx4 v[224:227], v22, s[64:67], s38 offen offset:1024 sc1
  buffer_store_dwordx4 v[224:227], v22, s[64:67], s38 offen offset:2048 sc1
  buffer_store_dwordx4 v[224:227], v22, s[64:67], s38 offen offset:3072 sc1
  v_mfma_f32_16x16x32_bf16 v[176:179], a[152:155], v[116:119], v[176:179]
  v_exp_f32_e64 v76, v76
  v_mfma_f32_16x16x32_bf16 v[196:199], a[156:159], v[116:119], v[196:199]
  v_cvt_pk_bf16_f32 v101, v74, v75
  v_mfma_f32_16x16x32_bf16 v[136:139], a[160:163], a[184:187], v[136:139]
  v_exp_f32_e64 v77, v77
  v_mfma_f32_16x16x32_bf16 v[156:159], a[164:167], a[184:187], v[156:159]
  v_exp_f32_e64 v78, v78
  v_mfma_f32_16x16x32_bf16 v[176:179], a[168:171], a[184:187], v[176:179]
  ds_read_b128 a[140:143], v7 offset:53248
  v_cvt_pk_bf16_f32 v102, v76, v77
  v_mfma_f32_16x16x32_bf16 v[196:199], a[172:175], a[184:187], v[196:199]
  v_exp_f32_e64 v79, v79
  v_mfma_f32_16x16x32_bf16 a[208:211], a[216:219], v[120:123], a[208:211]
  v_cvt_pk_bf16_f32 v103, v78, v79
  v_mfma_f32_16x16x32_bf16 v[140:143], a[144:147], v[120:123], v[140:143]
  ds_write_b128 v208, v[100:103] offset:60416
  v_mfma_f32_16x16x32_bf16 v[160:163], a[148:151], v[120:123], v[160:163]
  v_exp_f32_e64 v80, v80
  v_mfma_f32_16x16x32_bf16 v[180:183], a[152:155], v[120:123], v[180:183]
  v_exp_f32_e64 v81, v81
  v_mfma_f32_16x16x32_bf16 v[200:203], a[156:159], v[120:123], v[200:203]
  v_exp_f32_e64 v82, v82
  v_mfma_f32_16x16x32_bf16 v[140:143], a[160:163], a[188:191], v[140:143]
  v_cvt_pk_bf16_f32 v104, v80, v81
  v_mfma_f32_16x16x32_bf16 v[160:163], a[164:167], a[188:191], v[160:163]
  v_exp_f32_e64 v83, v83
  v_mfma_f32_16x16x32_bf16 v[180:183], a[168:171], a[188:191], v[180:183]
  v_exp_f32_e64 v84, v84
  v_mfma_f32_16x16x32_bf16 v[200:203], a[172:175], a[188:191], v[200:203]
  v_cvt_pk_bf16_f32 v105, v82, v83
  v_mfma_f32_16x16x32_bf16 a[212:215], a[216:219], v[124:127], a[212:215]
  v_exp_f32_e64 v85, v85
  v_mfma_f32_16x16x32_bf16 v[144:147], a[144:147], v[124:127], v[144:147]
  v_exp_f32_e64 v86, v86
  v_mfma_f32_16x16x32_bf16 v[164:167], a[148:151], v[124:127], v[164:167]
  v_cvt_pk_bf16_f32 v106, v84, v85
  v_mfma_f32_16x16x32_bf16 v[184:187], a[152:155], v[124:127], v[184:187]
  v_exp_f32_e64 v87, v87
  v_mfma_f32_16x16x32_bf16 v[204:207], a[156:159], v[124:127], v[204:207]
  v_cvt_pk_bf16_f32 v107, v86, v87
  v_mfma_f32_16x16x32_bf16 v[144:147], a[160:163], a[192:195], v[144:147]
  ds_write_b128 v208, v[104:107] offset:61440
  v_mfma_f32_16x16x32_bf16 v[164:167], a[164:167], a[192:195], v[164:167]
  v_mfma_f32_16x16x32_bf16 v[184:187], a[168:171], a[192:195], v[184:187]
  v_mfma_f32_16x16x32_bf16 v[204:207], a[172:175], a[192:195], v[204:207]
  s_waitcnt vmcnt(12) lgkmcnt(0)
  s_barrier
  v_mfma_f32_16x16x32_bf16 v[48:51], a[112:115], a[0:3], v[28:31]
  ds_read_b64_tr_b16 a[144:145], v8 offset:40960
  s_add_u32 m0, s43, 32768
  s_add_u32 s51, s49, 98304
  v_mfma_f32_16x16x32_bf16 v[52:55], a[128:131], a[0:3], v[28:31]
  ds_read_b64_tr_b16 a[146:147], v8 offset:45056
  ds_read_b64_tr_b16 a[148:149], v9 offset:40960
  s_and_b32 s51, s51, 0x3ffff
  v_mfma_f32_16x16x32_bf16 v[48:51], a[116:119], a[20:23], v[48:51]
  ds_read_b64_tr_b16 a[150:151], v9 offset:45056
  ds_read_b64_tr_b16 a[152:153], v10 offset:40960
  v_mfma_f32_16x16x32_bf16 v[52:55], a[132:135], a[20:23], v[52:55]
  buffer_load_dwordx4 v16, s[8:11], s51 offen offset:0 nt lds
  ds_read_b64_tr_b16 a[154:155], v10 offset:45056
  v_mfma_f32_16x16x32_bf16 v[48:51], a[120:123], a[40:43], v[48:51]
  ds_read_b64_tr_b16 a[156:157], v11 offset:40960
  ds_read_b64_tr_b16 a[158:159], v11 offset:45056
  v_mfma_f32_16x16x32_bf16 v[52:55], a[136:139], a[40:43], v[52:55]
  ds_read_b128 a[176:179], v209 offset:57344
  ds_read_b64_tr_b16 a[160:161], v12 offset:40960
  v_mfma_f32_16x16x32_bf16 v[48:51], a[124:127], a[60:63], v[48:51]
  ds_read_b64_tr_b16 a[162:163], v12 offset:45056
  ds_read_b64_tr_b16 a[164:165], v13 offset:40960
  v_mfma_f32_16x16x32_bf16 v[52:55], a[140:143], a[60:63], v[52:55]
  ds_read_b64_tr_b16 a[166:167], v13 offset:45056
  ds_read_b64_tr_b16 a[168:169], v14 offset:40960
  v_mfma_f32_16x16x32_bf16 v[56:59], a[112:115], a[4:7], v[32:35]
  ds_read_b64_tr_b16 a[170:171], v14 offset:45056
  ds_read_b64_tr_b16 a[172:173], v15 offset:40960
  v_mfma_f32_16x16x32_bf16 v[60:63], a[128:131], a[4:7], v[32:35]
  buffer_load_dwordx4 v17, s[8:11], s51 offen offset:1024 nt lds
  ds_read_b64_tr_b16 a[174:175], v15 offset:45056
  v_mfma_f32_16x16x32_bf16 v[56:59], a[116:119], a[24:27], v[56:59]
  ds_read_b128 a[180:183], v209 offset:58368
  ds_read_b128 a[184:187], v209 offset:59392
  v_mfma_f32_16x16x32_bf16 v[60:63], a[132:135], a[24:27], v[60:63]
  ds_read_b128 a[188:191], v209 offset:60416
  v_mfma_f32_16x16x32_bf16 v[56:59], a[120:123], a[44:47], v[56:59]
  ds_read_b128 a[192:195], v209 offset:61440
  v_mfma_f32_16x16x32_bf16 v[60:63], a[136:139], a[44:47], v[60:63]
  v_mfma_f32_16x16x32_bf16 v[56:59], a[124:127], a[64:67], v[56:59]
  v_exp_f32_e64 v48, v48
  v_mfma_f32_16x16x32_bf16 v[60:63], a[140:143], a[64:67], v[60:63]
  v_exp_f32_e64 v49, v49
  v_mfma_f32_16x16x32_bf16 v[64:67], a[112:115], a[8:11], v[36:39]
  v_exp_f32_e64 v50, v50
  v_mfma_f32_16x16x32_bf16 v[68:71], a[128:131], a[8:11], v[36:39]
  buffer_load_dwordx4 v18, s[8:11], s51 offen offset:2048 nt lds
  v_cvt_pk_bf16_f32 v108, v48, v49
  v_mfma_f32_16x16x32_bf16 v[64:67], a[116:119], a[28:31], v[64:67]
  v_exp_f32_e64 v51, v51
  v_mfma_f32_16x16x32_bf16 v[68:71], a[132:135], a[28:31], v[68:71]
  v_exp_f32_e64 v52, v52
  v_mfma_f32_16x16x32_bf16 v[64:67], a[120:123], a[48:51], v[64:67]
  v_cvt_pk_bf16_f32 v109, v50, v51
  v_mfma_f32_16x16x32_bf16 v[68:71], a[136:139], a[48:51], v[68:71]
  s_waitcnt lgkmcnt(0)
  s_nop 0
  v_mfma_f32_16x16x32_bf16 v[64:67], a[124:127], a[68:71], v[64:67]
  v_exp_f32_e64 v53, v53
  v_mfma_f32_16x16x32_bf16 v[68:71], a[140:143], a[68:71], v[68:71]
  v_exp_f32_e64 v54, v54
  v_mfma_f32_16x16x32_bf16 a[196:199], a[216:219], v[88:91], a[196:199]
  ds_read_b128 a[80:83], v4 offset:0
  v_cvt_pk_bf16_f32 v110, v52, v53
  v_mfma_f32_16x16x32_bf16 v[128:131], a[144:147], v[88:91], v[128:131]
  v_exp_f32_e64 v55, v55
  v_mfma_f32_16x16x32_bf16 v[148:151], a[148:151], v[88:91], v[148:151]
  buffer_load_dwordx4 v19, s[8:11], s51 offen offset:3072 nt lds
  v_cvt_pk_bf16_f32 v111, v54, v55
  v_mfma_f32_16x16x32_bf16 v[168:171], a[152:155], v[88:91], v[168:171]
  ds_write_b128 v208, v[108:111] offset:0
  v_mfma_f32_16x16x32_bf16 v[188:191], a[156:159], v[88:91], v[188:191]
  v_exp_f32_e64 v56, v56
  v_mfma_f32_16x16x32_bf16 v[128:131], a[160:163], a[176:179], v[128:131]
  v_exp_f32_e64 v57, v57
  v_mfma_f32_16x16x32_bf16 v[148:151], a[164:167], a[176:179], v[148:151]
  s_add_u32 m0, s43, 122880
  v_exp_f32_e64 v58, v58
  v_mfma_f32_16x16x32_bf16 v[168:171], a[168:171], a[176:179], v[168:171]
  ds_read_b128 a[96:99], v4 offset:4096
  v_cvt_pk_bf16_f32 v112, v56, v57
  v_mfma_f32_16x16x32_bf16 v[188:191], a[172:175], a[176:179], v[188:191]
  s_add_u32 s51, s49, 65536
  v_exp_f32_e64 v59, v59
  v_mfma_f32_16x16x32_bf16 v[72:75], a[112:115], a[12:15], v[40:43]
  s_and_b32 s51, s51, 0x3ffff
  v_exp_f32_e64 v60, v60
  v_mfma_f32_16x16x32_bf16 v[76:79], a[128:131], a[12:15], v[40:43]
  buffer_load_dwordx4 v20, s[12:15], s51 offen offset:0 nt lds
  v_cvt_pk_bf16_f32 v113, v58, v59
  v_mfma_f32_16x16x32_bf16 v[72:75], a[116:119], a[32:35], v[72:75]
  v_exp_f32_e64 v61, v61
  v_mfma_f32_16x16x32_bf16 v[76:79], a[132:135], a[32:35], v[76:79]
  v_exp_f32_e64 v62, v62
  v_mfma_f32_16x16x32_bf16 v[72:75], a[120:123], a[52:55], v[72:75]
  ds_read_b128 a[84:87], v5 offset:0
  v_cvt_pk_bf16_f32 v114, v60, v61
  v_mfma_f32_16x16x32_bf16 v[76:79], a[136:139], a[52:55], v[76:79]
  v_exp_f32_e64 v63, v63
  v_mfma_f32_16x16x32_bf16 v[72:75], a[124:127], a[72:75], v[72:75]
  v_cvt_pk_bf16_f32 v115, v62, v63
  v_mfma_f32_16x16x32_bf16 v[76:79], a[140:143], a[72:75], v[76:79]
  ds_write_b128 v208, v[112:115] offset:1024
  v_mfma_f32_16x16x32_bf16 a[200:203], a[216:219], v[92:95], a[200:203]
  v_exp_f32_e64 v64, v64
  v_mfma_f32_16x16x32_bf16 v[132:135], a[144:147], v[92:95], v[132:135]
  v_exp_f32_e64 v65, v65
  v_mfma_f32_16x16x32_bf16 v[152:155], a[148:151], v[92:95], v[152:155]
  ds_read_b128 a[100:103], v5 offset:4096
  buffer_load_dwordx4 v21, s[12:15], s51 offen offset:1024 nt lds
  v_mfma_f32_16x16x32_bf16 v[172:175], a[152:155], v[92:95], v[172:175]
  v_exp_f32_e64 v66, v66
  v_mfma_f32_16x16x32_bf16 v[192:195], a[156:159], v[92:95], v[192:195]
  v_cvt_pk_bf16_f32 v116, v64, v65
  v_mfma_f32_16x16x32_bf16 v[132:135], a[160:163], a[180:183], v[132:135]
  v_exp_f32_e64 v67, v67
  v_mfma_f32_16x16x32_bf16 v[152:155], a[164:167], a[180:183], v[152:155]
  v_exp_f32_e64 v68, v68
  v_mfma_f32_16x16x32_bf16 v[172:175], a[168:171], a[180:183], v[172:175]
  ds_read_b128 a[88:91], v6 offset:0
  v_cvt_pk_bf16_f32 v117, v66, v67
  v_mfma_f32_16x16x32_bf16 v[192:195], a[172:175], a[180:183], v[192:195]
  v_exp_f32_e64 v69, v69
  v_mfma_f32_16x16x32_bf16 v[80:83], a[112:115], a[16:19], v[44:47]
  v_exp_f32_e64 v70, v70
  v_mfma_f32_16x16x32_bf16 v[84:87], a[128:131], a[16:19], v[44:47]
  buffer_load_dwordx4 v20, s[12:15], s51 offen offset:2048 nt lds
  v_cvt_pk_bf16_f32 v118, v68, v69
  v_mfma_f32_16x16x32_bf16 v[80:83], a[116:119], a[36:39], v[80:83]
  v_exp_f32_e64 v71, v71
  v_mfma_f32_16x16x32_bf16 v[84:87], a[132:135], a[36:39], v[84:87]
  ds_read_b128 a[104:107], v6 offset:4096
  v_cvt_pk_bf16_f32 v119, v70, v71
  v_mfma_f32_16x16x32_bf16 v[80:83], a[120:123], a[56:59], v[80:83]
  ds_write_b128 v208, v[116:119] offset:2048
  v_mfma_f32_16x16x32_bf16 v[84:87], a[136:139], a[56:59], v[84:87]
  v_exp_f32_e64 v72, v72
  v_mfma_f32_16x16x32_bf16 v[80:83], a[124:127], a[76:79], v[80:83]
  v_exp_f32_e64 v73, v73
  v_mfma_f32_16x16x32_bf16 v[84:87], a[140:143], a[76:79], v[84:87]
  v_exp_f32_e64 v74, v74
  v_mfma_f32_16x16x32_bf16 a[204:207], a[216:219], v[96:99], a[204:207]
  buffer_load_dwordx4 v21, s[12:15], s51 offen offset:3072 nt lds
  v_cvt_pk_bf16_f32 v120, v72, v73
  v_mfma_f32_16x16x32_bf16 v[136:139], a[144:147], v[96:99], v[136:139]
  v_exp_f32_e64 v75, v75
  v_mfma_f32_16x16x32_bf16 v[156:159], a[148:151], v[96:99], v[156:159]
  v_exp_f32_e64 v76, v76
  v_mfma_f32_16x16x32_bf16 v[176:179], a[152:155], v[96:99], v[176:179]
  ds_read_b128 a[92:95], v7 offset:0
  v_cvt_pk_bf16_f32 v121, v74, v75
  v_mfma_f32_16x16x32_bf16 v[196:199], a[156:159], v[96:99], v[196:199]
  v_exp_f32_e64 v77, v77
  v_mfma_f32_16x16x32_bf16 v[136:139], a[160:163], a[184:187], v[136:139]
  v_exp_f32_e64 v78, v78
  v_mfma_f32_16x16x32_bf16 v[156:159], a[164:167], a[184:187], v[156:159]
  ds_read_b128 a[108:111], v7 offset:4096
  v_cvt_pk_bf16_f32 v122, v76, v77
  v_mfma_f32_16x16x32_bf16 v[176:179], a[168:171], a[184:187], v[176:179]
  v_exp_f32_e64 v79, v79
  v_mfma_f32_16x16x32_bf16 v[196:199], a[172:175], a[184:187], v[196:199]
  v_cvt_pk_bf16_f32 v123, v78, v79
  v_mfma_f32_16x16x32_bf16 a[208:211], a[216:219], v[100:103], a[208:211]
  ds_write_b128 v208, v[120:123] offset:3072
  v_mfma_f32_16x16x32_bf16 v[140:143], a[144:147], v[100:103], v[140:143]
  v_exp_f32_e64 v80, v80
  v_mfma_f32_16x16x32_bf16 v[160:163], a[148:151], v[100:103], v[160:163]
  v_exp_f32_e64 v81, v81
  v_mfma_f32_16x16x32_bf16 v[180:183], a[152:155], v[100:103], v[180:183]
  v_exp_f32_e64 v82, v82
  v_mfma_f32_16x16x32_bf16 v[200:203], a[156:159], v[100:103], v[200:203]
  v_cvt_pk_bf16_f32 v124, v80, v81
  v_mfma_f32_16x16x32_bf16 v[140:143], a[160:163], a[188:191], v[140:143]
  v_exp_f32_e64 v83, v83
  v_mfma_f32_16x16x32_bf16 v[160:163], a[164:167], a[188:191], v[160:163]
  v_exp_f32_e64 v84, v84
  v_mfma_f32_16x16x32_bf16 v[180:183], a[168:171], a[188:191], v[180:183]
  v_cvt_pk_bf16_f32 v125, v82, v83
  v_mfma_f32_16x16x32_bf16 v[200:203], a[172:175], a[188:191], v[200:203]
  v_exp_f32_e64 v85, v85
  v_mfma_f32_16x16x32_bf16 a[212:215], a[216:219], v[104:107], a[212:215]
  v_exp_f32_e64 v86, v86
  v_mfma_f32_16x16x32_bf16 v[144:147], a[144:147], v[104:107], v[144:147]
  v_cvt_pk_bf16_f32 v126, v84, v85
  v_mfma_f32_16x16x32_bf16 v[164:167], a[148:151], v[104:107], v[164:167]
  v_exp_f32_e64 v87, v87
  v_mfma_f32_16x16x32_bf16 v[184:187], a[152:155], v[104:107], v[184:187]
  v_cvt_pk_bf16_f32 v127, v86, v87
  v_mfma_f32_16x16x32_bf16 v[204:207], a[156:159], v[104:107], v[204:207]
  ds_write_b128 v208, v[124:127] offset:4096
  v_mfma_f32_16x16x32_bf16 v[144:147], a[160:163], a[192:195], v[144:147]
  v_mfma_f32_16x16x32_bf16 v[164:167], a[164:167], a[192:195], v[164:167]
  v_mfma_f32_16x16x32_bf16 v[184:187], a[168:171], a[192:195], v[184:187]
  v_mfma_f32_16x16x32_bf16 v[204:207], a[172:175], a[192:195], v[204:207]
  s_waitcnt vmcnt(12) lgkmcnt(0)
  s_barrier
  v_mfma_f32_16x16x32_bf16 v[48:51], a[80:83], a[0:3], v[28:31]
  ds_read_b64_tr_b16 a[144:145], v8 offset:0
  s_add_u32 m0, s43, 49152
  s_add_u32 s51, s49, 114688
  v_mfma_f32_16x16x32_bf16 v[52:55], a[96:99], a[0:3], v[28:31]
  ds_read_b64_tr_b16 a[146:147], v8 offset:4096
  ds_read_b64_tr_b16 a[148:149], v9 offset:0
  s_and_b32 s51, s51, 0x3ffff
  v_mfma_f32_16x16x32_bf16 v[48:51], a[84:87], a[20:23], v[48:51]
  ds_read_b64_tr_b16 a[150:151], v9 offset:4096
  ds_read_b64_tr_b16 a[152:153], v10 offset:0
  v_mfma_f32_16x16x32_bf16 v[52:55], a[100:103], a[20:23], v[52:55]
  buffer_load_dwordx4 v16, s[8:11], s51 offen offset:0 nt lds
  ds_read_b64_tr_b16 a[154:155], v10 offset:4096
  v_mfma_f32_16x16x32_bf16 v[48:51], a[88:91], a[40:43], v[48:51]
  ds_read_b64_tr_b16 a[156:157], v11 offset:0
  ds_read_b64_tr_b16 a[158:159], v11 offset:4096
  v_mfma_f32_16x16x32_bf16 v[52:55], a[104:107], a[40:43], v[52:55]
  ds_read_b128 a[176:179], v209 offset:0
  ds_read_b64_tr_b16 a[160:161], v12 offset:0
  v_mfma_f32_16x16x32_bf16 v[48:51], a[92:95], a[60:63], v[48:51]
  ds_read_b64_tr_b16 a[162:163], v12 offset:4096
  ds_read_b64_tr_b16 a[164:165], v13 offset:0
  v_mfma_f32_16x16x32_bf16 v[52:55], a[108:111], a[60:63], v[52:55]
  ds_read_b64_tr_b16 a[166:167], v13 offset:4096
  ds_read_b64_tr_b16 a[168:169], v14 offset:0
  v_mfma_f32_16x16x32_bf16 v[56:59], a[80:83], a[4:7], v[32:35]
  ds_read_b64_tr_b16 a[170:171], v14 offset:4096
  ds_read_b64_tr_b16 a[172:173], v15 offset:0
  v_mfma_f32_16x16x32_bf16 v[60:63], a[96:99], a[4:7], v[32:35]
  buffer_load_dwordx4 v17, s[8:11], s51 offen offset:1024 nt lds
  ds_read_b64_tr_b16 a[174:175], v15 offset:4096
  v_mfma_f32_16x16x32_bf16 v[56:59], a[84:87], a[24:27], v[56:59]
  ds_read_b128 a[180:183], v209 offset:1024
  ds_read_b128 a[184:187], v209 offset:2048
  v_mfma_f32_16x16x32_bf16 v[60:63], a[100:103], a[24:27], v[60:63]
  ds_read_b128 a[188:191], v209 offset:3072
  v_mfma_f32_16x16x32_bf16 v[56:59], a[88:91], a[44:47], v[56:59]
  ds_read_b128 a[192:195], v209 offset:4096
  v_mfma_f32_16x16x32_bf16 v[60:63], a[104:107], a[44:47], v[60:63]
  v_mfma_f32_16x16x32_bf16 v[56:59], a[92:95], a[64:67], v[56:59]
  v_exp_f32_e64 v48, v48
  v_mfma_f32_16x16x32_bf16 v[60:63], a[108:111], a[64:67], v[60:63]
  v_exp_f32_e64 v49, v49
  v_mfma_f32_16x16x32_bf16 v[64:67], a[80:83], a[8:11], v[36:39]
  v_exp_f32_e64 v50, v50
  v_mfma_f32_16x16x32_bf16 v[68:71], a[96:99], a[8:11], v[36:39]
  buffer_load_dwordx4 v18, s[8:11], s51 offen offset:2048 nt lds
  v_cvt_pk_bf16_f32 v88, v48, v49
  v_mfma_f32_16x16x32_bf16 v[64:67], a[84:87], a[28:31], v[64:67]
  v_exp_f32_e64 v51, v51
  v_mfma_f32_16x16x32_bf16 v[68:71], a[100:103], a[28:31], v[68:71]
  v_exp_f32_e64 v52, v52
  v_mfma_f32_16x16x32_bf16 v[64:67], a[88:91], a[48:51], v[64:67]
  v_cvt_pk_bf16_f32 v89, v50, v51
  v_mfma_f32_16x16x32_bf16 v[68:71], a[104:107], a[48:51], v[68:71]
  s_waitcnt lgkmcnt(0)
  s_nop 0
  v_mfma_f32_16x16x32_bf16 v[64:67], a[92:95], a[68:71], v[64:67]
  v_exp_f32_e64 v53, v53
  v_mfma_f32_16x16x32_bf16 v[68:71], a[108:111], a[68:71], v[68:71]
  v_exp_f32_e64 v54, v54
  v_mfma_f32_16x16x32_bf16 a[196:199], a[216:219], v[108:111], a[196:199]
  ds_read_b128 a[112:115], v4 offset:16384
  v_cvt_pk_bf16_f32 v90, v52, v53
  v_mfma_f32_16x16x32_bf16 v[128:131], a[144:147], v[108:111], v[128:131]
  v_exp_f32_e64 v55, v55
  v_mfma_f32_16x16x32_bf16 v[148:151], a[148:151], v[108:111], v[148:151]
  buffer_load_dwordx4 v19, s[8:11], s51 offen offset:3072 nt lds
  v_cvt_pk_bf16_f32 v91, v54, v55
  v_mfma_f32_16x16x32_bf16 v[168:171], a[152:155], v[108:111], v[168:171]
  ds_write_b128 v208, v[88:91] offset:57344
  v_mfma_f32_16x16x32_bf16 v[188:191], a[156:159], v[108:111], v[188:191]
  v_exp_f32_e64 v56, v56
  v_mfma_f32_16x16x32_bf16 v[128:131], a[160:163], a[176:179], v[128:131]
  v_exp_f32_e64 v57, v57
  v_mfma_f32_16x16x32_bf16 v[148:151], a[164:167], a[176:179], v[148:151]
  s_add_u32 m0, s43, 106496
  v_exp_f32_e64 v58, v58
  v_mfma_f32_16x16x32_bf16 v[168:171], a[168:171], a[176:179], v[168:171]
  ds_read_b128 a[128:131], v4 offset:20480
  v_cvt_pk_bf16_f32 v92, v56, v57
  v_mfma_f32_16x16x32_bf16 v[188:191], a[172:175], a[176:179], v[188:191]
  s_add_u32 s51, s49, 81920
  v_exp_f32_e64 v59, v59
  v_mfma_f32_16x16x32_bf16 v[72:75], a[80:83], a[12:15], v[40:43]
  s_and_b32 s51, s51, 0x3ffff
  v_exp_f32_e64 v60, v60
  v_mfma_f32_16x16x32_bf16 v[76:79], a[96:99], a[12:15], v[40:43]
  buffer_load_dwordx4 v20, s[12:15], s51 offen offset:0 nt lds
  v_cvt_pk_bf16_f32 v93, v58, v59
  v_mfma_f32_16x16x32_bf16 v[72:75], a[84:87], a[32:35], v[72:75]
  v_exp_f32_e64 v61, v61
  v_mfma_f32_16x16x32_bf16 v[76:79], a[100:103], a[32:35], v[76:79]
  v_exp_f32_e64 v62, v62
  v_mfma_f32_16x16x32_bf16 v[72:75], a[88:91], a[52:55], v[72:75]
  ds_read_b128 a[116:119], v5 offset:16384
  v_cvt_pk_bf16_f32 v94, v60, v61
  v_mfma_f32_16x16x32_bf16 v[76:79], a[104:107], a[52:55], v[76:79]
  v_exp_f32_e64 v63, v63
  v_mfma_f32_16x16x32_bf16 v[72:75], a[92:95], a[72:75], v[72:75]
  v_cvt_pk_bf16_f32 v95, v62, v63
  v_mfma_f32_16x16x32_bf16 v[76:79], a[108:111], a[72:75], v[76:79]
  ds_write_b128 v208, v[92:95] offset:58368
  v_mfma_f32_16x16x32_bf16 a[200:203], a[216:219], v[112:115], a[200:203]
  v_exp_f32_e64 v64, v64
  v_mfma_f32_16x16x32_bf16 v[132:135], a[144:147], v[112:115], v[132:135]
  v_exp_f32_e64 v65, v65
  v_mfma_f32_16x16x32_bf16 v[152:155], a[148:151], v[112:115], v[152:155]
  ds_read_b128 a[132:135], v5 offset:20480
  buffer_load_dwordx4 v21, s[12:15], s51 offen offset:1024 nt lds
  v_mfma_f32_16x16x32_bf16 v[172:175], a[152:155], v[112:115], v[172:175]
  v_exp_f32_e64 v66, v66
  v_mfma_f32_16x16x32_bf16 v[192:195], a[156:159], v[112:115], v[192:195]
  v_cvt_pk_bf16_f32 v96, v64, v65
  v_mfma_f32_16x16x32_bf16 v[132:135], a[160:163], a[180:183], v[132:135]
  v_exp_f32_e64 v67, v67
  v_mfma_f32_16x16x32_bf16 v[152:155], a[164:167], a[180:183], v[152:155]
  v_exp_f32_e64 v68, v68
  v_mfma_f32_16x16x32_bf16 v[172:175], a[168:171], a[180:183], v[172:175]
  ds_read_b128 a[120:123], v6 offset:16384
  v_cvt_pk_bf16_f32 v97, v66, v67
  v_mfma_f32_16x16x32_bf16 v[192:195], a[172:175], a[180:183], v[192:195]
  v_exp_f32_e64 v69, v69
  v_mfma_f32_16x16x32_bf16 v[80:83], a[80:83], a[16:19], v[44:47]
  v_exp_f32_e64 v70, v70
  v_mfma_f32_16x16x32_bf16 v[84:87], a[96:99], a[16:19], v[44:47]
  buffer_load_dwordx4 v20, s[12:15], s51 offen offset:2048 nt lds
  v_cvt_pk_bf16_f32 v98, v68, v69
  v_mfma_f32_16x16x32_bf16 v[80:83], a[84:87], a[36:39], v[80:83]
  v_exp_f32_e64 v71, v71
  v_mfma_f32_16x16x32_bf16 v[84:87], a[100:103], a[36:39], v[84:87]
  ds_read_b128 a[136:139], v6 offset:20480
  v_cvt_pk_bf16_f32 v99, v70, v71
  v_mfma_f32_16x16x32_bf16 v[80:83], a[88:91], a[56:59], v[80:83]
  ds_write_b128 v208, v[96:99] offset:59392
  v_mfma_f32_16x16x32_bf16 v[84:87], a[104:107], a[56:59], v[84:87]
  v_exp_f32_e64 v72, v72
  v_mfma_f32_16x16x32_bf16 v[80:83], a[92:95], a[76:79], v[80:83]
  v_exp_f32_e64 v73, v73
  v_mfma_f32_16x16x32_bf16 v[84:87], a[108:111], a[76:79], v[84:87]
  v_exp_f32_e64 v74, v74
  v_mfma_f32_16x16x32_bf16 a[204:207], a[216:219], v[116:119], a[204:207]
  buffer_load_dwordx4 v21, s[12:15], s51 offen offset:3072 nt lds
  v_cvt_pk_bf16_f32 v100, v72, v73
  v_mfma_f32_16x16x32_bf16 v[136:139], a[144:147], v[116:119], v[136:139]
  v_exp_f32_e64 v75, v75
  v_mfma_f32_16x16x32_bf16 v[156:159], a[148:151], v[116:119], v[156:159]
  v_exp_f32_e64 v76, v76
  v_mfma_f32_16x16x32_bf16 v[176:179], a[152:155], v[116:119], v[176:179]
  ds_read_b128 a[124:127], v7 offset:16384
  v_cvt_pk_bf16_f32 v101, v74, v75
  v_mfma_f32_16x16x32_bf16 v[196:199], a[156:159], v[116:119], v[196:199]
  v_exp_f32_e64 v77, v77
  v_mfma_f32_16x16x32_bf16 v[136:139], a[160:163], a[184:187], v[136:139]
  v_exp_f32_e64 v78, v78
  v_mfma_f32_16x16x32_bf16 v[156:159], a[164:167], a[184:187], v[156:159]
  ds_read_b128 a[140:143], v7 offset:20480
  v_cvt_pk_bf16_f32 v102, v76, v77
  v_mfma_f32_16x16x32_bf16 v[176:179], a[168:171], a[184:187], v[176:179]
  v_exp_f32_e64 v79, v79
  v_mfma_f32_16x16x32_bf16 v[196:199], a[172:175], a[184:187], v[196:199]
  v_cvt_pk_bf16_f32 v103, v78, v79
  v_mfma_f32_16x16x32_bf16 a[208:211], a[216:219], v[120:123], a[208:211]
  ds_write_b128 v208, v[100:103] offset:60416
  v_mfma_f32_16x16x32_bf16 v[140:143], a[144:147], v[120:123], v[140:143]
  v_exp_f32_e64 v80, v80
  v_mfma_f32_16x16x32_bf16 v[160:163], a[148:151], v[120:123], v[160:163]
  v_exp_f32_e64 v81, v81
  v_mfma_f32_16x16x32_bf16 v[180:183], a[152:155], v[120:123], v[180:183]
  v_exp_f32_e64 v82, v82
  v_mfma_f32_16x16x32_bf16 v[200:203], a[156:159], v[120:123], v[200:203]
  v_cvt_pk_bf16_f32 v104, v80, v81
  v_mfma_f32_16x16x32_bf16 v[140:143], a[160:163], a[188:191], v[140:143]
  v_exp_f32_e64 v83, v83
  v_mfma_f32_16x16x32_bf16 v[160:163], a[164:167], a[188:191], v[160:163]
  v_exp_f32_e64 v84, v84
  v_mfma_f32_16x16x32_bf16 v[180:183], a[168:171], a[188:191], v[180:183]
  v_cvt_pk_bf16_f32 v105, v82, v83
  v_mfma_f32_16x16x32_bf16 v[200:203], a[172:175], a[188:191], v[200:203]
  v_exp_f32_e64 v85, v85
  v_mfma_f32_16x16x32_bf16 a[212:215], a[216:219], v[124:127], a[212:215]
  v_exp_f32_e64 v86, v86
  v_mfma_f32_16x16x32_bf16 v[144:147], a[144:147], v[124:127], v[144:147]
  v_cvt_pk_bf16_f32 v106, v84, v85
  v_mfma_f32_16x16x32_bf16 v[164:167], a[148:151], v[124:127], v[164:167]
  v_exp_f32_e64 v87, v87
  v_mfma_f32_16x16x32_bf16 v[184:187], a[152:155], v[124:127], v[184:187]
  v_cvt_pk_bf16_f32 v107, v86, v87
  v_mfma_f32_16x16x32_bf16 v[204:207], a[156:159], v[124:127], v[204:207]
  ds_write_b128 v208, v[104:107] offset:61440
  v_mfma_f32_16x16x32_bf16 v[144:147], a[160:163], a[192:195], v[144:147]
  v_mfma_f32_16x16x32_bf16 v[164:167], a[164:167], a[192:195], v[164:167]
  v_mfma_f32_16x16x32_bf16 v[184:187], a[168:171], a[192:195], v[184:187]
  v_mfma_f32_16x16x32_bf16 v[204:207], a[172:175], a[192:195], v[204:207]
  s_waitcnt vmcnt(8) lgkmcnt(0)
  s_barrier
  v_mfma_f32_16x16x32_bf16 v[48:51], a[112:115], a[0:3], v[28:31]
  s_nop 0
  ds_read_b64_tr_b16 a[144:145], v8 offset:57344
  s_add_u32 m0, s43, 0x0
  s_add_u32 s51, s49, 131072
  v_mfma_f32_16x16x32_bf16 v[52:55], a[128:131], a[0:3], v[28:31]
  ds_read_b64_tr_b16 a[146:147], v8 offset:61440
  ds_read_b64_tr_b16 a[148:149], v9 offset:57344
  s_and_b32 s51, s51, 0x3ffff
  v_mfma_f32_16x16x32_bf16 v[48:51], a[116:119], a[20:23], v[48:51]
  ds_read_b64_tr_b16 a[150:151], v9 offset:61440
  ds_read_b64_tr_b16 a[152:153], v10 offset:57344
  v_mfma_f32_16x16x32_bf16 v[52:55], a[132:135], a[20:23], v[52:55]
  buffer_load_dwordx4 v16, s[8:11], s51 offen offset:0 nt lds
  ds_read_b64_tr_b16 a[154:155], v10 offset:61440
  v_mfma_f32_16x16x32_bf16 v[48:51], a[120:123], a[40:43], v[48:51]
  ds_read_b64_tr_b16 a[156:157], v11 offset:57344
  ds_read_b64_tr_b16 a[158:159], v11 offset:61440
  v_mfma_f32_16x16x32_bf16 v[52:55], a[136:139], a[40:43], v[52:55]
  ds_read_b128 a[176:179], v209 offset:57344
  ds_read_b64_tr_b16 a[160:161], v12 offset:57344
  v_mfma_f32_16x16x32_bf16 v[48:51], a[124:127], a[60:63], v[48:51]
  ds_read_b64_tr_b16 a[162:163], v12 offset:61440
  ds_read_b64_tr_b16 a[164:165], v13 offset:57344
  v_mfma_f32_16x16x32_bf16 v[52:55], a[140:143], a[60:63], v[52:55]
  ds_read_b64_tr_b16 a[166:167], v13 offset:61440
  ds_read_b64_tr_b16 a[168:169], v14 offset:57344
  v_mfma_f32_16x16x32_bf16 v[56:59], a[112:115], a[4:7], v[32:35]
  ds_read_b64_tr_b16 a[170:171], v14 offset:61440
  ds_read_b64_tr_b16 a[172:173], v15 offset:57344
  v_mfma_f32_16x16x32_bf16 v[60:63], a[128:131], a[4:7], v[32:35]
  buffer_load_dwordx4 v17, s[8:11], s51 offen offset:1024 nt lds
  ds_read_b64_tr_b16 a[174:175], v15 offset:61440
  v_mfma_f32_16x16x32_bf16 v[56:59], a[116:119], a[24:27], v[56:59]
  ds_read_b128 a[180:183], v209 offset:58368
  ds_read_b128 a[184:187], v209 offset:59392
  v_mfma_f32_16x16x32_bf16 v[60:63], a[132:135], a[24:27], v[60:63]
  ds_read_b128 a[188:191], v209 offset:60416
  v_mfma_f32_16x16x32_bf16 v[56:59], a[120:123], a[44:47], v[56:59]
  ds_read_b128 a[192:195], v209 offset:61440
  v_mfma_f32_16x16x32_bf16 v[60:63], a[136:139], a[44:47], v[60:63]
  v_mfma_f32_16x16x32_bf16 v[56:59], a[124:127], a[64:67], v[56:59]
  v_exp_f32_e64 v48, v48
  v_mfma_f32_16x16x32_bf16 v[60:63], a[140:143], a[64:67], v[60:63]
  v_exp_f32_e64 v49, v49
  v_mfma_f32_16x16x32_bf16 v[64:67], a[112:115], a[8:11], v[36:39]
  v_exp_f32_e64 v50, v50
  v_mfma_f32_16x16x32_bf16 v[68:71], a[128:131], a[8:11], v[36:39]
  buffer_load_dwordx4 v18, s[8:11], s51 offen offset:2048 nt lds
  v_cvt_pk_bf16_f32 v108, v48, v49
  v_mfma_f32_16x16x32_bf16 v[64:67], a[116:119], a[28:31], v[64:67]
  v_exp_f32_e64 v51, v51
  v_mfma_f32_16x16x32_bf16 v[68:71], a[132:135], a[28:31], v[68:71]
  v_exp_f32_e64 v52, v52
  v_mfma_f32_16x16x32_bf16 v[64:67], a[120:123], a[48:51], v[64:67]
  v_cvt_pk_bf16_f32 v109, v50, v51
  v_mfma_f32_16x16x32_bf16 v[68:71], a[136:139], a[48:51], v[68:71]
  s_waitcnt lgkmcnt(0)
  s_nop 0
  v_mfma_f32_16x16x32_bf16 v[64:67], a[124:127], a[68:71], v[64:67]
  v_exp_f32_e64 v53, v53
  v_mfma_f32_16x16x32_bf16 v[68:71], a[140:143], a[68:71], v[68:71]
  v_exp_f32_e64 v54, v54
  v_mfma_f32_16x16x32_bf16 a[196:199], a[216:219], v[88:91], a[196:199]
  ds_read_b128 a[80:83], v4 offset:32768
  v_cvt_pk_bf16_f32 v110, v52, v53
  v_mfma_f32_16x16x32_bf16 v[128:131], a[144:147], v[88:91], v[128:131]
  v_exp_f32_e64 v55, v55
  v_mfma_f32_16x16x32_bf16 v[148:151], a[148:151], v[88:91], v[148:151]
  buffer_load_dwordx4 v19, s[8:11], s51 offen offset:3072 nt lds
  v_cvt_pk_bf16_f32 v111, v54, v55
  v_mfma_f32_16x16x32_bf16 v[168:171], a[152:155], v[88:91], v[168:171]
  ds_write_b128 v208, v[108:111] offset:0
  v_mfma_f32_16x16x32_bf16 v[188:191], a[156:159], v[88:91], v[188:191]
  v_exp_f32_e64 v56, v56
  v_mfma_f32_16x16x32_bf16 v[128:131], a[160:163], a[176:179], v[128:131]
  v_exp_f32_e64 v57, v57
  v_mfma_f32_16x16x32_bf16 v[148:151], a[164:167], a[176:179], v[148:151]
  s_add_u32 m0, s43, 65536
  v_exp_f32_e64 v58, v58
  v_mfma_f32_16x16x32_bf16 v[168:171], a[168:171], a[176:179], v[168:171]
  ds_read_b128 a[96:99], v4 offset:36864
  v_cvt_pk_bf16_f32 v112, v56, v57
  v_mfma_f32_16x16x32_bf16 v[188:191], a[172:175], a[176:179], v[188:191]
  s_add_u32 s51, s49, 98304
  v_exp_f32_e64 v59, v59
  v_mfma_f32_16x16x32_bf16 v[72:75], a[112:115], a[12:15], v[40:43]
  s_and_b32 s51, s51, 0x3ffff
  v_exp_f32_e64 v60, v60
  v_mfma_f32_16x16x32_bf16 v[76:79], a[128:131], a[12:15], v[40:43]
  buffer_load_dwordx4 v20, s[12:15], s51 offen offset:0 nt lds
  v_cvt_pk_bf16_f32 v113, v58, v59
  v_mfma_f32_16x16x32_bf16 v[72:75], a[116:119], a[32:35], v[72:75]
  v_exp_f32_e64 v61, v61
  v_mfma_f32_16x16x32_bf16 v[76:79], a[132:135], a[32:35], v[76:79]
  v_exp_f32_e64 v62, v62
  v_mfma_f32_16x16x32_bf16 v[72:75], a[120:123], a[52:55], v[72:75]
  ds_read_b128 a[84:87], v5 offset:32768
  v_cvt_pk_bf16_f32 v114, v60, v61
  v_mfma_f32_16x16x32_bf16 v[76:79], a[136:139], a[52:55], v[76:79]
  v_exp_f32_e64 v63, v63
  v_mfma_f32_16x16x32_bf16 v[72:75], a[124:127], a[72:75], v[72:75]
  v_cvt_pk_bf16_f32 v115, v62, v63
  v_mfma_f32_16x16x32_bf16 v[76:79], a[140:143], a[72:75], v[76:79]
  ds_write_b128 v208, v[112:115] offset:1024
  v_mfma_f32_16x16x32_bf16 a[200:203], a[216:219], v[92:95], a[200:203]
  v_exp_f32_e64 v64, v64
  v_mfma_f32_16x16x32_bf16 v[132:135], a[144:147], v[92:95], v[132:135]
  v_exp_f32_e64 v65, v65
  v_mfma_f32_16x16x32_bf16 v[152:155], a[148:151], v[92:95], v[152:155]
  ds_read_b128 a[100:103], v5 offset:36864
  buffer_load_dwordx4 v21, s[12:15], s51 offen offset:1024 nt lds
  v_mfma_f32_16x16x32_bf16 v[172:175], a[152:155], v[92:95], v[172:175]
  v_exp_f32_e64 v66, v66
  v_mfma_f32_16x16x32_bf16 v[192:195], a[156:159], v[92:95], v[192:195]
  v_cvt_pk_bf16_f32 v116, v64, v65
  v_mfma_f32_16x16x32_bf16 v[132:135], a[160:163], a[180:183], v[132:135]
  v_exp_f32_e64 v67, v67
  v_mfma_f32_16x16x32_bf16 v[152:155], a[164:167], a[180:183], v[152:155]
  v_exp_f32_e64 v68, v68
  v_mfma_f32_16x16x32_bf16 v[172:175], a[168:171], a[180:183], v[172:175]
  ds_read_b128 a[88:91], v6 offset:32768
  v_cvt_pk_bf16_f32 v117, v66, v67
  v_mfma_f32_16x16x32_bf16 v[192:195], a[172:175], a[180:183], v[192:195]
  v_exp_f32_e64 v69, v69
  v_mfma_f32_16x16x32_bf16 v[80:83], a[112:115], a[16:19], v[44:47]
  v_exp_f32_e64 v70, v70
  v_mfma_f32_16x16x32_bf16 v[84:87], a[128:131], a[16:19], v[44:47]
  buffer_load_dwordx4 v20, s[12:15], s51 offen offset:2048 nt lds
  v_cvt_pk_bf16_f32 v118, v68, v69
  v_mfma_f32_16x16x32_bf16 v[80:83], a[116:119], a[36:39], v[80:83]
  v_exp_f32_e64 v71, v71
  v_mfma_f32_16x16x32_bf16 v[84:87], a[132:135], a[36:39], v[84:87]
  ds_read_b128 a[104:107], v6 offset:36864
  v_cvt_pk_bf16_f32 v119, v70, v71
  v_mfma_f32_16x16x32_bf16 v[80:83], a[120:123], a[56:59], v[80:83]
  ds_write_b128 v208, v[116:119] offset:2048
  v_mfma_f32_16x16x32_bf16 v[84:87], a[136:139], a[56:59], v[84:87]
  v_exp_f32_e64 v72, v72
  v_mfma_f32_16x16x32_bf16 v[80:83], a[124:127], a[76:79], v[80:83]
  v_exp_f32_e64 v73, v73
  v_mfma_f32_16x16x32_bf16 v[84:87], a[140:143], a[76:79], v[84:87]
  v_exp_f32_e64 v74, v74
  v_mfma_f32_16x16x32_bf16 a[204:207], a[216:219], v[96:99], a[204:207]
  buffer_load_dwordx4 v21, s[12:15], s51 offen offset:3072 nt lds
  v_cvt_pk_bf16_f32 v120, v72, v73
  v_mfma_f32_16x16x32_bf16 v[136:139], a[144:147], v[96:99], v[136:139]
  v_exp_f32_e64 v75, v75
  v_mfma_f32_16x16x32_bf16 v[156:159], a[148:151], v[96:99], v[156:159]
  v_exp_f32_e64 v76, v76
  v_mfma_f32_16x16x32_bf16 v[176:179], a[152:155], v[96:99], v[176:179]
  ds_read_b128 a[92:95], v7 offset:32768
  v_cvt_pk_bf16_f32 v121, v74, v75
  v_mfma_f32_16x16x32_bf16 v[196:199], a[156:159], v[96:99], v[196:199]
  v_exp_f32_e64 v77, v77
  v_mfma_f32_16x16x32_bf16 v[136:139], a[160:163], a[184:187], v[136:139]
  v_exp_f32_e64 v78, v78
  v_mfma_f32_16x16x32_bf16 v[156:159], a[164:167], a[184:187], v[156:159]
  ds_read_b128 a[108:111], v7 offset:36864
  v_cvt_pk_bf16_f32 v122, v76, v77
  v_mfma_f32_16x16x32_bf16 v[176:179], a[168:171], a[184:187], v[176:179]
  v_exp_f32_e64 v79, v79
  v_mfma_f32_16x16x32_bf16 v[196:199], a[172:175], a[184:187], v[196:199]
  v_cvt_pk_bf16_f32 v123, v78, v79
  v_mfma_f32_16x16x32_bf16 a[208:211], a[216:219], v[100:103], a[208:211]
  ds_write_b128 v208, v[120:123] offset:3072
  v_mfma_f32_16x16x32_bf16 v[140:143], a[144:147], v[100:103], v[140:143]
  v_exp_f32_e64 v80, v80
  v_mfma_f32_16x16x32_bf16 v[160:163], a[148:151], v[100:103], v[160:163]
  v_exp_f32_e64 v81, v81
  v_mfma_f32_16x16x32_bf16 v[180:183], a[152:155], v[100:103], v[180:183]
  v_exp_f32_e64 v82, v82
  v_mfma_f32_16x16x32_bf16 v[200:203], a[156:159], v[100:103], v[200:203]
  v_cvt_pk_bf16_f32 v124, v80, v81
  v_mfma_f32_16x16x32_bf16 v[140:143], a[160:163], a[188:191], v[140:143]
  v_exp_f32_e64 v83, v83
  v_mfma_f32_16x16x32_bf16 v[160:163], a[164:167], a[188:191], v[160:163]
  v_exp_f32_e64 v84, v84
  v_mfma_f32_16x16x32_bf16 v[180:183], a[168:171], a[188:191], v[180:183]
  v_cvt_pk_bf16_f32 v125, v82, v83
  v_mfma_f32_16x16x32_bf16 v[200:203], a[172:175], a[188:191], v[200:203]
  v_exp_f32_e64 v85, v85
  v_mfma_f32_16x16x32_bf16 a[212:215], a[216:219], v[104:107], a[212:215]
  v_exp_f32_e64 v86, v86
  v_mfma_f32_16x16x32_bf16 v[144:147], a[144:147], v[104:107], v[144:147]
  v_cvt_pk_bf16_f32 v126, v84, v85
  v_mfma_f32_16x16x32_bf16 v[164:167], a[148:151], v[104:107], v[164:167]
  v_exp_f32_e64 v87, v87
  v_mfma_f32_16x16x32_bf16 v[184:187], a[152:155], v[104:107], v[184:187]
  v_cvt_pk_bf16_f32 v127, v86, v87
  v_mfma_f32_16x16x32_bf16 v[204:207], a[156:159], v[104:107], v[204:207]
  ds_write_b128 v208, v[124:127] offset:4096
  v_mfma_f32_16x16x32_bf16 v[144:147], a[160:163], a[192:195], v[144:147]
  v_mfma_f32_16x16x32_bf16 v[164:167], a[164:167], a[192:195], v[164:167]
  v_mfma_f32_16x16x32_bf16 v[184:187], a[168:171], a[192:195], v[184:187]
  v_mfma_f32_16x16x32_bf16 v[204:207], a[172:175], a[192:195], v[204:207]
  s_waitcnt vmcnt(8) lgkmcnt(0)
  s_barrier
  v_mfma_f32_16x16x32_bf16 v[48:51], a[80:83], a[0:3], v[28:31]
  ds_read_b64_tr_b16 a[144:145], v8 offset:40960
  s_add_u32 m0, s43, 16384
  s_add_u32 s51, s49, 147456
  v_mfma_f32_16x16x32_bf16 v[52:55], a[96:99], a[0:3], v[28:31]
  ds_read_b64_tr_b16 a[146:147], v8 offset:45056
  ds_read_b64_tr_b16 a[148:149], v9 offset:40960
  s_and_b32 s51, s51, 0x3ffff
  v_mfma_f32_16x16x32_bf16 v[48:51], a[84:87], a[20:23], v[48:51]
  ds_read_b64_tr_b16 a[150:151], v9 offset:45056
  ds_read_b64_tr_b16 a[152:153], v10 offset:40960
  v_mfma_f32_16x16x32_bf16 v[52:55], a[100:103], a[20:23], v[52:55]
  buffer_load_dwordx4 v16, s[8:11], s51 offen offset:0 nt lds
  ds_read_b64_tr_b16 a[154:155], v10 offset:45056
  v_mfma_f32_16x16x32_bf16 v[48:51], a[88:91], a[40:43], v[48:51]
  ds_read_b64_tr_b16 a[156:157], v11 offset:40960
  ds_read_b64_tr_b16 a[158:159], v11 offset:45056
  v_mfma_f32_16x16x32_bf16 v[52:55], a[104:107], a[40:43], v[52:55]
  ds_read_b128 a[176:179], v209 offset:0
  ds_read_b64_tr_b16 a[160:161], v12 offset:40960
  v_mfma_f32_16x16x32_bf16 v[48:51], a[92:95], a[60:63], v[48:51]
  ds_read_b64_tr_b16 a[162:163], v12 offset:45056
  ds_read_b64_tr_b16 a[164:165], v13 offset:40960
  v_mfma_f32_16x16x32_bf16 v[52:55], a[108:111], a[60:63], v[52:55]
  ds_read_b64_tr_b16 a[166:167], v13 offset:45056
  ds_read_b64_tr_b16 a[168:169], v14 offset:40960
  v_mfma_f32_16x16x32_bf16 v[56:59], a[80:83], a[4:7], v[32:35]
  ds_read_b64_tr_b16 a[170:171], v14 offset:45056
  buffer_load_dwordx4 v17, s[8:11], s51 offen offset:1024 nt lds
  v_mfma_f32_16x16x32_bf16 v[60:63], a[96:99], a[4:7], v[32:35]
  ds_read_b64_tr_b16 a[172:173], v15 offset:40960
  ds_read_b64_tr_b16 a[174:175], v15 offset:45056
  v_mfma_f32_16x16x32_bf16 v[56:59], a[84:87], a[24:27], v[56:59]
  ds_read_b128 a[180:183], v209 offset:1024
  ds_read_b128 a[184:187], v209 offset:2048
  v_mfma_f32_16x16x32_bf16 v[60:63], a[100:103], a[24:27], v[60:63]
  ds_read_b128 a[188:191], v209 offset:3072
  v_mfma_f32_16x16x32_bf16 v[56:59], a[88:91], a[44:47], v[56:59]
  ds_read_b128 a[192:195], v209 offset:4096
  v_mfma_f32_16x16x32_bf16 v[60:63], a[104:107], a[44:47], v[60:63]
  v_mfma_f32_16x16x32_bf16 v[56:59], a[92:95], a[64:67], v[56:59]
  v_exp_f32_e64 v48, v48
  v_mfma_f32_16x16x32_bf16 v[60:63], a[108:111], a[64:67], v[60:63]
  v_exp_f32_e64 v49, v49
  v_mfma_f32_16x16x32_bf16 v[64:67], a[80:83], a[8:11], v[36:39]
  buffer_load_dwordx4 v18, s[8:11], s51 offen offset:2048 nt lds
  v_mfma_f32_16x16x32_bf16 v[68:71], a[96:99], a[8:11], v[36:39]
  v_exp_f32_e64 v50, v50
  v_mfma_f32_16x16x32_bf16 v[64:67], a[84:87], a[28:31], v[64:67]
  v_cvt_pk_bf16_f32 v88, v48, v49
  v_mfma_f32_16x16x32_bf16 v[68:71], a[100:103], a[28:31], v[68:71]
  v_exp_f32_e64 v51, v51
  v_mfma_f32_16x16x32_bf16 v[64:67], a[88:91], a[48:51], v[64:67]
  v_exp_f32_e64 v52, v52
  v_mfma_f32_16x16x32_bf16 v[68:71], a[104:107], a[48:51], v[68:71]
  s_waitcnt lgkmcnt(0)
  s_nop 0
  v_cvt_pk_bf16_f32 v89, v50, v51
  v_mfma_f32_16x16x32_bf16 v[64:67], a[92:95], a[68:71], v[64:67]
  v_exp_f32_e64 v53, v53
  v_mfma_f32_16x16x32_bf16 v[68:71], a[108:111], a[68:71], v[68:71]
  v_exp_f32_e64 v54, v54
  v_mfma_f32_16x16x32_bf16 a[196:199], a[216:219], v[108:111], a[196:199]
  buffer_load_dwordx4 v19, s[8:11], s51 offen offset:3072 nt lds
  v_cvt_pk_bf16_f32 v90, v52, v53
  v_mfma_f32_16x16x32_bf16 v[128:131], a[144:147], v[108:111], v[128:131]
  v_exp_f32_e64 v55, v55
  v_mfma_f32_16x16x32_bf16 v[148:151], a[148:151], v[108:111], v[148:151]
  ds_read_b128 a[112:115], v4 offset:49152
  v_cvt_pk_bf16_f32 v91, v54, v55
  v_mfma_f32_16x16x32_bf16 v[168:171], a[152:155], v[108:111], v[168:171]
  ds_write_b128 v208, v[88:91] offset:57344
  v_mfma_f32_16x16x32_bf16 v[188:191], a[156:159], v[108:111], v[188:191]
  s_add_u32 m0, s43, 122880
  v_exp_f32_e64 v56, v56
  v_mfma_f32_16x16x32_bf16 v[128:131], a[160:163], a[176:179], v[128:131]
  s_add_u32 s51, s49, 114688
  v_exp_f32_e64 v57, v57
  v_mfma_f32_16x16x32_bf16 v[148:151], a[164:167], a[176:179], v[148:151]
  s_and_b32 s51, s51, 0x3ffff
  v_exp_f32_e64 v58, v58
  v_mfma_f32_16x16x32_bf16 v[168:171], a[168:171], a[176:179], v[168:171]
  ds_read_b128 a[128:131], v4 offset:53248
  v_cvt_pk_bf16_f32 v92, v56, v57
  v_mfma_f32_16x16x32_bf16 v[188:191], a[172:175], a[176:179], v[188:191]
  v_exp_f32_e64 v59, v59
  v_mfma_f32_16x16x32_bf16 v[72:75], a[80:83], a[12:15], v[40:43]
  buffer_load_dwordx4 v20, s[12:15], s51 offen offset:0 nt lds
  v_mfma_f32_16x16x32_bf16 v[76:79], a[96:99], a[12:15], v[40:43]
  v_exp_f32_e64 v60, v60
  v_mfma_f32_16x16x32_bf16 v[72:75], a[84:87], a[32:35], v[72:75]
  ds_read_b128 a[116:119], v5 offset:49152
  v_cvt_pk_bf16_f32 v93, v58, v59
  v_mfma_f32_16x16x32_bf16 v[76:79], a[100:103], a[32:35], v[76:79]
  v_exp_f32_e64 v61, v61
  v_mfma_f32_16x16x32_bf16 v[72:75], a[88:91], a[52:55], v[72:75]
  v_exp_f32_e64 v62, v62
  v_mfma_f32_16x16x32_bf16 v[76:79], a[104:107], a[52:55], v[76:79]
  buffer_load_dwordx4 v21, s[12:15], s51 offen offset:1024 nt lds
  v_cvt_pk_bf16_f32 v94, v60, v61
  v_mfma_f32_16x16x32_bf16 v[72:75], a[92:95], a[72:75], v[72:75]
  v_exp_f32_e64 v63, v63
  v_mfma_f32_16x16x32_bf16 v[76:79], a[108:111], a[72:75], v[76:79]
  ds_read_b128 a[132:135], v5 offset:53248
  v_cvt_pk_bf16_f32 v95, v62, v63
  v_mfma_f32_16x16x32_bf16 a[200:203], a[216:219], v[112:115], a[200:203]
  ds_write_b128 v208, v[92:95] offset:58368
  v_mfma_f32_16x16x32_bf16 v[132:135], a[144:147], v[112:115], v[132:135]
  v_exp_f32_e64 v64, v64
  v_mfma_f32_16x16x32_bf16 v[152:155], a[148:151], v[112:115], v[152:155]
  v_exp_f32_e64 v65, v65
  v_mfma_f32_16x16x32_bf16 v[172:175], a[152:155], v[112:115], v[172:175]
  v_exp_f32_e64 v66, v66
  v_mfma_f32_16x16x32_bf16 v[192:195], a[156:159], v[112:115], v[192:195]
  buffer_load_dwordx4 v20, s[12:15], s51 offen offset:2048 nt lds
  v_cvt_pk_bf16_f32 v96, v64, v65
  v_mfma_f32_16x16x32_bf16 v[132:135], a[160:163], a[180:183], v[132:135]
  v_exp_f32_e64 v67, v67
  v_mfma_f32_16x16x32_bf16 v[152:155], a[164:167], a[180:183], v[152:155]
  v_exp_f32_e64 v68, v68
  v_mfma_f32_16x16x32_bf16 v[172:175], a[168:171], a[180:183], v[172:175]
  ds_read_b128 a[120:123], v6 offset:49152
  v_cvt_pk_bf16_f32 v97, v66, v67
  v_mfma_f32_16x16x32_bf16 v[192:195], a[172:175], a[180:183], v[192:195]
  v_exp_f32_e64 v69, v69
  v_mfma_f32_16x16x32_bf16 v[80:83], a[80:83], a[16:19], v[44:47]
  v_exp_f32_e64 v70, v70
  v_mfma_f32_16x16x32_bf16 v[84:87], a[96:99], a[16:19], v[44:47]
  buffer_load_dwordx4 v21, s[12:15], s51 offen offset:3072 nt lds
  v_cvt_pk_bf16_f32 v98, v68, v69
  v_mfma_f32_16x16x32_bf16 v[80:83], a[84:87], a[36:39], v[80:83]
  v_exp_f32_e64 v71, v71
  v_mfma_f32_16x16x32_bf16 v[84:87], a[100:103], a[36:39], v[84:87]
  ds_read_b128 a[136:139], v6 offset:53248
  v_cvt_pk_bf16_f32 v99, v70, v71
  v_mfma_f32_16x16x32_bf16 v[80:83], a[88:91], a[56:59], v[80:83]
  ds_write_b128 v208, v[96:99] offset:59392
  v_mfma_f32_16x16x32_bf16 v[84:87], a[104:107], a[56:59], v[84:87]
  v_exp_f32_e64 v72, v72
  v_mfma_f32_16x16x32_bf16 v[80:83], a[92:95], a[76:79], v[80:83]
  v_exp_f32_e64 v73, v73
  v_mfma_f32_16x16x32_bf16 v[84:87], a[108:111], a[76:79], v[84:87]
  v_exp_f32_e64 v74, v74
  v_mfma_f32_16x16x32_bf16 a[204:207], a[216:219], v[116:119], a[204:207]
  ds_read_b128 a[124:127], v7 offset:49152
  v_cvt_pk_bf16_f32 v100, v72, v73
  v_mfma_f32_16x16x32_bf16 v[136:139], a[144:147], v[116:119], v[136:139]
  v_exp_f32_e64 v75, v75
  v_mfma_f32_16x16x32_bf16 v[156:159], a[148:151], v[116:119], v[156:159]
  v_mov_b32 v3, 0
  v_mov_b32_e64 v23, 1
  s_lshl_b32 s39, s52, 2
  s_or_b32 s38, s48, s32
  s_cmp_eq_u32 s38, 0
  s_cselect_b32 s70, 1, 0
  s_mov_b32 s71, 0
  s_mov_b64 exec, s[70:71]
  buffer_store_dword v23, v3, s[56:59], s39 offen offset:64 sc1
  s_mov_b64 exec, -1
  v_mfma_f32_16x16x32_bf16 v[176:179], a[152:155], v[116:119], v[176:179]
  v_exp_f32_e64 v76, v76
  v_mfma_f32_16x16x32_bf16 v[196:199], a[156:159], v[116:119], v[196:199]
  v_cvt_pk_bf16_f32 v101, v74, v75
  v_mfma_f32_16x16x32_bf16 v[136:139], a[160:163], a[184:187], v[136:139]
  v_exp_f32_e64 v77, v77
  v_mfma_f32_16x16x32_bf16 v[156:159], a[164:167], a[184:187], v[156:159]
  v_exp_f32_e64 v78, v78
  v_mfma_f32_16x16x32_bf16 v[176:179], a[168:171], a[184:187], v[176:179]
  ds_read_b128 a[140:143], v7 offset:53248
  v_cvt_pk_bf16_f32 v102, v76, v77
  v_mfma_f32_16x16x32_bf16 v[196:199], a[172:175], a[184:187], v[196:199]
  v_exp_f32_e64 v79, v79
  v_mfma_f32_16x16x32_bf16 a[208:211], a[216:219], v[120:123], a[208:211]
  v_cvt_pk_bf16_f32 v103, v78, v79
  v_mfma_f32_16x16x32_bf16 v[140:143], a[144:147], v[120:123], v[140:143]
  ds_write_b128 v208, v[100:103] offset:60416
  v_mfma_f32_16x16x32_bf16 v[160:163], a[148:151], v[120:123], v[160:163]
  v_exp_f32_e64 v80, v80
  v_mfma_f32_16x16x32_bf16 v[180:183], a[152:155], v[120:123], v[180:183]
  v_exp_f32_e64 v81, v81
  v_mfma_f32_16x16x32_bf16 v[200:203], a[156:159], v[120:123], v[200:203]
  v_exp_f32_e64 v82, v82
  v_mfma_f32_16x16x32_bf16 v[140:143], a[160:163], a[188:191], v[140:143]
  v_cvt_pk_bf16_f32 v104, v80, v81
  v_mfma_f32_16x16x32_bf16 v[160:163], a[164:167], a[188:191], v[160:163]
  v_exp_f32_e64 v83, v83
  v_mfma_f32_16x16x32_bf16 v[180:183], a[168:171], a[188:191], v[180:183]
  v_exp_f32_e64 v84, v84
  v_mfma_f32_16x16x32_bf16 v[200:203], a[172:175], a[188:191], v[200:203]
  v_cvt_pk_bf16_f32 v105, v82, v83
  v_mfma_f32_16x16x32_bf16 a[212:215], a[216:219], v[124:127], a[212:215]
  v_exp_f32_e64 v85, v85
  v_mfma_f32_16x16x32_bf16 v[144:147], a[144:147], v[124:127], v[144:147]
  v_exp_f32_e64 v86, v86
  v_mfma_f32_16x16x32_bf16 v[164:167], a[148:151], v[124:127], v[164:167]
  v_cvt_pk_bf16_f32 v106, v84, v85
  v_mfma_f32_16x16x32_bf16 v[184:187], a[152:155], v[124:127], v[184:187]
  v_exp_f32_e64 v87, v87
  v_mfma_f32_16x16x32_bf16 v[204:207], a[156:159], v[124:127], v[204:207]
  v_cvt_pk_bf16_f32 v107, v86, v87
  v_mfma_f32_16x16x32_bf16 v[144:147], a[160:163], a[192:195], v[144:147]
  ds_write_b128 v208, v[104:107] offset:61440
  v_mfma_f32_16x16x32_bf16 v[164:167], a[164:167], a[192:195], v[164:167]
  v_mfma_f32_16x16x32_bf16 v[184:187], a[168:171], a[192:195], v[184:187]
  v_mfma_f32_16x16x32_bf16 v[204:207], a[172:175], a[192:195], v[204:207]
  s_waitcnt vmcnt(9) lgkmcnt(0)
  s_barrier
  v_mfma_f32_16x16x32_bf16 v[48:51], a[112:115], a[0:3], v[28:31]
  ds_read_b64_tr_b16 a[144:145], v8 offset:0
  s_add_u32 m0, s43, 32768
  s_add_u32 s51, s49, 163840
  v_mfma_f32_16x16x32_bf16 v[52:55], a[128:131], a[0:3], v[28:31]
  ds_read_b64_tr_b16 a[146:147], v8 offset:4096
  ds_read_b64_tr_b16 a[148:149], v9 offset:0
  s_and_b32 s51, s51, 0x3ffff
  v_mfma_f32_16x16x32_bf16 v[48:51], a[116:119], a[20:23], v[48:51]
  ds_read_b64_tr_b16 a[150:151], v9 offset:4096
  ds_read_b64_tr_b16 a[152:153], v10 offset:0
  v_mfma_f32_16x16x32_bf16 v[52:55], a[132:135], a[20:23], v[52:55]
  buffer_load_dwordx4 v16, s[8:11], s51 offen offset:0 nt lds
  ds_read_b64_tr_b16 a[154:155], v10 offset:4096
  v_mfma_f32_16x16x32_bf16 v[48:51], a[120:123], a[40:43], v[48:51]
  ds_read_b64_tr_b16 a[156:157], v11 offset:0
  ds_read_b64_tr_b16 a[158:159], v11 offset:4096
  v_mfma_f32_16x16x32_bf16 v[52:55], a[136:139], a[40:43], v[52:55]
  ds_read_b128 a[176:179], v209 offset:57344
  ds_read_b64_tr_b16 a[160:161], v12 offset:0
  v_mfma_f32_16x16x32_bf16 v[48:51], a[124:127], a[60:63], v[48:51]
  ds_read_b64_tr_b16 a[162:163], v12 offset:4096
  ds_read_b64_tr_b16 a[164:165], v13 offset:0
  v_mfma_f32_16x16x32_bf16 v[52:55], a[140:143], a[60:63], v[52:55]
  ds_read_b64_tr_b16 a[166:167], v13 offset:4096
  ds_read_b64_tr_b16 a[168:169], v14 offset:0
  v_mfma_f32_16x16x32_bf16 v[56:59], a[112:115], a[4:7], v[32:35]
  ds_read_b64_tr_b16 a[170:171], v14 offset:4096
  ds_read_b64_tr_b16 a[172:173], v15 offset:0
  v_mfma_f32_16x16x32_bf16 v[60:63], a[128:131], a[4:7], v[32:35]
  buffer_load_dwordx4 v17, s[8:11], s51 offen offset:1024 nt lds
  ds_read_b64_tr_b16 a[174:175], v15 offset:4096
  v_mfma_f32_16x16x32_bf16 v[56:59], a[116:119], a[24:27], v[56:59]
  ds_read_b128 a[180:183], v209 offset:58368
  ds_read_b128 a[184:187], v209 offset:59392
  v_mfma_f32_16x16x32_bf16 v[60:63], a[132:135], a[24:27], v[60:63]
  ds_read_b128 a[188:191], v209 offset:60416
  v_mfma_f32_16x16x32_bf16 v[56:59], a[120:123], a[44:47], v[56:59]
  ds_read_b128 a[192:195], v209 offset:61440
  v_mfma_f32_16x16x32_bf16 v[60:63], a[136:139], a[44:47], v[60:63]
  v_mfma_f32_16x16x32_bf16 v[56:59], a[124:127], a[64:67], v[56:59]
  v_exp_f32_e64 v48, v48
  v_mfma_f32_16x16x32_bf16 v[60:63], a[140:143], a[64:67], v[60:63]
  v_exp_f32_e64 v49, v49
  v_mfma_f32_16x16x32_bf16 v[64:67], a[112:115], a[8:11], v[36:39]
  v_exp_f32_e64 v50, v50
  v_mfma_f32_16x16x32_bf16 v[68:71], a[128:131], a[8:11], v[36:39]
  buffer_load_dwordx4 v18, s[8:11], s51 offen offset:2048 nt lds
  v_cvt_pk_bf16_f32 v108, v48, v49
  v_mfma_f32_16x16x32_bf16 v[64:67], a[116:119], a[28:31], v[64:67]
  v_exp_f32_e64 v51, v51
  v_mfma_f32_16x16x32_bf16 v[68:71], a[132:135], a[28:31], v[68:71]
  v_exp_f32_e64 v52, v52
  v_mfma_f32_16x16x32_bf16 v[64:67], a[120:123], a[48:51], v[64:67]
  v_cvt_pk_bf16_f32 v109, v50, v51
  v_mfma_f32_16x16x32_bf16 v[68:71], a[136:139], a[48:51], v[68:71]
  s_waitcnt lgkmcnt(0)
  s_nop 0
  v_mfma_f32_16x16x32_bf16 v[64:67], a[124:127], a[68:71], v[64:67]
  v_exp_f32_e64 v53, v53
  v_mfma_f32_16x16x32_bf16 v[68:71], a[140:143], a[68:71], v[68:71]
  v_exp_f32_e64 v54, v54
  v_mfma_f32_16x16x32_bf16 a[196:199], a[216:219], v[88:91], a[196:199]
  ds_read_b128 a[80:83], v4 offset:0
  v_cvt_pk_bf16_f32 v110, v52, v53
  v_mfma_f32_16x16x32_bf16 v[128:131], a[144:147], v[88:91], v[128:131]
  v_exp_f32_e64 v55, v55
  v_mfma_f32_16x16x32_bf16 v[148:151], a[148:151], v[88:91], v[148:151]
  buffer_load_dwordx4 v19, s[8:11], s51 offen offset:3072 nt lds
  v_cvt_pk_bf16_f32 v111, v54, v55
  v_mfma_f32_16x16x32_bf16 v[168:171], a[152:155], v[88:91], v[168:171]
  ds_write_b128 v208, v[108:111] offset:0
  v_mfma_f32_16x16x32_bf16 v[188:191], a[156:159], v[88:91], v[188:191]
  v_exp_f32_e64 v56, v56
  v_mfma_f32_16x16x32_bf16 v[128:131], a[160:163], a[176:179], v[128:131]
  v_exp_f32_e64 v57, v57
  v_mfma_f32_16x16x32_bf16 v[148:151], a[164:167], a[176:179], v[148:151]
  s_add_u32 m0, s43, 106496
  v_exp_f32_e64 v58, v58
  v_mfma_f32_16x16x32_bf16 v[168:171], a[168:171], a[176:179], v[168:171]
  ds_read_b128 a[96:99], v4 offset:4096
  v_cvt_pk_bf16_f32 v112, v56, v57
  v_mfma_f32_16x16x32_bf16 v[188:191], a[172:175], a[176:179], v[188:191]
  s_add_u32 s51, s49, 131072
  v_exp_f32_e64 v59, v59
  v_mfma_f32_16x16x32_bf16 v[72:75], a[112:115], a[12:15], v[40:43]
  s_and_b32 s51, s51, 0x3ffff
  v_exp_f32_e64 v60, v60
  v_mfma_f32_16x16x32_bf16 v[76:79], a[128:131], a[12:15], v[40:43]
  buffer_load_dwordx4 v20, s[12:15], s51 offen offset:0 nt lds
  v_cvt_pk_bf16_f32 v113, v58, v59
  v_mfma_f32_16x16x32_bf16 v[72:75], a[116:119], a[32:35], v[72:75]
  v_exp_f32_e64 v61, v61
  v_mfma_f32_16x16x32_bf16 v[76:79], a[132:135], a[32:35], v[76:79]
  v_exp_f32_e64 v62, v62
  v_mfma_f32_16x16x32_bf16 v[72:75], a[120:123], a[52:55], v[72:75]
  ds_read_b128 a[84:87], v5 offset:0
  v_cvt_pk_bf16_f32 v114, v60, v61
  v_mfma_f32_16x16x32_bf16 v[76:79], a[136:139], a[52:55], v[76:79]
  v_exp_f32_e64 v63, v63
  v_mfma_f32_16x16x32_bf16 v[72:75], a[124:127], a[72:75], v[72:75]
  v_cvt_pk_bf16_f32 v115, v62, v63
  v_mfma_f32_16x16x32_bf16 v[76:79], a[140:143], a[72:75], v[76:79]
  ds_write_b128 v208, v[112:115] offset:1024
  v_mfma_f32_16x16x32_bf16 a[200:203], a[216:219], v[92:95], a[200:203]
  v_exp_f32_e64 v64, v64
  v_mfma_f32_16x16x32_bf16 v[132:135], a[144:147], v[92:95], v[132:135]
  v_exp_f32_e64 v65, v65
  v_mfma_f32_16x16x32_bf16 v[152:155], a[148:151], v[92:95], v[152:155]
  ds_read_b128 a[100:103], v5 offset:4096
  buffer_load_dwordx4 v21, s[12:15], s51 offen offset:1024 nt lds
  v_mfma_f32_16x16x32_bf16 v[172:175], a[152:155], v[92:95], v[172:175]
  v_exp_f32_e64 v66, v66
  v_mfma_f32_16x16x32_bf16 v[192:195], a[156:159], v[92:95], v[192:195]
  v_cvt_pk_bf16_f32 v116, v64, v65
  v_mfma_f32_16x16x32_bf16 v[132:135], a[160:163], a[180:183], v[132:135]
  v_exp_f32_e64 v67, v67
  v_mfma_f32_16x16x32_bf16 v[152:155], a[164:167], a[180:183], v[152:155]
  v_exp_f32_e64 v68, v68
  v_mfma_f32_16x16x32_bf16 v[172:175], a[168:171], a[180:183], v[172:175]
  ds_read_b128 a[88:91], v6 offset:0
  v_cvt_pk_bf16_f32 v117, v66, v67
  v_mfma_f32_16x16x32_bf16 v[192:195], a[172:175], a[180:183], v[192:195]
  v_exp_f32_e64 v69, v69
  v_mfma_f32_16x16x32_bf16 v[80:83], a[112:115], a[16:19], v[44:47]
  v_exp_f32_e64 v70, v70
  v_mfma_f32_16x16x32_bf16 v[84:87], a[128:131], a[16:19], v[44:47]
  buffer_load_dwordx4 v20, s[12:15], s51 offen offset:2048 nt lds
  v_cvt_pk_bf16_f32 v118, v68, v69
  v_mfma_f32_16x16x32_bf16 v[80:83], a[116:119], a[36:39], v[80:83]
  v_exp_f32_e64 v71, v71
  v_mfma_f32_16x16x32_bf16 v[84:87], a[132:135], a[36:39], v[84:87]
  ds_read_b128 a[104:107], v6 offset:4096
  v_cvt_pk_bf16_f32 v119, v70, v71
  v_mfma_f32_16x16x32_bf16 v[80:83], a[120:123], a[56:59], v[80:83]
  ds_write_b128 v208, v[116:119] offset:2048
  v_mfma_f32_16x16x32_bf16 v[84:87], a[136:139], a[56:59], v[84:87]
  v_exp_f32_e64 v72, v72
  v_mfma_f32_16x16x32_bf16 v[80:83], a[124:127], a[76:79], v[80:83]
  v_exp_f32_e64 v73, v73
  v_mfma_f32_16x16x32_bf16 v[84:87], a[140:143], a[76:79], v[84:87]
  v_exp_f32_e64 v74, v74
  v_mfma_f32_16x16x32_bf16 a[204:207], a[216:219], v[96:99], a[204:207]
  buffer_load_dwordx4 v21, s[12:15], s51 offen offset:3072 nt lds
  v_cvt_pk_bf16_f32 v120, v72, v73
  v_mfma_f32_16x16x32_bf16 v[136:139], a[144:147], v[96:99], v[136:139]
  v_exp_f32_e64 v75, v75
  v_mfma_f32_16x16x32_bf16 v[156:159], a[148:151], v[96:99], v[156:159]
  v_exp_f32_e64 v76, v76
  v_mfma_f32_16x16x32_bf16 v[176:179], a[152:155], v[96:99], v[176:179]
  ds_read_b128 a[92:95], v7 offset:0
  v_cvt_pk_bf16_f32 v121, v74, v75
  v_mfma_f32_16x16x32_bf16 v[196:199], a[156:159], v[96:99], v[196:199]
  v_exp_f32_e64 v77, v77
  v_mfma_f32_16x16x32_bf16 v[136:139], a[160:163], a[184:187], v[136:139]
  v_exp_f32_e64 v78, v78
  v_mfma_f32_16x16x32_bf16 v[156:159], a[164:167], a[184:187], v[156:159]
  ds_read_b128 a[108:111], v7 offset:4096
  v_cvt_pk_bf16_f32 v122, v76, v77
  v_mfma_f32_16x16x32_bf16 v[176:179], a[168:171], a[184:187], v[176:179]
  v_exp_f32_e64 v79, v79
  v_mfma_f32_16x16x32_bf16 v[196:199], a[172:175], a[184:187], v[196:199]
  v_cvt_pk_bf16_f32 v123, v78, v79
  v_mfma_f32_16x16x32_bf16 a[208:211], a[216:219], v[100:103], a[208:211]
  ds_write_b128 v208, v[120:123] offset:3072
  v_mfma_f32_16x16x32_bf16 v[140:143], a[144:147], v[100:103], v[140:143]
  v_exp_f32_e64 v80, v80
  v_mfma_f32_16x16x32_bf16 v[160:163], a[148:151], v[100:103], v[160:163]
  v_exp_f32_e64 v81, v81
  v_mfma_f32_16x16x32_bf16 v[180:183], a[152:155], v[100:103], v[180:183]
  v_exp_f32_e64 v82, v82
  v_mfma_f32_16x16x32_bf16 v[200:203], a[156:159], v[100:103], v[200:203]
  v_cvt_pk_bf16_f32 v124, v80, v81
  v_mfma_f32_16x16x32_bf16 v[140:143], a[160:163], a[188:191], v[140:143]
  v_exp_f32_e64 v83, v83
  v_mfma_f32_16x16x32_bf16 v[160:163], a[164:167], a[188:191], v[160:163]
  v_exp_f32_e64 v84, v84
  v_mfma_f32_16x16x32_bf16 v[180:183], a[168:171], a[188:191], v[180:183]
  v_cvt_pk_bf16_f32 v125, v82, v83
  v_mfma_f32_16x16x32_bf16 v[200:203], a[172:175], a[188:191], v[200:203]
  v_exp_f32_e64 v85, v85
  v_mfma_f32_16x16x32_bf16 a[212:215], a[216:219], v[104:107], a[212:215]
  v_exp_f32_e64 v86, v86
  v_mfma_f32_16x16x32_bf16 v[144:147], a[144:147], v[104:107], v[144:147]
  v_cvt_pk_bf16_f32 v126, v84, v85
  v_mfma_f32_16x16x32_bf16 v[164:167], a[148:151], v[104:107], v[164:167]
  v_exp_f32_e64 v87, v87
  v_mfma_f32_16x16x32_bf16 v[184:187], a[152:155], v[104:107], v[184:187]
  v_cvt_pk_bf16_f32 v127, v86, v87
  v_mfma_f32_16x16x32_bf16 v[204:207], a[156:159], v[104:107], v[204:207]
  ds_write_b128 v208, v[124:127] offset:4096
  v_mfma_f32_16x16x32_bf16 v[144:147], a[160:163], a[192:195], v[144:147]
  v_mfma_f32_16x16x32_bf16 v[164:167], a[164:167], a[192:195], v[164:167]
  v_mfma_f32_16x16x32_bf16 v[184:187], a[168:171], a[192:195], v[184:187]
  v_mfma_f32_16x16x32_bf16 v[204:207], a[172:175], a[192:195], v[204:207]
  s_waitcnt vmcnt(9) lgkmcnt(0)
  s_barrier
  v_mfma_f32_16x16x32_bf16 v[48:51], a[80:83], a[0:3], v[28:31]
  ds_read_b64_tr_b16 a[144:145], v8 offset:57344
  s_add_u32 m0, s43, 49152
  s_add_u32 s51, s49, 180224
  v_mfma_f32_16x16x32_bf16 v[52:55], a[96:99], a[0:3], v[28:31]
  ds_read_b64_tr_b16 a[146:147], v8 offset:61440
  ds_read_b64_tr_b16 a[148:149], v9 offset:57344
  s_and_b32 s51, s51, 0x3ffff
  v_mfma_f32_16x16x32_bf16 v[48:51], a[84:87], a[20:23], v[48:51]
  ds_read_b64_tr_b16 a[150:151], v9 offset:61440
  ds_read_b64_tr_b16 a[152:153], v10 offset:57344
  v_mfma_f32_16x16x32_bf16 v[52:55], a[100:103], a[20:23], v[52:55]
  buffer_load_dwordx4 v16, s[8:11], s51 offen offset:0 nt lds
  ds_read_b64_tr_b16 a[154:155], v10 offset:61440
  v_mfma_f32_16x16x32_bf16 v[48:51], a[88:91], a[40:43], v[48:51]
  ds_read_b64_tr_b16 a[156:157], v11 offset:57344
  ds_read_b64_tr_b16 a[158:159], v11 offset:61440
  v_mfma_f32_16x16x32_bf16 v[52:55], a[104:107], a[40:43], v[52:55]
  ds_read_b128 a[176:179], v209 offset:0
  ds_read_b64_tr_b16 a[160:161], v12 offset:57344
  v_mfma_f32_16x16x32_bf16 v[48:51], a[92:95], a[60:63], v[48:51]
  ds_read_b64_tr_b16 a[162:163], v12 offset:61440
  ds_read_b64_tr_b16 a[164:165], v13 offset:57344
  v_mfma_f32_16x16x32_bf16 v[52:55], a[108:111], a[60:63], v[52:55]
  ds_read_b64_tr_b16 a[166:167], v13 offset:61440
  ds_read_b64_tr_b16 a[168:169], v14 offset:57344
  v_mfma_f32_16x16x32_bf16 v[56:59], a[80:83], a[4:7], v[32:35]
  ds_read_b64_tr_b16 a[170:171], v14 offset:61440
  ds_read_b64_tr_b16 a[172:173], v15 offset:57344
  v_mfma_f32_16x16x32_bf16 v[60:63], a[96:99], a[4:7], v[32:35]
  buffer_load_dwordx4 v17, s[8:11], s51 offen offset:1024 nt lds
  ds_read_b64_tr_b16 a[174:175], v15 offset:61440
  v_mfma_f32_16x16x32_bf16 v[56:59], a[84:87], a[24:27], v[56:59]
  ds_read_b128 a[180:183], v209 offset:1024
  ds_read_b128 a[184:187], v209 offset:2048
  v_mfma_f32_16x16x32_bf16 v[60:63], a[100:103], a[24:27], v[60:63]
  ds_read_b128 a[188:191], v209 offset:3072
  v_mfma_f32_16x16x32_bf16 v[56:59], a[88:91], a[44:47], v[56:59]
  ds_read_b128 a[192:195], v209 offset:4096
  v_mfma_f32_16x16x32_bf16 v[60:63], a[104:107], a[44:47], v[60:63]
  v_mfma_f32_16x16x32_bf16 v[56:59], a[92:95], a[64:67], v[56:59]
  v_exp_f32_e64 v48, v48
  v_mfma_f32_16x16x32_bf16 v[60:63], a[108:111], a[64:67], v[60:63]
  v_exp_f32_e64 v49, v49
  v_mfma_f32_16x16x32_bf16 v[64:67], a[80:83], a[8:11], v[36:39]
  v_exp_f32_e64 v50, v50
  v_mfma_f32_16x16x32_bf16 v[68:71], a[96:99], a[8:11], v[36:39]
  buffer_load_dwordx4 v18, s[8:11], s51 offen offset:2048 nt lds
  v_cvt_pk_bf16_f32 v88, v48, v49
  v_mfma_f32_16x16x32_bf16 v[64:67], a[84:87], a[28:31], v[64:67]
  v_exp_f32_e64 v51, v51
  v_mfma_f32_16x16x32_bf16 v[68:71], a[100:103], a[28:31], v[68:71]
  v_exp_f32_e64 v52, v52
  v_mfma_f32_16x16x32_bf16 v[64:67], a[88:91], a[48:51], v[64:67]
  v_cvt_pk_bf16_f32 v89, v50, v51
  v_mfma_f32_16x16x32_bf16 v[68:71], a[104:107], a[48:51], v[68:71]
  s_waitcnt lgkmcnt(0)
  s_nop 0
  v_mfma_f32_16x16x32_bf16 v[64:67], a[92:95], a[68:71], v[64:67]
  v_exp_f32_e64 v53, v53
  v_mfma_f32_16x16x32_bf16 v[68:71], a[108:111], a[68:71], v[68:71]
  v_exp_f32_e64 v54, v54
  v_mfma_f32_16x16x32_bf16 a[196:199], a[216:219], v[108:111], a[196:199]
  ds_read_b128 a[112:115], v4 offset:16384
  v_cvt_pk_bf16_f32 v90, v52, v53
  v_mfma_f32_16x16x32_bf16 v[128:131], a[144:147], v[108:111], v[128:131]
  v_exp_f32_e64 v55, v55
  v_mfma_f32_16x16x32_bf16 v[148:151], a[148:151], v[108:111], v[148:151]
  buffer_load_dwordx4 v19, s[8:11], s51 offen offset:3072 nt lds
  v_cvt_pk_bf16_f32 v91, v54, v55
  v_mfma_f32_16x16x32_bf16 v[168:171], a[152:155], v[108:111], v[168:171]
  ds_write_b128 v208, v[88:91] offset:57344
  v_mfma_f32_16x16x32_bf16 v[188:191], a[156:159], v[108:111], v[188:191]
  v_exp_f32_e64 v56, v56
  v_mfma_f32_16x16x32_bf16 v[128:131], a[160:163], a[176:179], v[128:131]
  v_exp_f32_e64 v57, v57
  v_mfma_f32_16x16x32_bf16 v[148:151], a[164:167], a[176:179], v[148:151]
  s_add_u32 m0, s43, 65536
  v_exp_f32_e64 v58, v58
  v_mfma_f32_16x16x32_bf16 v[168:171], a[168:171], a[176:179], v[168:171]
  ds_read_b128 a[128:131], v4 offset:20480
  v_cvt_pk_bf16_f32 v92, v56, v57
  v_mfma_f32_16x16x32_bf16 v[188:191], a[172:175], a[176:179], v[188:191]
  s_add_u32 s51, s49, 147456
  v_exp_f32_e64 v59, v59
  v_mfma_f32_16x16x32_bf16 v[72:75], a[80:83], a[12:15], v[40:43]
  s_and_b32 s51, s51, 0x3ffff
  v_exp_f32_e64 v60, v60
  v_mfma_f32_16x16x32_bf16 v[76:79], a[96:99], a[12:15], v[40:43]
  buffer_load_dwordx4 v20, s[12:15], s51 offen offset:0 nt lds
  v_cvt_pk_bf16_f32 v93, v58, v59
  v_mfma_f32_16x16x32_bf16 v[72:75], a[84:87], a[32:35], v[72:75]
  v_exp_f32_e64 v61, v61
  v_mfma_f32_16x16x32_bf16 v[76:79], a[100:103], a[32:35], v[76:79]
  v_exp_f32_e64 v62, v62
  v_mfma_f32_16x16x32_bf16 v[72:75], a[88:91], a[52:55], v[72:75]
  ds_read_b128 a[116:119], v5 offset:16384
  v_cvt_pk_bf16_f32 v94, v60, v61
  v_mfma_f32_16x16x32_bf16 v[76:79], a[104:107], a[52:55], v[76:79]
  v_exp_f32_e64 v63, v63
  v_mfma_f32_16x16x32_bf16 v[72:75], a[92:95], a[72:75], v[72:75]
  v_cvt_pk_bf16_f32 v95, v62, v63
  v_mfma_f32_16x16x32_bf16 v[76:79], a[108:111], a[72:75], v[76:79]
  ds_write_b128 v208, v[92:95] offset:58368
  v_mfma_f32_16x16x32_bf16 a[200:203], a[216:219], v[112:115], a[200:203]
  v_exp_f32_e64 v64, v64
  v_mfma_f32_16x16x32_bf16 v[132:135], a[144:147], v[112:115], v[132:135]
  v_exp_f32_e64 v65, v65
  v_mfma_f32_16x16x32_bf16 v[152:155], a[148:151], v[112:115], v[152:155]
  ds_read_b128 a[132:135], v5 offset:20480
  buffer_load_dwordx4 v21, s[12:15], s51 offen offset:1024 nt lds
  v_mfma_f32_16x16x32_bf16 v[172:175], a[152:155], v[112:115], v[172:175]
  v_exp_f32_e64 v66, v66
  v_mfma_f32_16x16x32_bf16 v[192:195], a[156:159], v[112:115], v[192:195]
  v_cvt_pk_bf16_f32 v96, v64, v65
  v_mfma_f32_16x16x32_bf16 v[132:135], a[160:163], a[180:183], v[132:135]
  v_exp_f32_e64 v67, v67
  v_mfma_f32_16x16x32_bf16 v[152:155], a[164:167], a[180:183], v[152:155]
  v_exp_f32_e64 v68, v68
  v_mfma_f32_16x16x32_bf16 v[172:175], a[168:171], a[180:183], v[172:175]
  ds_read_b128 a[120:123], v6 offset:16384
  v_cvt_pk_bf16_f32 v97, v66, v67
  v_mfma_f32_16x16x32_bf16 v[192:195], a[172:175], a[180:183], v[192:195]
  v_exp_f32_e64 v69, v69
  v_mfma_f32_16x16x32_bf16 v[80:83], a[80:83], a[16:19], v[44:47]
  v_exp_f32_e64 v70, v70
  v_mfma_f32_16x16x32_bf16 v[84:87], a[96:99], a[16:19], v[44:47]
  buffer_load_dwordx4 v20, s[12:15], s51 offen offset:2048 nt lds
  v_cvt_pk_bf16_f32 v98, v68, v69
  v_mfma_f32_16x16x32_bf16 v[80:83], a[84:87], a[36:39], v[80:83]
  v_exp_f32_e64 v71, v71
  v_mfma_f32_16x16x32_bf16 v[84:87], a[100:103], a[36:39], v[84:87]
  ds_read_b128 a[136:139], v6 offset:20480
  v_cvt_pk_bf16_f32 v99, v70, v71
  v_mfma_f32_16x16x32_bf16 v[80:83], a[88:91], a[56:59], v[80:83]
  ds_write_b128 v208, v[96:99] offset:59392
  v_mfma_f32_16x16x32_bf16 v[84:87], a[104:107], a[56:59], v[84:87]
  v_exp_f32_e64 v72, v72
  v_mfma_f32_16x16x32_bf16 v[80:83], a[92:95], a[76:79], v[80:83]
  v_exp_f32_e64 v73, v73
  v_mfma_f32_16x16x32_bf16 v[84:87], a[108:111], a[76:79], v[84:87]
  v_exp_f32_e64 v74, v74
  v_mfma_f32_16x16x32_bf16 a[204:207], a[216:219], v[116:119], a[204:207]
  buffer_load_dwordx4 v21, s[12:15], s51 offen offset:3072 nt lds
  v_cvt_pk_bf16_f32 v100, v72, v73
  v_mfma_f32_16x16x32_bf16 v[136:139], a[144:147], v[116:119], v[136:139]
  v_exp_f32_e64 v75, v75
  v_mfma_f32_16x16x32_bf16 v[156:159], a[148:151], v[116:119], v[156:159]
  v_exp_f32_e64 v76, v76
  v_mfma_f32_16x16x32_bf16 v[176:179], a[152:155], v[116:119], v[176:179]
  ds_read_b128 a[124:127], v7 offset:16384
  v_cvt_pk_bf16_f32 v101, v74, v75
  v_mfma_f32_16x16x32_bf16 v[196:199], a[156:159], v[116:119], v[196:199]
  v_exp_f32_e64 v77, v77
  v_mfma_f32_16x16x32_bf16 v[136:139], a[160:163], a[184:187], v[136:139]
  v_exp_f32_e64 v78, v78
  v_mfma_f32_16x16x32_bf16 v[156:159], a[164:167], a[184:187], v[156:159]
  ds_read_b128 a[140:143], v7 offset:20480
  v_cvt_pk_bf16_f32 v102, v76, v77
  v_mfma_f32_16x16x32_bf16 v[176:179], a[168:171], a[184:187], v[176:179]
  v_exp_f32_e64 v79, v79
  v_mfma_f32_16x16x32_bf16 v[196:199], a[172:175], a[184:187], v[196:199]
  v_cvt_pk_bf16_f32 v103, v78, v79
  v_mfma_f32_16x16x32_bf16 a[208:211], a[216:219], v[120:123], a[208:211]
  ds_write_b128 v208, v[100:103] offset:60416
  v_mfma_f32_16x16x32_bf16 v[140:143], a[144:147], v[120:123], v[140:143]
  v_exp_f32_e64 v80, v80
  v_mfma_f32_16x16x32_bf16 v[160:163], a[148:151], v[120:123], v[160:163]
  v_exp_f32_e64 v81, v81
  v_mfma_f32_16x16x32_bf16 v[180:183], a[152:155], v[120:123], v[180:183]
  v_exp_f32_e64 v82, v82
  v_mfma_f32_16x16x32_bf16 v[200:203], a[156:159], v[120:123], v[200:203]
  v_cvt_pk_bf16_f32 v104, v80, v81
  v_mfma_f32_16x16x32_bf16 v[140:143], a[160:163], a[188:191], v[140:143]
  v_exp_f32_e64 v83, v83
  v_mfma_f32_16x16x32_bf16 v[160:163], a[164:167], a[188:191], v[160:163]
  v_exp_f32_e64 v84, v84
  v_mfma_f32_16x16x32_bf16 v[180:183], a[168:171], a[188:191], v[180:183]
  v_cvt_pk_bf16_f32 v105, v82, v83
  v_mfma_f32_16x16x32_bf16 v[200:203], a[172:175], a[188:191], v[200:203]
  v_exp_f32_e64 v85, v85
  v_mfma_f32_16x16x32_bf16 a[212:215], a[216:219], v[124:127], a[212:215]
  v_exp_f32_e64 v86, v86
  v_mfma_f32_16x16x32_bf16 v[144:147], a[144:147], v[124:127], v[144:147]
  v_cvt_pk_bf16_f32 v106, v84, v85
  v_mfma_f32_16x16x32_bf16 v[164:167], a[148:151], v[124:127], v[164:167]
  v_exp_f32_e64 v87, v87
  v_mfma_f32_16x16x32_bf16 v[184:187], a[152:155], v[124:127], v[184:187]
  v_cvt_pk_bf16_f32 v107, v86, v87
  v_mfma_f32_16x16x32_bf16 v[204:207], a[156:159], v[124:127], v[204:207]
  ds_write_b128 v208, v[104:107] offset:61440
  v_mfma_f32_16x16x32_bf16 v[144:147], a[160:163], a[192:195], v[144:147]
  v_mfma_f32_16x16x32_bf16 v[164:167], a[164:167], a[192:195], v[164:167]
  v_mfma_f32_16x16x32_bf16 v[184:187], a[168:171], a[192:195], v[184:187]
  v_mfma_f32_16x16x32_bf16 v[204:207], a[172:175], a[192:195], v[204:207]
  s_waitcnt vmcnt(8) lgkmcnt(0)
  s_barrier
  v_mfma_f32_16x16x32_bf16 v[48:51], a[112:115], a[0:3], v[28:31]
  s_nop 0
  ds_read_b64_tr_b16 a[144:145], v8 offset:40960
  s_add_u32 m0, s43, 0x0
  s_add_u32 s51, s49, 196608
  v_mfma_f32_16x16x32_bf16 v[52:55], a[128:131], a[0:3], v[28:31]
  ds_read_b64_tr_b16 a[146:147], v8 offset:45056
  ds_read_b64_tr_b16 a[148:149], v9 offset:40960
  s_and_b32 s51, s51, 0x3ffff
  v_mfma_f32_16x16x32_bf16 v[48:51], a[116:119], a[20:23], v[48:51]
  ds_read_b64_tr_b16 a[150:151], v9 offset:45056
  ds_read_b64_tr_b16 a[152:153], v10 offset:40960
  v_mfma_f32_16x16x32_bf16 v[52:55], a[132:135], a[20:23], v[52:55]
  buffer_load_dwordx4 v16, s[8:11], s51 offen offset:0 nt lds
  ds_read_b64_tr_b16 a[154:155], v10 offset:45056
  v_mfma_f32_16x16x32_bf16 v[48:51], a[120:123], a[40:43], v[48:51]
  ds_read_b64_tr_b16 a[156:157], v11 offset:40960
  ds_read_b64_tr_b16 a[158:159], v11 offset:45056
  v_mfma_f32_16x16x32_bf16 v[52:55], a[136:139], a[40:43], v[52:55]
  ds_read_b128 a[176:179], v209 offset:57344
  ds_read_b64_tr_b16 a[160:161], v12 offset:40960
  v_mfma_f32_16x16x32_bf16 v[48:51], a[124:127], a[60:63], v[48:51]
  ds_read_b64_tr_b16 a[162:163], v12 offset:45056
  ds_read_b64_tr_b16 a[164:165], v13 offset:40960
  v_mfma_f32_16x16x32_bf16 v[52:55], a[140:143], a[60:63], v[52:55]
  ds_read_b64_tr_b16 a[166:167], v13 offset:45056
  ds_read_b64_tr_b16 a[168:169], v14 offset:40960
  v_mfma_f32_16x16x32_bf16 v[56:59], a[112:115], a[4:7], v[32:35]
  ds_read_b64_tr_b16 a[170:171], v14 offset:45056
  ds_read_b64_tr_b16 a[172:173], v15 offset:40960
  v_mfma_f32_16x16x32_bf16 v[60:63], a[128:131], a[4:7], v[32:35]
  buffer_load_dwordx4 v17, s[8:11], s51 offen offset:1024 nt lds
  ds_read_b64_tr_b16 a[174:175], v15 offset:45056
  v_mfma_f32_16x16x32_bf16 v[56:59], a[116:119], a[24:27], v[56:59]
  ds_read_b128 a[180:183], v209 offset:58368
  ds_read_b128 a[184:187], v209 offset:59392
  v_mfma_f32_16x16x32_bf16 v[60:63], a[132:135], a[24:27], v[60:63]
  ds_read_b128 a[188:191], v209 offset:60416
  v_mfma_f32_16x16x32_bf16 v[56:59], a[120:123], a[44:47], v[56:59]
  ds_read_b128 a[192:195], v209 offset:61440
  v_mfma_f32_16x16x32_bf16 v[60:63], a[136:139], a[44:47], v[60:63]
  v_mfma_f32_16x16x32_bf16 v[56:59], a[124:127], a[64:67], v[56:59]
  v_exp_f32_e64 v48, v48
  v_mfma_f32_16x16x32_bf16 v[60:63], a[140:143], a[64:67], v[60:63]
  v_exp_f32_e64 v49, v49
  v_mfma_f32_16x16x32_bf16 v[64:67], a[112:115], a[8:11], v[36:39]
  v_exp_f32_e64 v50, v50
  v_mfma_f32_16x16x32_bf16 v[68:71], a[128:131], a[8:11], v[36:39]
  buffer_load_dwordx4 v18, s[8:11], s51 offen offset:2048 nt lds
  v_cvt_pk_bf16_f32 v108, v48, v49
  v_mfma_f32_16x16x32_bf16 v[64:67], a[116:119], a[28:31], v[64:67]
  v_exp_f32_e64 v51, v51
  v_mfma_f32_16x16x32_bf16 v[68:71], a[132:135], a[28:31], v[68:71]
  v_exp_f32_e64 v52, v52
  v_mfma_f32_16x16x32_bf16 v[64:67], a[120:123], a[48:51], v[64:67]
  v_cvt_pk_bf16_f32 v109, v50, v51
  v_mfma_f32_16x16x32_bf16 v[68:71], a[136:139], a[48:51], v[68:71]
  s_waitcnt lgkmcnt(0)
  s_nop 0
  v_mfma_f32_16x16x32_bf16 v[64:67], a[124:127], a[68:71], v[64:67]
  v_exp_f32_e64 v53, v53
  v_mfma_f32_16x16x32_bf16 v[68:71], a[140:143], a[68:71], v[68:71]
  v_exp_f32_e64 v54, v54
  v_mfma_f32_16x16x32_bf16 a[196:199], a[216:219], v[88:91], a[196:199]
  ds_read_b128 a[80:83], v4 offset:32768
  v_cvt_pk_bf16_f32 v110, v52, v53
  v_mfma_f32_16x16x32_bf16 v[128:131], a[144:147], v[88:91], v[128:131]
  v_exp_f32_e64 v55, v55
  v_mfma_f32_16x16x32_bf16 v[148:151], a[148:151], v[88:91], v[148:151]
  buffer_load_dwordx4 v19, s[8:11], s51 offen offset:3072 nt lds
  v_cvt_pk_bf16_f32 v111, v54, v55
  v_mfma_f32_16x16x32_bf16 v[168:171], a[152:155], v[88:91], v[168:171]
  ds_write_b128 v208, v[108:111] offset:0
  v_mfma_f32_16x16x32_bf16 v[188:191], a[156:159], v[88:91], v[188:191]
  v_exp_f32_e64 v56, v56
  v_mfma_f32_16x16x32_bf16 v[128:131], a[160:163], a[176:179], v[128:131]
  v_exp_f32_e64 v57, v57
  v_mfma_f32_16x16x32_bf16 v[148:151], a[164:167], a[176:179], v[148:151]
  s_add_u32 m0, s43, 122880
  v_exp_f32_e64 v58, v58
  v_mfma_f32_16x16x32_bf16 v[168:171], a[168:171], a[176:179], v[168:171]
  ds_read_b128 a[96:99], v4 offset:36864
  v_cvt_pk_bf16_f32 v112, v56, v57
  v_mfma_f32_16x16x32_bf16 v[188:191], a[172:175], a[176:179], v[188:191]
  s_add_u32 s51, s49, 163840
  v_exp_f32_e64 v59, v59
  v_mfma_f32_16x16x32_bf16 v[72:75], a[112:115], a[12:15], v[40:43]
  s_and_b32 s51, s51, 0x3ffff
  v_exp_f32_e64 v60, v60
  v_mfma_f32_16x16x32_bf16 v[76:79], a[128:131], a[12:15], v[40:43]
  buffer_load_dwordx4 v20, s[12:15], s51 offen offset:0 nt lds
  v_cvt_pk_bf16_f32 v113, v58, v59
  v_mfma_f32_16x16x32_bf16 v[72:75], a[116:119], a[32:35], v[72:75]
  v_exp_f32_e64 v61, v61
  v_mfma_f32_16x16x32_bf16 v[76:79], a[132:135], a[32:35], v[76:79]
  v_exp_f32_e64 v62, v62
  v_mfma_f32_16x16x32_bf16 v[72:75], a[120:123], a[52:55], v[72:75]
  ds_read_b128 a[84:87], v5 offset:32768
  v_cvt_pk_bf16_f32 v114, v60, v61
  v_mfma_f32_16x16x32_bf16 v[76:79], a[136:139], a[52:55], v[76:79]
  v_exp_f32_e64 v63, v63
  v_mfma_f32_16x16x32_bf16 v[72:75], a[124:127], a[72:75], v[72:75]
  v_cvt_pk_bf16_f32 v115, v62, v63
  v_mfma_f32_16x16x32_bf16 v[76:79], a[140:143], a[72:75], v[76:79]
  ds_write_b128 v208, v[112:115] offset:1024
  v_mfma_f32_16x16x32_bf16 a[200:203], a[216:219], v[92:95], a[200:203]
  v_exp_f32_e64 v64, v64
  v_mfma_f32_16x16x32_bf16 v[132:135], a[144:147], v[92:95], v[132:135]
  v_exp_f32_e64 v65, v65
  v_mfma_f32_16x16x32_bf16 v[152:155], a[148:151], v[92:95], v[152:155]
  ds_read_b128 a[100:103], v5 offset:36864
  buffer_load_dwordx4 v21, s[12:15], s51 offen offset:1024 nt lds
  v_mfma_f32_16x16x32_bf16 v[172:175], a[152:155], v[92:95], v[172:175]
  v_exp_f32_e64 v66, v66
  v_mfma_f32_16x16x32_bf16 v[192:195], a[156:159], v[92:95], v[192:195]
  v_cvt_pk_bf16_f32 v116, v64, v65
  v_mfma_f32_16x16x32_bf16 v[132:135], a[160:163], a[180:183], v[132:135]
  v_exp_f32_e64 v67, v67
  v_mfma_f32_16x16x32_bf16 v[152:155], a[164:167], a[180:183], v[152:155]
  v_exp_f32_e64 v68, v68
  v_mfma_f32_16x16x32_bf16 v[172:175], a[168:171], a[180:183], v[172:175]
  ds_read_b128 a[88:91], v6 offset:32768
  v_cvt_pk_bf16_f32 v117, v66, v67
  v_mfma_f32_16x16x32_bf16 v[192:195], a[172:175], a[180:183], v[192:195]
  v_exp_f32_e64 v69, v69
  v_mfma_f32_16x16x32_bf16 v[80:83], a[112:115], a[16:19], v[44:47]
  v_exp_f32_e64 v70, v70
  v_mfma_f32_16x16x32_bf16 v[84:87], a[128:131], a[16:19], v[44:47]
  buffer_load_dwordx4 v20, s[12:15], s51 offen offset:2048 nt lds
  v_cvt_pk_bf16_f32 v118, v68, v69
  v_mfma_f32_16x16x32_bf16 v[80:83], a[116:119], a[36:39], v[80:83]
  v_exp_f32_e64 v71, v71
  v_mfma_f32_16x16x32_bf16 v[84:87], a[132:135], a[36:39], v[84:87]
  ds_read_b128 a[104:107], v6 offset:36864
  v_cvt_pk_bf16_f32 v119, v70, v71
  v_mfma_f32_16x16x32_bf16 v[80:83], a[120:123], a[56:59], v[80:83]
  ds_write_b128 v208, v[116:119] offset:2048
  v_mfma_f32_16x16x32_bf16 v[84:87], a[136:139], a[56:59], v[84:87]
  v_exp_f32_e64 v72, v72
  v_mfma_f32_16x16x32_bf16 v[80:83], a[124:127], a[76:79], v[80:83]
  v_exp_f32_e64 v73, v73
  v_mfma_f32_16x16x32_bf16 v[84:87], a[140:143], a[76:79], v[84:87]
  v_exp_f32_e64 v74, v74
  v_mfma_f32_16x16x32_bf16 a[204:207], a[216:219], v[96:99], a[204:207]
  buffer_load_dwordx4 v21, s[12:15], s51 offen offset:3072 nt lds
  v_cvt_pk_bf16_f32 v120, v72, v73
  v_mfma_f32_16x16x32_bf16 v[136:139], a[144:147], v[96:99], v[136:139]
  v_exp_f32_e64 v75, v75
  v_mfma_f32_16x16x32_bf16 v[156:159], a[148:151], v[96:99], v[156:159]
  v_exp_f32_e64 v76, v76
  v_mfma_f32_16x16x32_bf16 v[176:179], a[152:155], v[96:99], v[176:179]
  ds_read_b128 a[92:95], v7 offset:32768
  v_cvt_pk_bf16_f32 v121, v74, v75
  v_mfma_f32_16x16x32_bf16 v[196:199], a[156:159], v[96:99], v[196:199]
  v_exp_f32_e64 v77, v77
  v_mfma_f32_16x16x32_bf16 v[136:139], a[160:163], a[184:187], v[136:139]
  v_exp_f32_e64 v78, v78
  v_mfma_f32_16x16x32_bf16 v[156:159], a[164:167], a[184:187], v[156:159]
  ds_read_b128 a[108:111], v7 offset:36864
  v_cvt_pk_bf16_f32 v122, v76, v77
  v_mfma_f32_16x16x32_bf16 v[176:179], a[168:171], a[184:187], v[176:179]
  v_exp_f32_e64 v79, v79
  v_mfma_f32_16x16x32_bf16 v[196:199], a[172:175], a[184:187], v[196:199]
  v_cvt_pk_bf16_f32 v123, v78, v79
  v_mfma_f32_16x16x32_bf16 a[208:211], a[216:219], v[100:103], a[208:211]
  ds_write_b128 v208, v[120:123] offset:3072
  v_mfma_f32_16x16x32_bf16 v[140:143], a[144:147], v[100:103], v[140:143]
  v_exp_f32_e64 v80, v80
  v_mfma_f32_16x16x32_bf16 v[160:163], a[148:151], v[100:103], v[160:163]
  v_exp_f32_e64 v81, v81
  v_mfma_f32_16x16x32_bf16 v[180:183], a[152:155], v[100:103], v[180:183]
  v_exp_f32_e64 v82, v82
  v_mfma_f32_16x16x32_bf16 v[200:203], a[156:159], v[100:103], v[200:203]
  v_cvt_pk_bf16_f32 v124, v80, v81
  v_mfma_f32_16x16x32_bf16 v[140:143], a[160:163], a[188:191], v[140:143]
  v_exp_f32_e64 v83, v83
  v_mfma_f32_16x16x32_bf16 v[160:163], a[164:167], a[188:191], v[160:163]
  v_exp_f32_e64 v84, v84
  v_mfma_f32_16x16x32_bf16 v[180:183], a[168:171], a[188:191], v[180:183]
  v_cvt_pk_bf16_f32 v125, v82, v83
  v_mfma_f32_16x16x32_bf16 v[200:203], a[172:175], a[188:191], v[200:203]
  v_exp_f32_e64 v85, v85
  v_mfma_f32_16x16x32_bf16 a[212:215], a[216:219], v[104:107], a[212:215]
  v_exp_f32_e64 v86, v86
  v_mfma_f32_16x16x32_bf16 v[144:147], a[144:147], v[104:107], v[144:147]
  v_cvt_pk_bf16_f32 v126, v84, v85
  v_mfma_f32_16x16x32_bf16 v[164:167], a[148:151], v[104:107], v[164:167]
  v_exp_f32_e64 v87, v87
  v_mfma_f32_16x16x32_bf16 v[184:187], a[152:155], v[104:107], v[184:187]
  v_cvt_pk_bf16_f32 v127, v86, v87
  v_mfma_f32_16x16x32_bf16 v[204:207], a[156:159], v[104:107], v[204:207]
  ds_write_b128 v208, v[124:127] offset:4096
  v_mfma_f32_16x16x32_bf16 v[144:147], a[160:163], a[192:195], v[144:147]
  v_mfma_f32_16x16x32_bf16 v[164:167], a[164:167], a[192:195], v[164:167]
  v_mfma_f32_16x16x32_bf16 v[184:187], a[168:171], a[192:195], v[184:187]
  v_mfma_f32_16x16x32_bf16 v[204:207], a[172:175], a[192:195], v[204:207]
  s_waitcnt vmcnt(8) lgkmcnt(0)
  s_barrier
  v_mfma_f32_16x16x32_bf16 v[48:51], a[80:83], a[0:3], v[28:31]
  ds_read_b64_tr_b16 a[144:145], v8 offset:0
  s_add_u32 m0, s43, 16384
  s_add_u32 s51, s49, 212992
  v_mfma_f32_16x16x32_bf16 v[52:55], a[96:99], a[0:3], v[28:31]
  ds_read_b64_tr_b16 a[146:147], v8 offset:4096
  ds_read_b64_tr_b16 a[148:149], v9 offset:0
  s_and_b32 s51, s51, 0x3ffff
  v_mfma_f32_16x16x32_bf16 v[48:51], a[84:87], a[20:23], v[48:51]
  ds_read_b64_tr_b16 a[150:151], v9 offset:4096
  ds_read_b64_tr_b16 a[152:153], v10 offset:0
  v_mfma_f32_16x16x32_bf16 v[52:55], a[100:103], a[20:23], v[52:55]
  buffer_load_dwordx4 v16, s[8:11], s51 offen offset:0 nt lds
  ds_read_b64_tr_b16 a[154:155], v10 offset:4096
  v_mfma_f32_16x16x32_bf16 v[48:51], a[88:91], a[40:43], v[48:51]
  ds_read_b64_tr_b16 a[156:157], v11 offset:0
  ds_read_b64_tr_b16 a[158:159], v11 offset:4096
  v_mfma_f32_16x16x32_bf16 v[52:55], a[104:107], a[40:43], v[52:55]
  ds_read_b128 a[176:179], v209 offset:0
  ds_read_b64_tr_b16 a[160:161], v12 offset:0
  v_mfma_f32_16x16x32_bf16 v[48:51], a[92:95], a[60:63], v[48:51]
  ds_read_b64_tr_b16 a[162:163], v12 offset:4096
  ds_read_b64_tr_b16 a[164:165], v13 offset:0
  v_mfma_f32_16x16x32_bf16 v[52:55], a[108:111], a[60:63], v[52:55]
  ds_read_b64_tr_b16 a[166:167], v13 offset:4096
  ds_read_b64_tr_b16 a[168:169], v14 offset:0
  v_mfma_f32_16x16x32_bf16 v[56:59], a[80:83], a[4:7], v[32:35]
  ds_read_b64_tr_b16 a[170:171], v14 offset:4096
  ds_read_b64_tr_b16 a[172:173], v15 offset:0
  v_mfma_f32_16x16x32_bf16 v[60:63], a[96:99], a[4:7], v[32:35]
  buffer_load_dwordx4 v17, s[8:11], s51 offen offset:1024 nt lds
  ds_read_b64_tr_b16 a[174:175], v15 offset:4096
  v_mfma_f32_16x16x32_bf16 v[56:59], a[84:87], a[24:27], v[56:59]
  ds_read_b128 a[180:183], v209 offset:1024
  ds_read_b128 a[184:187], v209 offset:2048
  v_mfma_f32_16x16x32_bf16 v[60:63], a[100:103], a[24:27], v[60:63]
  ds_read_b128 a[188:191], v209 offset:3072
  v_mfma_f32_16x16x32_bf16 v[56:59], a[88:91], a[44:47], v[56:59]
  ds_read_b128 a[192:195], v209 offset:4096
  v_mfma_f32_16x16x32_bf16 v[60:63], a[104:107], a[44:47], v[60:63]
  v_mfma_f32_16x16x32_bf16 v[56:59], a[92:95], a[64:67], v[56:59]
  v_exp_f32_e64 v48, v48
  v_mfma_f32_16x16x32_bf16 v[60:63], a[108:111], a[64:67], v[60:63]
  v_exp_f32_e64 v49, v49
  v_mfma_f32_16x16x32_bf16 v[64:67], a[80:83], a[8:11], v[36:39]
  v_exp_f32_e64 v50, v50
  v_mfma_f32_16x16x32_bf16 v[68:71], a[96:99], a[8:11], v[36:39]
  buffer_load_dwordx4 v18, s[8:11], s51 offen offset:2048 nt lds
  v_cvt_pk_bf16_f32 v88, v48, v49
  v_mfma_f32_16x16x32_bf16 v[64:67], a[84:87], a[28:31], v[64:67]
  v_exp_f32_e64 v51, v51
  v_mfma_f32_16x16x32_bf16 v[68:71], a[100:103], a[28:31], v[68:71]
  v_exp_f32_e64 v52, v52
  v_mfma_f32_16x16x32_bf16 v[64:67], a[88:91], a[48:51], v[64:67]
  v_cvt_pk_bf16_f32 v89, v50, v51
  v_mfma_f32_16x16x32_bf16 v[68:71], a[104:107], a[48:51], v[68:71]
  s_waitcnt lgkmcnt(0)
  s_nop 0
  v_mfma_f32_16x16x32_bf16 v[64:67], a[92:95], a[68:71], v[64:67]
  v_exp_f32_e64 v53, v53
  v_mfma_f32_16x16x32_bf16 v[68:71], a[108:111], a[68:71], v[68:71]
  v_exp_f32_e64 v54, v54
  v_mfma_f32_16x16x32_bf16 a[196:199], a[216:219], v[108:111], a[196:199]
  ds_read_b128 a[112:115], v4 offset:49152
  v_cvt_pk_bf16_f32 v90, v52, v53
  v_mfma_f32_16x16x32_bf16 v[128:131], a[144:147], v[108:111], v[128:131]
  v_exp_f32_e64 v55, v55
  v_mfma_f32_16x16x32_bf16 v[148:151], a[148:151], v[108:111], v[148:151]
  buffer_load_dwordx4 v19, s[8:11], s51 offen offset:3072 nt lds
  v_cvt_pk_bf16_f32 v91, v54, v55
  v_mfma_f32_16x16x32_bf16 v[168:171], a[152:155], v[108:111], v[168:171]
  ds_write_b128 v208, v[88:91] offset:57344
  v_mfma_f32_16x16x32_bf16 v[188:191], a[156:159], v[108:111], v[188:191]
  v_exp_f32_e64 v56, v56
  v_mfma_f32_16x16x32_bf16 v[128:131], a[160:163], a[176:179], v[128:131]
  v_exp_f32_e64 v57, v57
  v_mfma_f32_16x16x32_bf16 v[148:151], a[164:167], a[176:179], v[148:151]
  s_add_u32 m0, s43, 106496
  v_exp_f32_e64 v58, v58
  v_mfma_f32_16x16x32_bf16 v[168:171], a[168:171], a[176:179], v[168:171]
  ds_read_b128 a[128:131], v4 offset:53248
  v_cvt_pk_bf16_f32 v92, v56, v57
  v_mfma_f32_16x16x32_bf16 v[188:191], a[172:175], a[176:179], v[188:191]
  s_add_u32 s51, s49, 180224
  v_exp_f32_e64 v59, v59
  v_mfma_f32_16x16x32_bf16 v[72:75], a[80:83], a[12:15], v[40:43]
  s_and_b32 s51, s51, 0x3ffff
  v_exp_f32_e64 v60, v60
  v_mfma_f32_16x16x32_bf16 v[76:79], a[96:99], a[12:15], v[40:43]
  buffer_load_dwordx4 v20, s[12:15], s51 offen offset:0 nt lds
  v_cvt_pk_bf16_f32 v93, v58, v59
  v_mfma_f32_16x16x32_bf16 v[72:75], a[84:87], a[32:35], v[72:75]
  v_exp_f32_e64 v61, v61
  v_mfma_f32_16x16x32_bf16 v[76:79], a[100:103], a[32:35], v[76:79]
  v_exp_f32_e64 v62, v62
  v_mfma_f32_16x16x32_bf16 v[72:75], a[88:91], a[52:55], v[72:75]
  ds_read_b128 a[116:119], v5 offset:49152
  v_cvt_pk_bf16_f32 v94, v60, v61
  v_mfma_f32_16x16x32_bf16 v[76:79], a[104:107], a[52:55], v[76:79]
  v_exp_f32_e64 v63, v63
  v_mfma_f32_16x16x32_bf16 v[72:75], a[92:95], a[72:75], v[72:75]
  v_cvt_pk_bf16_f32 v95, v62, v63
  v_mfma_f32_16x16x32_bf16 v[76:79], a[108:111], a[72:75], v[76:79]
  ds_write_b128 v208, v[92:95] offset:58368
  v_mfma_f32_16x16x32_bf16 a[200:203], a[216:219], v[112:115], a[200:203]
  v_exp_f32_e64 v64, v64
  v_mfma_f32_16x16x32_bf16 v[132:135], a[144:147], v[112:115], v[132:135]
  v_exp_f32_e64 v65, v65
  v_mfma_f32_16x16x32_bf16 v[152:155], a[148:151], v[112:115], v[152:155]
  ds_read_b128 a[132:135], v5 offset:53248
  buffer_load_dwordx4 v21, s[12:15], s51 offen offset:1024 nt lds
  v_mfma_f32_16x16x32_bf16 v[172:175], a[152:155], v[112:115], v[172:175]
  v_exp_f32_e64 v66, v66
  v_mfma_f32_16x16x32_bf16 v[192:195], a[156:159], v[112:115], v[192:195]
  v_cvt_pk_bf16_f32 v96, v64, v65
  v_mfma_f32_16x16x32_bf16 v[132:135], a[160:163], a[180:183], v[132:135]
  v_exp_f32_e64 v67, v67
  v_mfma_f32_16x16x32_bf16 v[152:155], a[164:167], a[180:183], v[152:155]
  v_exp_f32_e64 v68, v68
  v_mfma_f32_16x16x32_bf16 v[172:175], a[168:171], a[180:183], v[172:175]
  ds_read_b128 a[120:123], v6 offset:49152
  v_cvt_pk_bf16_f32 v97, v66, v67
  v_mfma_f32_16x16x32_bf16 v[192:195], a[172:175], a[180:183], v[192:195]
  v_exp_f32_e64 v69, v69
  v_mfma_f32_16x16x32_bf16 v[80:83], a[80:83], a[16:19], v[44:47]
  v_exp_f32_e64 v70, v70
  v_mfma_f32_16x16x32_bf16 v[84:87], a[96:99], a[16:19], v[44:47]
  buffer_load_dwordx4 v20, s[12:15], s51 offen offset:2048 nt lds
  v_cvt_pk_bf16_f32 v98, v68, v69
  v_mfma_f32_16x16x32_bf16 v[80:83], a[84:87], a[36:39], v[80:83]
  v_exp_f32_e64 v71, v71
  v_mfma_f32_16x16x32_bf16 v[84:87], a[100:103], a[36:39], v[84:87]
  ds_read_b128 a[136:139], v6 offset:53248
  v_cvt_pk_bf16_f32 v99, v70, v71
  v_mfma_f32_16x16x32_bf16 v[80:83], a[88:91], a[56:59], v[80:83]
  ds_write_b128 v208, v[96:99] offset:59392
  v_mfma_f32_16x16x32_bf16 v[84:87], a[104:107], a[56:59], v[84:87]
  v_exp_f32_e64 v72, v72
  v_mfma_f32_16x16x32_bf16 v[80:83], a[92:95], a[76:79], v[80:83]
  v_exp_f32_e64 v73, v73
  v_mfma_f32_16x16x32_bf16 v[84:87], a[108:111], a[76:79], v[84:87]
  v_exp_f32_e64 v74, v74
  v_mfma_f32_16x16x32_bf16 a[204:207], a[216:219], v[116:119], a[204:207]
  buffer_load_dwordx4 v21, s[12:15], s51 offen offset:3072 nt lds
  v_cvt_pk_bf16_f32 v100, v72, v73
  v_mfma_f32_16x16x32_bf16 v[136:139], a[144:147], v[116:119], v[136:139]
  v_exp_f32_e64 v75, v75
  v_mfma_f32_16x16x32_bf16 v[156:159], a[148:151], v[116:119], v[156:159]
  v_exp_f32_e64 v76, v76
  v_mfma_f32_16x16x32_bf16 v[176:179], a[152:155], v[116:119], v[176:179]
  ds_read_b128 a[124:127], v7 offset:49152
  v_cvt_pk_bf16_f32 v101, v74, v75
  v_mfma_f32_16x16x32_bf16 v[196:199], a[156:159], v[116:119], v[196:199]
  v_exp_f32_e64 v77, v77
  v_mfma_f32_16x16x32_bf16 v[136:139], a[160:163], a[184:187], v[136:139]
  v_exp_f32_e64 v78, v78
  v_mfma_f32_16x16x32_bf16 v[156:159], a[164:167], a[184:187], v[156:159]
  ds_read_b128 a[140:143], v7 offset:53248
  v_cvt_pk_bf16_f32 v102, v76, v77
  v_mfma_f32_16x16x32_bf16 v[176:179], a[168:171], a[184:187], v[176:179]
  v_exp_f32_e64 v79, v79
  v_mfma_f32_16x16x32_bf16 v[196:199], a[172:175], a[184:187], v[196:199]
  v_cvt_pk_bf16_f32 v103, v78, v79
  v_mfma_f32_16x16x32_bf16 a[208:211], a[216:219], v[120:123], a[208:211]
  ds_write_b128 v208, v[100:103] offset:60416
  v_mfma_f32_16x16x32_bf16 v[140:143], a[144:147], v[120:123], v[140:143]
  v_exp_f32_e64 v80, v80
  v_mfma_f32_16x16x32_bf16 v[160:163], a[148:151], v[120:123], v[160:163]
  v_exp_f32_e64 v81, v81
  v_mfma_f32_16x16x32_bf16 v[180:183], a[152:155], v[120:123], v[180:183]
  v_exp_f32_e64 v82, v82
  v_mfma_f32_16x16x32_bf16 v[200:203], a[156:159], v[120:123], v[200:203]
  v_cvt_pk_bf16_f32 v104, v80, v81
  v_mfma_f32_16x16x32_bf16 v[140:143], a[160:163], a[188:191], v[140:143]
  v_exp_f32_e64 v83, v83
  v_mfma_f32_16x16x32_bf16 v[160:163], a[164:167], a[188:191], v[160:163]
  v_exp_f32_e64 v84, v84
  v_mfma_f32_16x16x32_bf16 v[180:183], a[168:171], a[188:191], v[180:183]
  v_cvt_pk_bf16_f32 v105, v82, v83
  v_mfma_f32_16x16x32_bf16 v[200:203], a[172:175], a[188:191], v[200:203]
  v_exp_f32_e64 v85, v85
  v_mfma_f32_16x16x32_bf16 a[212:215], a[216:219], v[124:127], a[212:215]
  v_exp_f32_e64 v86, v86
  v_mfma_f32_16x16x32_bf16 v[144:147], a[144:147], v[124:127], v[144:147]
  v_cvt_pk_bf16_f32 v106, v84, v85
  v_mfma_f32_16x16x32_bf16 v[164:167], a[148:151], v[124:127], v[164:167]
  v_exp_f32_e64 v87, v87
  v_mfma_f32_16x16x32_bf16 v[184:187], a[152:155], v[124:127], v[184:187]
  v_cvt_pk_bf16_f32 v107, v86, v87
  v_mfma_f32_16x16x32_bf16 v[204:207], a[156:159], v[124:127], v[204:207]
  ds_write_b128 v208, v[104:107] offset:61440
  v_mfma_f32_16x16x32_bf16 v[144:147], a[160:163], a[192:195], v[144:147]
  v_mfma_f32_16x16x32_bf16 v[164:167], a[164:167], a[192:195], v[164:167]
  v_mfma_f32_16x16x32_bf16 v[184:187], a[168:171], a[192:195], v[184:187]
  v_mfma_f32_16x16x32_bf16 v[204:207], a[172:175], a[192:195], v[204:207]
  s_waitcnt vmcnt(8) lgkmcnt(0)
  s_barrier
  v_mfma_f32_16x16x32_bf16 v[48:51], a[112:115], a[0:3], v[28:31]
  ds_read_b64_tr_b16 a[144:145], v8 offset:57344
  s_add_u32 m0, s43, 32768
  s_add_u32 s51, s49, 229376
  v_mfma_f32_16x16x32_bf16 v[52:55], a[128:131], a[0:3], v[28:31]
  ds_read_b64_tr_b16 a[146:147], v8 offset:61440
  ds_read_b64_tr_b16 a[148:149], v9 offset:57344
  s_and_b32 s51, s51, 0x3ffff
  v_mfma_f32_16x16x32_bf16 v[48:51], a[116:119], a[20:23], v[48:51]
  ds_read_b64_tr_b16 a[150:151], v9 offset:61440
  ds_read_b64_tr_b16 a[152:153], v10 offset:57344
  v_mfma_f32_16x16x32_bf16 v[52:55], a[132:135], a[20:23], v[52:55]
  buffer_load_dwordx4 v16, s[8:11], s51 offen offset:0 nt lds
  ds_read_b64_tr_b16 a[154:155], v10 offset:61440
  v_mfma_f32_16x16x32_bf16 v[48:51], a[120:123], a[40:43], v[48:51]
  ds_read_b64_tr_b16 a[156:157], v11 offset:57344
  ds_read_b64_tr_b16 a[158:159], v11 offset:61440
  v_mfma_f32_16x16x32_bf16 v[52:55], a[136:139], a[40:43], v[52:55]
  ds_read_b128 a[176:179], v209 offset:57344
  ds_read_b64_tr_b16 a[160:161], v12 offset:57344
  v_mfma_f32_16x16x32_bf16 v[48:51], a[124:127], a[60:63], v[48:51]
  ds_read_b64_tr_b16 a[162:163], v12 offset:61440
  ds_read_b64_tr_b16 a[164:165], v13 offset:57344
  v_mfma_f32_16x16x32_bf16 v[52:55], a[140:143], a[60:63], v[52:55]
  ds_read_b64_tr_b16 a[166:167], v13 offset:61440
  ds_read_b64_tr_b16 a[168:169], v14 offset:57344
  v_mfma_f32_16x16x32_bf16 v[56:59], a[112:115], a[4:7], v[32:35]
  ds_read_b64_tr_b16 a[170:171], v14 offset:61440
  ds_read_b64_tr_b16 a[172:173], v15 offset:57344
  v_mfma_f32_16x16x32_bf16 v[60:63], a[128:131], a[4:7], v[32:35]
  buffer_load_dwordx4 v17, s[8:11], s51 offen offset:1024 nt lds
  ds_read_b64_tr_b16 a[174:175], v15 offset:61440
  v_mfma_f32_16x16x32_bf16 v[56:59], a[116:119], a[24:27], v[56:59]
  ds_read_b128 a[180:183], v209 offset:58368
  ds_read_b128 a[184:187], v209 offset:59392
  v_mfma_f32_16x16x32_bf16 v[60:63], a[132:135], a[24:27], v[60:63]
  ds_read_b128 a[188:191], v209 offset:60416
  v_mfma_f32_16x16x32_bf16 v[56:59], a[120:123], a[44:47], v[56:59]
  ds_read_b128 a[192:195], v209 offset:61440
  v_mfma_f32_16x16x32_bf16 v[60:63], a[136:139], a[44:47], v[60:63]
  v_mfma_f32_16x16x32_bf16 v[56:59], a[124:127], a[64:67], v[56:59]
  v_exp_f32_e64 v48, v48
  v_mfma_f32_16x16x32_bf16 v[60:63], a[140:143], a[64:67], v[60:63]
  v_exp_f32_e64 v49, v49
  v_mfma_f32_16x16x32_bf16 v[64:67], a[112:115], a[8:11], v[36:39]
  v_exp_f32_e64 v50, v50
  v_mfma_f32_16x16x32_bf16 v[68:71], a[128:131], a[8:11], v[36:39]
  buffer_load_dwordx4 v18, s[8:11], s51 offen offset:2048 nt lds
  v_cvt_pk_bf16_f32 v108, v48, v49
  v_mfma_f32_16x16x32_bf16 v[64:67], a[116:119], a[28:31], v[64:67]
  v_exp_f32_e64 v51, v51
  v_mfma_f32_16x16x32_bf16 v[68:71], a[132:135], a[28:31], v[68:71]
  v_exp_f32_e64 v52, v52
  v_mfma_f32_16x16x32_bf16 v[64:67], a[120:123], a[48:51], v[64:67]
  v_cvt_pk_bf16_f32 v109, v50, v51
  v_mfma_f32_16x16x32_bf16 v[68:71], a[136:139], a[48:51], v[68:71]
  s_waitcnt lgkmcnt(0)
  s_nop 0
  v_mfma_f32_16x16x32_bf16 v[64:67], a[124:127], a[68:71], v[64:67]
  v_exp_f32_e64 v53, v53
  v_mfma_f32_16x16x32_bf16 v[68:71], a[140:143], a[68:71], v[68:71]
  v_exp_f32_e64 v54, v54
  v_mfma_f32_16x16x32_bf16 a[196:199], a[216:219], v[88:91], a[196:199]
  ds_read_b128 a[80:83], v4 offset:0
  v_cvt_pk_bf16_f32 v110, v52, v53
  v_mfma_f32_16x16x32_bf16 v[128:131], a[144:147], v[88:91], v[128:131]
  v_exp_f32_e64 v55, v55
  v_mfma_f32_16x16x32_bf16 v[148:151], a[148:151], v[88:91], v[148:151]
  buffer_load_dwordx4 v19, s[8:11], s51 offen offset:3072 nt lds
  v_cvt_pk_bf16_f32 v111, v54, v55
  v_mfma_f32_16x16x32_bf16 v[168:171], a[152:155], v[88:91], v[168:171]
  ds_write_b128 v208, v[108:111] offset:0
  v_mfma_f32_16x16x32_bf16 v[188:191], a[156:159], v[88:91], v[188:191]
  v_exp_f32_e64 v56, v56
  v_mfma_f32_16x16x32_bf16 v[128:131], a[160:163], a[176:179], v[128:131]
  v_exp_f32_e64 v57, v57
  v_mfma_f32_16x16x32_bf16 v[148:151], a[164:167], a[176:179], v[148:151]
  s_add_u32 m0, s43, 65536
  v_exp_f32_e64 v58, v58
  v_mfma_f32_16x16x32_bf16 v[168:171], a[168:171], a[176:179], v[168:171]
  ds_read_b128 a[96:99], v4 offset:4096
  v_cvt_pk_bf16_f32 v112, v56, v57
  v_mfma_f32_16x16x32_bf16 v[188:191], a[172:175], a[176:179], v[188:191]
  s_add_u32 s51, s49, 196608
  v_exp_f32_e64 v59, v59
  v_mfma_f32_16x16x32_bf16 v[72:75], a[112:115], a[12:15], v[40:43]
  s_and_b32 s51, s51, 0x3ffff
  v_exp_f32_e64 v60, v60
  v_mfma_f32_16x16x32_bf16 v[76:79], a[128:131], a[12:15], v[40:43]
  buffer_load_dwordx4 v20, s[12:15], s51 offen offset:0 nt lds
  v_cvt_pk_bf16_f32 v113, v58, v59
  v_mfma_f32_16x16x32_bf16 v[72:75], a[116:119], a[32:35], v[72:75]
  v_exp_f32_e64 v61, v61
  v_mfma_f32_16x16x32_bf16 v[76:79], a[132:135], a[32:35], v[76:79]
  v_exp_f32_e64 v62, v62
  v_mfma_f32_16x16x32_bf16 v[72:75], a[120:123], a[52:55], v[72:75]
  ds_read_b128 a[84:87], v5 offset:0
  v_cvt_pk_bf16_f32 v114, v60, v61
  v_mfma_f32_16x16x32_bf16 v[76:79], a[136:139], a[52:55], v[76:79]
  v_exp_f32_e64 v63, v63
  v_mfma_f32_16x16x32_bf16 v[72:75], a[124:127], a[72:75], v[72:75]
  v_cvt_pk_bf16_f32 v115, v62, v63
  v_mfma_f32_16x16x32_bf16 v[76:79], a[140:143], a[72:75], v[76:79]
  ds_write_b128 v208, v[112:115] offset:1024
  v_mfma_f32_16x16x32_bf16 a[200:203], a[216:219], v[92:95], a[200:203]
  v_exp_f32_e64 v64, v64
  v_mfma_f32_16x16x32_bf16 v[132:135], a[144:147], v[92:95], v[132:135]
  v_exp_f32_e64 v65, v65
  v_mfma_f32_16x16x32_bf16 v[152:155], a[148:151], v[92:95], v[152:155]
  ds_read_b128 a[100:103], v5 offset:4096
  buffer_load_dwordx4 v21, s[12:15], s51 offen offset:1024 nt lds
  v_mfma_f32_16x16x32_bf16 v[172:175], a[152:155], v[92:95], v[172:175]
  v_exp_f32_e64 v66, v66
  v_mfma_f32_16x16x32_bf16 v[192:195], a[156:159], v[92:95], v[192:195]
  v_cvt_pk_bf16_f32 v116, v64, v65
  v_mfma_f32_16x16x32_bf16 v[132:135], a[160:163], a[180:183], v[132:135]
  v_exp_f32_e64 v67, v67
  v_mfma_f32_16x16x32_bf16 v[152:155], a[164:167], a[180:183], v[152:155]
  v_exp_f32_e64 v68, v68
  v_mfma_f32_16x16x32_bf16 v[172:175], a[168:171], a[180:183], v[172:175]
  ds_read_b128 a[88:91], v6 offset:0
  v_cvt_pk_bf16_f32 v117, v66, v67
  v_mfma_f32_16x16x32_bf16 v[192:195], a[172:175], a[180:183], v[192:195]
  v_exp_f32_e64 v69, v69
  v_mfma_f32_16x16x32_bf16 v[80:83], a[112:115], a[16:19], v[44:47]
  v_exp_f32_e64 v70, v70
  v_mfma_f32_16x16x32_bf16 v[84:87], a[128:131], a[16:19], v[44:47]
  buffer_load_dwordx4 v20, s[12:15], s51 offen offset:2048 nt lds
  v_cvt_pk_bf16_f32 v118, v68, v69
  v_mfma_f32_16x16x32_bf16 v[80:83], a[116:119], a[36:39], v[80:83]
  v_exp_f32_e64 v71, v71
  v_mfma_f32_16x16x32_bf16 v[84:87], a[132:135], a[36:39], v[84:87]
  ds_read_b128 a[104:107], v6 offset:4096
  v_cvt_pk_bf16_f32 v119, v70, v71
  v_mfma_f32_16x16x32_bf16 v[80:83], a[120:123], a[56:59], v[80:83]
  ds_write_b128 v208, v[116:119] offset:2048
  v_mfma_f32_16x16x32_bf16 v[84:87], a[136:139], a[56:59], v[84:87]
  v_exp_f32_e64 v72, v72
  v_mfma_f32_16x16x32_bf16 v[80:83], a[124:127], a[76:79], v[80:83]
  v_exp_f32_e64 v73, v73
  v_mfma_f32_16x16x32_bf16 v[84:87], a[140:143], a[76:79], v[84:87]
  v_exp_f32_e64 v74, v74
  v_mfma_f32_16x16x32_bf16 a[204:207], a[216:219], v[96:99], a[204:207]
  buffer_load_dwordx4 v21, s[12:15], s51 offen offset:3072 nt lds
  v_cvt_pk_bf16_f32 v120, v72, v73
  v_mfma_f32_16x16x32_bf16 v[136:139], a[144:147], v[96:99], v[136:139]
  v_exp_f32_e64 v75, v75
  v_mfma_f32_16x16x32_bf16 v[156:159], a[148:151], v[96:99], v[156:159]
  v_exp_f32_e64 v76, v76
  v_mfma_f32_16x16x32_bf16 v[176:179], a[152:155], v[96:99], v[176:179]
  ds_read_b128 a[92:95], v7 offset:0
  v_cvt_pk_bf16_f32 v121, v74, v75
  v_mfma_f32_16x16x32_bf16 v[196:199], a[156:159], v[96:99], v[196:199]
  v_exp_f32_e64 v77, v77
  v_mfma_f32_16x16x32_bf16 v[136:139], a[160:163], a[184:187], v[136:139]
  v_exp_f32_e64 v78, v78
  v_mfma_f32_16x16x32_bf16 v[156:159], a[164:167], a[184:187], v[156:159]
  ds_read_b128 a[108:111], v7 offset:4096
  v_cvt_pk_bf16_f32 v122, v76, v77
  v_mfma_f32_16x16x32_bf16 v[176:179], a[168:171], a[184:187], v[176:179]
  v_exp_f32_e64 v79, v79
  v_mfma_f32_16x16x32_bf16 v[196:199], a[172:175], a[184:187], v[196:199]
  v_cvt_pk_bf16_f32 v123, v78, v79
  v_mfma_f32_16x16x32_bf16 a[208:211], a[216:219], v[100:103], a[208:211]
  ds_write_b128 v208, v[120:123] offset:3072
  v_mfma_f32_16x16x32_bf16 v[140:143], a[144:147], v[100:103], v[140:143]
  v_exp_f32_e64 v80, v80
  v_mfma_f32_16x16x32_bf16 v[160:163], a[148:151], v[100:103], v[160:163]
  v_exp_f32_e64 v81, v81
  v_mfma_f32_16x16x32_bf16 v[180:183], a[152:155], v[100:103], v[180:183]
  v_exp_f32_e64 v82, v82
  v_mfma_f32_16x16x32_bf16 v[200:203], a[156:159], v[100:103], v[200:203]
  v_cvt_pk_bf16_f32 v124, v80, v81
  v_mfma_f32_16x16x32_bf16 v[140:143], a[160:163], a[188:191], v[140:143]
  v_exp_f32_e64 v83, v83
  v_mfma_f32_16x16x32_bf16 v[160:163], a[164:167], a[188:191], v[160:163]
  v_exp_f32_e64 v84, v84
  v_mfma_f32_16x16x32_bf16 v[180:183], a[168:171], a[188:191], v[180:183]
  v_cvt_pk_bf16_f32 v125, v82, v83
  v_mfma_f32_16x16x32_bf16 v[200:203], a[172:175], a[188:191], v[200:203]
  v_exp_f32_e64 v85, v85
  v_mfma_f32_16x16x32_bf16 a[212:215], a[216:219], v[104:107], a[212:215]
  v_exp_f32_e64 v86, v86
  v_mfma_f32_16x16x32_bf16 v[144:147], a[144:147], v[104:107], v[144:147]
  v_cvt_pk_bf16_f32 v126, v84, v85
  v_mfma_f32_16x16x32_bf16 v[164:167], a[148:151], v[104:107], v[164:167]
  v_exp_f32_e64 v87, v87
  v_mfma_f32_16x16x32_bf16 v[184:187], a[152:155], v[104:107], v[184:187]
  v_cvt_pk_bf16_f32 v127, v86, v87
  v_mfma_f32_16x16x32_bf16 v[204:207], a[156:159], v[104:107], v[204:207]
  ds_write_b128 v208, v[124:127] offset:4096
  v_mfma_f32_16x16x32_bf16 v[144:147], a[160:163], a[192:195], v[144:147]
  v_mfma_f32_16x16x32_bf16 v[164:167], a[164:167], a[192:195], v[164:167]
  v_mfma_f32_16x16x32_bf16 v[184:187], a[168:171], a[192:195], v[184:187]
  v_mfma_f32_16x16x32_bf16 v[204:207], a[172:175], a[192:195], v[204:207]
  s_waitcnt vmcnt(8) lgkmcnt(0)
  s_barrier
  v_mfma_f32_16x16x32_bf16 v[48:51], a[80:83], a[0:3], v[28:31]
  ds_read_b64_tr_b16 a[144:145], v8 offset:40960
  s_add_u32 m0, s43, 49152
  s_add_u32 s51, s49, 245760
  v_mfma_f32_16x16x32_bf16 v[52:55], a[96:99], a[0:3], v[28:31]
  ds_read_b64_tr_b16 a[146:147], v8 offset:45056
  ds_read_b64_tr_b16 a[148:149], v9 offset:40960
  s_and_b32 s51, s51, 0x3ffff
  v_mfma_f32_16x16x32_bf16 v[48:51], a[84:87], a[20:23], v[48:51]
  ds_read_b64_tr_b16 a[150:151], v9 offset:45056
  ds_read_b64_tr_b16 a[152:153], v10 offset:40960
  v_mfma_f32_16x16x32_bf16 v[52:55], a[100:103], a[20:23], v[52:55]
  buffer_load_dwordx4 v16, s[8:11], s51 offen offset:0 nt lds
  ds_read_b64_tr_b16 a[154:155], v10 offset:45056
  v_mfma_f32_16x16x32_bf16 v[48:51], a[88:91], a[40:43], v[48:51]
  ds_read_b64_tr_b16 a[156:157], v11 offset:40960
  ds_read_b64_tr_b16 a[158:159], v11 offset:45056
  v_mfma_f32_16x16x32_bf16 v[52:55], a[104:107], a[40:43], v[52:55]
  ds_read_b128 a[176:179], v209 offset:0
  ds_read_b64_tr_b16 a[160:161], v12 offset:40960
  v_mfma_f32_16x16x32_bf16 v[48:51], a[92:95], a[60:63], v[48:51]
  ds_read_b64_tr_b16 a[162:163], v12 offset:45056
  ds_read_b64_tr_b16 a[164:165], v13 offset:40960
  v_mfma_f32_16x16x32_bf16 v[52:55], a[108:111], a[60:63], v[52:55]
  ds_read_b64_tr_b16 a[166:167], v13 offset:45056
  ds_read_b64_tr_b16 a[168:169], v14 offset:40960
  v_mfma_f32_16x16x32_bf16 v[56:59], a[80:83], a[4:7], v[32:35]
  ds_read_b64_tr_b16 a[170:171], v14 offset:45056
  buffer_load_dwordx4 v17, s[8:11], s51 offen offset:1024 nt lds
  v_mfma_f32_16x16x32_bf16 v[60:63], a[96:99], a[4:7], v[32:35]
  ds_read_b64_tr_b16 a[172:173], v15 offset:40960
  ds_read_b64_tr_b16 a[174:175], v15 offset:45056
  v_mfma_f32_16x16x32_bf16 v[56:59], a[84:87], a[24:27], v[56:59]
  ds_read_b128 a[180:183], v209 offset:1024
  ds_read_b128 a[184:187], v209 offset:2048
  v_mfma_f32_16x16x32_bf16 v[60:63], a[100:103], a[24:27], v[60:63]
  ds_read_b128 a[188:191], v209 offset:3072
  v_mfma_f32_16x16x32_bf16 v[56:59], a[88:91], a[44:47], v[56:59]
  ds_read_b128 a[192:195], v209 offset:4096
  v_mfma_f32_16x16x32_bf16 v[60:63], a[104:107], a[44:47], v[60:63]
  v_mfma_f32_16x16x32_bf16 v[56:59], a[92:95], a[64:67], v[56:59]
  v_exp_f32_e64 v48, v48
  v_mfma_f32_16x16x32_bf16 v[60:63], a[108:111], a[64:67], v[60:63]
  v_exp_f32_e64 v49, v49
  v_mfma_f32_16x16x32_bf16 v[64:67], a[80:83], a[8:11], v[36:39]
  buffer_load_dwordx4 v18, s[8:11], s51 offen offset:2048 nt lds
  v_mfma_f32_16x16x32_bf16 v[68:71], a[96:99], a[8:11], v[36:39]
  v_exp_f32_e64 v50, v50
  v_mfma_f32_16x16x32_bf16 v[64:67], a[84:87], a[28:31], v[64:67]
  v_cvt_pk_bf16_f32 v88, v48, v49
  v_mfma_f32_16x16x32_bf16 v[68:71], a[100:103], a[28:31], v[68:71]
  v_exp_f32_e64 v51, v51
  v_mfma_f32_16x16x32_bf16 v[64:67], a[88:91], a[48:51], v[64:67]
  v_exp_f32_e64 v52, v52
  v_mfma_f32_16x16x32_bf16 v[68:71], a[104:107], a[48:51], v[68:71]
  s_waitcnt lgkmcnt(0)
  s_nop 0
  v_cvt_pk_bf16_f32 v89, v50, v51
  v_mfma_f32_16x16x32_bf16 v[64:67], a[92:95], a[68:71], v[64:67]
  v_exp_f32_e64 v53, v53
  v_mfma_f32_16x16x32_bf16 v[68:71], a[108:111], a[68:71], v[68:71]
  v_exp_f32_e64 v54, v54
  v_mfma_f32_16x16x32_bf16 a[196:199], a[216:219], v[108:111], a[196:199]
  buffer_load_dwordx4 v19, s[8:11], s51 offen offset:3072 nt lds
  v_cvt_pk_bf16_f32 v90, v52, v53
  v_mfma_f32_16x16x32_bf16 v[128:131], a[144:147], v[108:111], v[128:131]
  v_exp_f32_e64 v55, v55
  v_mfma_f32_16x16x32_bf16 v[148:151], a[148:151], v[108:111], v[148:151]
  ds_read_b128 a[112:115], v4 offset:16384
  v_cvt_pk_bf16_f32 v91, v54, v55
  v_mfma_f32_16x16x32_bf16 v[168:171], a[152:155], v[108:111], v[168:171]
  ds_write_b128 v208, v[88:91] offset:57344
  v_mfma_f32_16x16x32_bf16 v[188:191], a[156:159], v[108:111], v[188:191]
  s_add_u32 m0, s43, 122880
  v_exp_f32_e64 v56, v56
  v_mfma_f32_16x16x32_bf16 v[128:131], a[160:163], a[176:179], v[128:131]
  s_add_u32 s51, s49, 212992
  v_exp_f32_e64 v57, v57
  v_mfma_f32_16x16x32_bf16 v[148:151], a[164:167], a[176:179], v[148:151]
  s_and_b32 s51, s51, 0x3ffff
  v_exp_f32_e64 v58, v58
  v_mfma_f32_16x16x32_bf16 v[168:171], a[168:171], a[176:179], v[168:171]
  ds_read_b128 a[128:131], v4 offset:20480
  v_cvt_pk_bf16_f32 v92, v56, v57
  v_mfma_f32_16x16x32_bf16 v[188:191], a[172:175], a[176:179], v[188:191]
  v_exp_f32_e64 v59, v59
  v_mfma_f32_16x16x32_bf16 v[72:75], a[80:83], a[12:15], v[40:43]
  buffer_load_dwordx4 v20, s[12:15], s51 offen offset:0 nt lds
  v_mfma_f32_16x16x32_bf16 v[76:79], a[96:99], a[12:15], v[40:43]
  v_exp_f32_e64 v60, v60
  v_mfma_f32_16x16x32_bf16 v[72:75], a[84:87], a[32:35], v[72:75]
  ds_read_b128 a[116:119], v5 offset:16384
  v_cvt_pk_bf16_f32 v93, v58, v59
  v_mfma_f32_16x16x32_bf16 v[76:79], a[100:103], a[32:35], v[76:79]
  v_exp_f32_e64 v61, v61
  v_mfma_f32_16x16x32_bf16 v[72:75], a[88:91], a[52:55], v[72:75]
  v_exp_f32_e64 v62, v62
  v_mfma_f32_16x16x32_bf16 v[76:79], a[104:107], a[52:55], v[76:79]
  buffer_load_dwordx4 v21, s[12:15], s51 offen offset:1024 nt lds
  v_cvt_pk_bf16_f32 v94, v60, v61
  v_mfma_f32_16x16x32_bf16 v[72:75], a[92:95], a[72:75], v[72:75]
  v_exp_f32_e64 v63, v63
  v_mfma_f32_16x16x32_bf16 v[76:79], a[108:111], a[72:75], v[76:79]
  ds_read_b128 a[132:135], v5 offset:20480
  v_cvt_pk_bf16_f32 v95, v62, v63
  v_mfma_f32_16x16x32_bf16 a[200:203], a[216:219], v[112:115], a[200:203]
  ds_write_b128 v208, v[92:95] offset:58368
  v_mfma_f32_16x16x32_bf16 v[132:135], a[144:147], v[112:115], v[132:135]
  v_exp_f32_e64 v64, v64
  v_mfma_f32_16x16x32_bf16 v[152:155], a[148:151], v[112:115], v[152:155]
  v_exp_f32_e64 v65, v65
  v_mfma_f32_16x16x32_bf16 v[172:175], a[152:155], v[112:115], v[172:175]
  v_exp_f32_e64 v66, v66
  v_mfma_f32_16x16x32_bf16 v[192:195], a[156:159], v[112:115], v[192:195]
  buffer_load_dwordx4 v20, s[12:15], s51 offen offset:2048 nt lds
  v_cvt_pk_bf16_f32 v96, v64, v65
  v_mfma_f32_16x16x32_bf16 v[132:135], a[160:163], a[180:183], v[132:135]
  v_exp_f32_e64 v67, v67
  v_mfma_f32_16x16x32_bf16 v[152:155], a[164:167], a[180:183], v[152:155]
  v_exp_f32_e64 v68, v68
  v_mfma_f32_16x16x32_bf16 v[172:175], a[168:171], a[180:183], v[172:175]
  ds_read_b128 a[120:123], v6 offset:16384
  v_cvt_pk_bf16_f32 v97, v66, v67
  v_mfma_f32_16x16x32_bf16 v[192:195], a[172:175], a[180:183], v[192:195]
  v_exp_f32_e64 v69, v69
  v_mfma_f32_16x16x32_bf16 v[80:83], a[80:83], a[16:19], v[44:47]
  v_exp_f32_e64 v70, v70
  v_mfma_f32_16x16x32_bf16 v[84:87], a[96:99], a[16:19], v[44:47]
  buffer_load_dwordx4 v21, s[12:15], s51 offen offset:3072 nt lds
  v_cvt_pk_bf16_f32 v98, v68, v69
  v_mfma_f32_16x16x32_bf16 v[80:83], a[84:87], a[36:39], v[80:83]
  v_exp_f32_e64 v71, v71
  v_mfma_f32_16x16x32_bf16 v[84:87], a[100:103], a[36:39], v[84:87]
  ds_read_b128 a[136:139], v6 offset:20480
  v_cvt_pk_bf16_f32 v99, v70, v71
  v_mfma_f32_16x16x32_bf16 v[80:83], a[88:91], a[56:59], v[80:83]
  ds_write_b128 v208, v[96:99] offset:59392
  v_mfma_f32_16x16x32_bf16 v[84:87], a[104:107], a[56:59], v[84:87]
  v_exp_f32_e64 v72, v72
  v_mfma_f32_16x16x32_bf16 v[80:83], a[92:95], a[76:79], v[80:83]
  v_exp_f32_e64 v73, v73
  v_mfma_f32_16x16x32_bf16 v[84:87], a[108:111], a[76:79], v[84:87]
  v_exp_f32_e64 v74, v74
  v_mfma_f32_16x16x32_bf16 a[204:207], a[216:219], v[116:119], a[204:207]
  ds_read_b128 a[124:127], v7 offset:16384
  v_cvt_pk_bf16_f32 v100, v72, v73
  v_mfma_f32_16x16x32_bf16 v[136:139], a[144:147], v[116:119], v[136:139]
  v_exp_f32_e64 v75, v75
  v_mfma_f32_16x16x32_bf16 v[156:159], a[148:151], v[116:119], v[156:159]
  v_mov_b32 v3, 0
  v_mov_b32 v219, 1
  s_lshl_b32 s39, s52, 2
  s_cmp_eq_u32 s32, 0
  s_cselect_b32 s70, 1, 0
  s_mov_b32 s71, 0
  s_mov_b64 exec, s[70:71]
  buffer_load_dword v219, v3, s[56:59], s39 offen offset:64
  s_mov_b64 exec, -1
  v_mfma_f32_16x16x32_bf16 v[176:179], a[152:155], v[116:119], v[176:179]
  v_exp_f32_e64 v76, v76
  v_mfma_f32_16x16x32_bf16 v[196:199], a[156:159], v[116:119], v[196:199]
  v_cvt_pk_bf16_f32 v101, v74, v75
  v_mfma_f32_16x16x32_bf16 v[136:139], a[160:163], a[184:187], v[136:139]
  v_exp_f32_e64 v77, v77
  v_mfma_f32_16x16x32_bf16 v[156:159], a[164:167], a[184:187], v[156:159]
  v_exp_f32_e64 v78, v78
  v_mfma_f32_16x16x32_bf16 v[176:179], a[168:171], a[184:187], v[176:179]
  ds_read_b128 a[140:143], v7 offset:20480
  v_cvt_pk_bf16_f32 v102, v76, v77
  v_mfma_f32_16x16x32_bf16 v[196:199], a[172:175], a[184:187], v[196:199]
  v_exp_f32_e64 v79, v79
  v_mfma_f32_16x16x32_bf16 a[208:211], a[216:219], v[120:123], a[208:211]
  v_cvt_pk_bf16_f32 v103, v78, v79
  v_mfma_f32_16x16x32_bf16 v[140:143], a[144:147], v[120:123], v[140:143]
  ds_write_b128 v208, v[100:103] offset:60416
  v_mfma_f32_16x16x32_bf16 v[160:163], a[148:151], v[120:123], v[160:163]
  v_exp_f32_e64 v80, v80
  v_mfma_f32_16x16x32_bf16 v[180:183], a[152:155], v[120:123], v[180:183]
  v_exp_f32_e64 v81, v81
  v_mfma_f32_16x16x32_bf16 v[200:203], a[156:159], v[120:123], v[200:203]
  v_exp_f32_e64 v82, v82
  v_mfma_f32_16x16x32_bf16 v[140:143], a[160:163], a[188:191], v[140:143]
  v_cvt_pk_bf16_f32 v104, v80, v81
  v_mfma_f32_16x16x32_bf16 v[160:163], a[164:167], a[188:191], v[160:163]
  v_exp_f32_e64 v83, v83
  v_mfma_f32_16x16x32_bf16 v[180:183], a[168:171], a[188:191], v[180:183]
  v_exp_f32_e64 v84, v84
  v_mfma_f32_16x16x32_bf16 v[200:203], a[172:175], a[188:191], v[200:203]
  v_cvt_pk_bf16_f32 v105, v82, v83
  v_mfma_f32_16x16x32_bf16 a[212:215], a[216:219], v[124:127], a[212:215]
  v_exp_f32_e64 v85, v85
  v_mfma_f32_16x16x32_bf16 v[144:147], a[144:147], v[124:127], v[144:147]
  v_exp_f32_e64 v86, v86
  v_mfma_f32_16x16x32_bf16 v[164:167], a[148:151], v[124:127], v[164:167]
  v_cvt_pk_bf16_f32 v106, v84, v85
  v_mfma_f32_16x16x32_bf16 v[184:187], a[152:155], v[124:127], v[184:187]
  v_exp_f32_e64 v87, v87
  v_mfma_f32_16x16x32_bf16 v[204:207], a[156:159], v[124:127], v[204:207]
  v_cvt_pk_bf16_f32 v107, v86, v87
  v_mfma_f32_16x16x32_bf16 v[144:147], a[160:163], a[192:195], v[144:147]
  ds_write_b128 v208, v[104:107] offset:61440
  v_mfma_f32_16x16x32_bf16 v[164:167], a[164:167], a[192:195], v[164:167]
  v_mfma_f32_16x16x32_bf16 v[184:187], a[168:171], a[192:195], v[184:187]
  v_mfma_f32_16x16x32_bf16 v[204:207], a[172:175], a[192:195], v[204:207]
  s_waitcnt vmcnt(9) lgkmcnt(0)
  s_barrier
  v_mfma_f32_16x16x32_bf16 v[48:51], a[112:115], a[0:3], v[28:31]
  ds_read_b64_tr_b16 a[144:145], v8 offset:0
  s_add_u32 m0, s43, 106496
  v_mfma_f32_16x16x32_bf16 v[52:55], a[128:131], a[0:3], v[28:31]
  ds_read_b64_tr_b16 a[146:147], v8 offset:4096
  ds_read_b64_tr_b16 a[148:149], v9 offset:0
  s_add_u32 s51, s49, 229376
  v_mfma_f32_16x16x32_bf16 v[48:51], a[116:119], a[20:23], v[48:51]
  ds_read_b64_tr_b16 a[150:151], v9 offset:4096
  ds_read_b64_tr_b16 a[152:153], v10 offset:0
  v_mfma_f32_16x16x32_bf16 v[52:55], a[132:135], a[20:23], v[52:55]
  ds_read_b64_tr_b16 a[154:155], v10 offset:4096
  ds_read_b64_tr_b16 a[156:157], v11 offset:0
  s_and_b32 s51, s51, 0x3ffff
  v_mfma_f32_16x16x32_bf16 v[48:51], a[120:123], a[40:43], v[48:51]
  ds_read_b64_tr_b16 a[158:159], v11 offset:4096
  ds_read_b128 a[176:179], v209 offset:57344
  v_mfma_f32_16x16x32_bf16 v[52:55], a[136:139], a[40:43], v[52:55]
  ds_read_b64_tr_b16 a[160:161], v12 offset:0
  buffer_load_dwordx4 v20, s[12:15], s51 offen offset:0 nt lds
  v_mfma_f32_16x16x32_bf16 v[48:51], a[124:127], a[60:63], v[48:51]
  ds_read_b64_tr_b16 a[162:163], v12 offset:4096
  ds_read_b64_tr_b16 a[164:165], v13 offset:0
  v_mfma_f32_16x16x32_bf16 v[52:55], a[140:143], a[60:63], v[52:55]
  ds_read_b64_tr_b16 a[166:167], v13 offset:4096
  ds_read_b64_tr_b16 a[168:169], v14 offset:0
  v_mfma_f32_16x16x32_bf16 v[56:59], a[112:115], a[4:7], v[32:35]
  ds_read_b64_tr_b16 a[170:171], v14 offset:4096
  ds_read_b64_tr_b16 a[172:173], v15 offset:0
  v_mfma_f32_16x16x32_bf16 v[60:63], a[128:131], a[4:7], v[32:35]
  ds_read_b64_tr_b16 a[174:175], v15 offset:4096
  v_mfma_f32_16x16x32_bf16 v[56:59], a[116:119], a[24:27], v[56:59]
  ds_read_b128 a[180:183], v209 offset:58368
  ds_read_b128 a[184:187], v209 offset:59392
  v_mfma_f32_16x16x32_bf16 v[60:63], a[132:135], a[24:27], v[60:63]
  ds_read_b128 a[188:191], v209 offset:60416
  v_mfma_f32_16x16x32_bf16 v[56:59], a[120:123], a[44:47], v[56:59]
  ds_read_b128 a[192:195], v209 offset:61440
  v_mfma_f32_16x16x32_bf16 v[60:63], a[136:139], a[44:47], v[60:63]
  v_mfma_f32_16x16x32_bf16 v[56:59], a[124:127], a[64:67], v[56:59]
  v_exp_f32_e64 v48, v48
  v_mfma_f32_16x16x32_bf16 v[60:63], a[140:143], a[64:67], v[60:63]
  v_exp_f32_e64 v49, v49
  v_mfma_f32_16x16x32_bf16 v[64:67], a[112:115], a[8:11], v[36:39]
  v_exp_f32_e64 v50, v50
  v_mfma_f32_16x16x32_bf16 v[68:71], a[128:131], a[8:11], v[36:39]
  v_cvt_pk_bf16_f32 v108, v48, v49
  v_mfma_f32_16x16x32_bf16 v[64:67], a[116:119], a[28:31], v[64:67]
  v_exp_f32_e64 v51, v51
  v_mfma_f32_16x16x32_bf16 v[68:71], a[132:135], a[28:31], v[68:71]
  v_exp_f32_e64 v52, v52
  v_mfma_f32_16x16x32_bf16 v[64:67], a[120:123], a[48:51], v[64:67]
  buffer_load_dwordx4 v21, s[12:15], s51 offen offset:1024 nt lds
  v_cvt_pk_bf16_f32 v109, v50, v51
  v_mfma_f32_16x16x32_bf16 v[68:71], a[136:139], a[48:51], v[68:71]
  s_waitcnt lgkmcnt(0)
  s_nop 0
  v_mfma_f32_16x16x32_bf16 v[64:67], a[124:127], a[68:71], v[64:67]
  v_exp_f32_e64 v53, v53
  v_mfma_f32_16x16x32_bf16 v[68:71], a[140:143], a[68:71], v[68:71]
  v_exp_f32_e64 v54, v54
  v_mfma_f32_16x16x32_bf16 a[196:199], a[216:219], v[88:91], a[196:199]
  ds_read_b128 a[80:83], v4 offset:32768
  v_cvt_pk_bf16_f32 v110, v52, v53
  v_mfma_f32_16x16x32_bf16 v[128:131], a[144:147], v[88:91], v[128:131]
  v_exp_f32_e64 v55, v55
  v_mfma_f32_16x16x32_bf16 v[148:151], a[148:151], v[88:91], v[148:151]
  v_cvt_pk_bf16_f32 v111, v54, v55
  v_mfma_f32_16x16x32_bf16 v[168:171], a[152:155], v[88:91], v[168:171]
  ds_write_b128 v208, v[108:111] offset:0
  v_mfma_f32_16x16x32_bf16 v[188:191], a[156:159], v[88:91], v[188:191]
  v_exp_f32_e64 v56, v56
  v_mfma_f32_16x16x32_bf16 v[128:131], a[160:163], a[176:179], v[128:131]
  v_exp_f32_e64 v57, v57
  v_mfma_f32_16x16x32_bf16 v[148:151], a[164:167], a[176:179], v[148:151]
  v_exp_f32_e64 v58, v58
  v_mfma_f32_16x16x32_bf16 v[168:171], a[168:171], a[176:179], v[168:171]
  ds_read_b128 a[96:99], v4 offset:36864
  v_cvt_pk_bf16_f32 v112, v56, v57
  v_mfma_f32_16x16x32_bf16 v[188:191], a[172:175], a[176:179], v[188:191]
  v_exp_f32_e64 v59, v59
  v_mfma_f32_16x16x32_bf16 v[72:75], a[112:115], a[12:15], v[40:43]
  v_exp_f32_e64 v60, v60
  v_mfma_f32_16x16x32_bf16 v[76:79], a[128:131], a[12:15], v[40:43]
  buffer_load_dwordx4 v20, s[12:15], s51 offen offset:2048 nt lds
  v_cvt_pk_bf16_f32 v113, v58, v59
  v_mfma_f32_16x16x32_bf16 v[72:75], a[116:119], a[32:35], v[72:75]
  v_exp_f32_e64 v61, v61
  v_mfma_f32_16x16x32_bf16 v[76:79], a[132:135], a[32:35], v[76:79]
  v_exp_f32_e64 v62, v62
  v_mfma_f32_16x16x32_bf16 v[72:75], a[120:123], a[52:55], v[72:75]
  ds_read_b128 a[84:87], v5 offset:32768
  v_cvt_pk_bf16_f32 v114, v60, v61
  v_mfma_f32_16x16x32_bf16 v[76:79], a[136:139], a[52:55], v[76:79]
  v_exp_f32_e64 v63, v63
  v_mfma_f32_16x16x32_bf16 v[72:75], a[124:127], a[72:75], v[72:75]
  v_cvt_pk_bf16_f32 v115, v62, v63
  v_mfma_f32_16x16x32_bf16 v[76:79], a[140:143], a[72:75], v[76:79]
  ds_write_b128 v208, v[112:115] offset:1024
  v_mfma_f32_16x16x32_bf16 a[200:203], a[216:219], v[92:95], a[200:203]
  v_exp_f32_e64 v64, v64
  v_mfma_f32_16x16x32_bf16 v[132:135], a[144:147], v[92:95], v[132:135]
  v_exp_f32_e64 v65, v65
  v_mfma_f32_16x16x32_bf16 v[152:155], a[148:151], v[92:95], v[152:155]
  ds_read_b128 a[100:103], v5 offset:36864
  v_mfma_f32_16x16x32_bf16 v[172:175], a[152:155], v[92:95], v[172:175]
  v_exp_f32_e64 v66, v66
  v_mfma_f32_16x16x32_bf16 v[192:195], a[156:159], v[92:95], v[192:195]
  v_cvt_pk_bf16_f32 v116, v64, v65
  v_mfma_f32_16x16x32_bf16 v[132:135], a[160:163], a[180:183], v[132:135]
  v_exp_f32_e64 v67, v67
  v_mfma_f32_16x16x32_bf16 v[152:155], a[164:167], a[180:183], v[152:155]
  v_exp_f32_e64 v68, v68
  v_mfma_f32_16x16x32_bf16 v[172:175], a[168:171], a[180:183], v[172:175]
  ds_read_b128 a[88:91], v6 offset:32768
  v_cvt_pk_bf16_f32 v117, v66, v67
  v_mfma_f32_16x16x32_bf16 v[192:195], a[172:175], a[180:183], v[192:195]
  v_exp_f32_e64 v69, v69
  v_mfma_f32_16x16x32_bf16 v[80:83], a[112:115], a[16:19], v[44:47]
  v_exp_f32_e64 v70, v70
  v_mfma_f32_16x16x32_bf16 v[84:87], a[128:131], a[16:19], v[44:47]
  buffer_load_dwordx4 v21, s[12:15], s51 offen offset:3072 nt lds
  v_cvt_pk_bf16_f32 v118, v68, v69
  v_mfma_f32_16x16x32_bf16 v[80:83], a[116:119], a[36:39], v[80:83]
  v_exp_f32_e64 v71, v71
  v_mfma_f32_16x16x32_bf16 v[84:87], a[132:135], a[36:39], v[84:87]
  ds_read_b128 a[104:107], v6 offset:36864
  v_cvt_pk_bf16_f32 v119, v70, v71
  v_mfma_f32_16x16x32_bf16 v[80:83], a[120:123], a[56:59], v[80:83]
  ds_write_b128 v208, v[116:119] offset:2048
  v_mfma_f32_16x16x32_bf16 v[84:87], a[136:139], a[56:59], v[84:87]
  v_exp_f32_e64 v72, v72
  v_mfma_f32_16x16x32_bf16 v[80:83], a[124:127], a[76:79], v[80:83]
  v_exp_f32_e64 v73, v73
  v_mfma_f32_16x16x32_bf16 v[84:87], a[140:143], a[76:79], v[84:87]
  v_exp_f32_e64 v74, v74
  v_mfma_f32_16x16x32_bf16 a[204:207], a[216:219], v[96:99], a[204:207]
  ds_read_b128 a[92:95], v7 offset:32768
  v_cvt_pk_bf16_f32 v120, v72, v73
  v_mfma_f32_16x16x32_bf16 v[136:139], a[144:147], v[96:99], v[136:139]
  v_exp_f32_e64 v75, v75
  v_mfma_f32_16x16x32_bf16 v[156:159], a[148:151], v[96:99], v[156:159]
  v_exp_f32_e64 v76, v76
  v_mfma_f32_16x16x32_bf16 v[176:179], a[152:155], v[96:99], v[176:179]
  v_cvt_pk_bf16_f32 v121, v74, v75
  v_mfma_f32_16x16x32_bf16 v[196:199], a[156:159], v[96:99], v[196:199]
  v_exp_f32_e64 v77, v77
  v_mfma_f32_16x16x32_bf16 v[136:139], a[160:163], a[184:187], v[136:139]
  v_exp_f32_e64 v78, v78
  v_mfma_f32_16x16x32_bf16 v[156:159], a[164:167], a[184:187], v[156:159]
  ds_read_b128 a[108:111], v7 offset:36864
  v_cvt_pk_bf16_f32 v122, v76, v77
  v_mfma_f32_16x16x32_bf16 v[176:179], a[168:171], a[184:187], v[176:179]
  v_exp_f32_e64 v79, v79
  v_mfma_f32_16x16x32_bf16 v[196:199], a[172:175], a[184:187], v[196:199]
  v_cvt_pk_bf16_f32 v123, v78, v79
  v_mfma_f32_16x16x32_bf16 a[208:211], a[216:219], v[100:103], a[208:211]
  ds_write_b128 v208, v[120:123] offset:3072
  v_mfma_f32_16x16x32_bf16 v[140:143], a[144:147], v[100:103], v[140:143]
  v_exp_f32_e64 v80, v80
  v_mfma_f32_16x16x32_bf16 v[160:163], a[148:151], v[100:103], v[160:163]
  v_exp_f32_e64 v81, v81
  v_mfma_f32_16x16x32_bf16 v[180:183], a[152:155], v[100:103], v[180:183]
  v_exp_f32_e64 v82, v82
  v_mfma_f32_16x16x32_bf16 v[200:203], a[156:159], v[100:103], v[200:203]
  v_cvt_pk_bf16_f32 v124, v80, v81
  v_mfma_f32_16x16x32_bf16 v[140:143], a[160:163], a[188:191], v[140:143]
  v_exp_f32_e64 v83, v83
  v_mfma_f32_16x16x32_bf16 v[160:163], a[164:167], a[188:191], v[160:163]
  v_exp_f32_e64 v84, v84
  v_mfma_f32_16x16x32_bf16 v[180:183], a[168:171], a[188:191], v[180:183]
  v_cvt_pk_bf16_f32 v125, v82, v83
  v_mfma_f32_16x16x32_bf16 v[200:203], a[172:175], a[188:191], v[200:203]
  v_exp_f32_e64 v85, v85
  v_mfma_f32_16x16x32_bf16 a[212:215], a[216:219], v[104:107], a[212:215]
  v_exp_f32_e64 v86, v86
  v_mfma_f32_16x16x32_bf16 v[144:147], a[144:147], v[104:107], v[144:147]
  v_cvt_pk_bf16_f32 v126, v84, v85
  v_mfma_f32_16x16x32_bf16 v[164:167], a[148:151], v[104:107], v[164:167]
  v_exp_f32_e64 v87, v87
  v_mfma_f32_16x16x32_bf16 v[184:187], a[152:155], v[104:107], v[184:187]
  v_cvt_pk_bf16_f32 v127, v86, v87
  v_mfma_f32_16x16x32_bf16 v[204:207], a[156:159], v[104:107], v[204:207]
  ds_write_b128 v208, v[124:127] offset:4096
  v_mfma_f32_16x16x32_bf16 v[144:147], a[160:163], a[192:195], v[144:147]
  v_mfma_f32_16x16x32_bf16 v[164:167], a[164:167], a[192:195], v[164:167]
  v_mfma_f32_16x16x32_bf16 v[184:187], a[168:171], a[192:195], v[184:187]
  v_mfma_f32_16x16x32_bf16 v[204:207], a[172:175], a[192:195], v[204:207]
  s_waitcnt vmcnt(5) lgkmcnt(0)
  s_barrier
  v_mfma_f32_16x16x32_bf16 v[48:51], a[80:83], a[0:3], v[28:31]
  ds_read_b64_tr_b16 a[144:145], v8 offset:57344
  s_add_u32 m0, s43, 65536
  s_add_u32 s51, s49, 245760
  v_mfma_f32_16x16x32_bf16 v[52:55], a[96:99], a[0:3], v[28:31]
  ds_read_b64_tr_b16 a[146:147], v8 offset:61440
  s_and_b32 s51, s51, 0x3ffff
  v_mfma_f32_16x16x32_bf16 v[48:51], a[84:87], a[20:23], v[48:51]
  buffer_load_dwordx4 v20, s[12:15], s51 offen offset:0 nt lds
  ds_read_b64_tr_b16 a[148:149], v9 offset:57344
  v_mfma_f32_16x16x32_bf16 v[52:55], a[100:103], a[20:23], v[52:55]
  ds_read_b64_tr_b16 a[150:151], v9 offset:61440
  ds_read_b64_tr_b16 a[152:153], v10 offset:57344
  v_mfma_f32_16x16x32_bf16 v[48:51], a[88:91], a[40:43], v[48:51]
  ds_read_b64_tr_b16 a[154:155], v10 offset:61440
  buffer_load_dwordx4 v21, s[12:15], s51 offen offset:1024 nt lds
  v_mfma_f32_16x16x32_bf16 v[52:55], a[104:107], a[40:43], v[52:55]
  ds_read_b64_tr_b16 a[156:157], v11 offset:57344
  ds_read_b64_tr_b16 a[158:159], v11 offset:61440
  v_mfma_f32_16x16x32_bf16 v[48:51], a[92:95], a[60:63], v[48:51]
  ds_read_b128 a[176:179], v209 offset:0
  ds_read_b64_tr_b16 a[160:161], v12 offset:57344
  v_mfma_f32_16x16x32_bf16 v[52:55], a[108:111], a[60:63], v[52:55]
  buffer_load_dwordx4 v20, s[12:15], s51 offen offset:2048 nt lds
  ds_read_b64_tr_b16 a[162:163], v12 offset:61440
  v_mfma_f32_16x16x32_bf16 v[56:59], a[80:83], a[4:7], v[32:35]
  ds_read_b64_tr_b16 a[164:165], v13 offset:57344
  ds_read_b64_tr_b16 a[166:167], v13 offset:61440
  v_mfma_f32_16x16x32_bf16 v[60:63], a[96:99], a[4:7], v[32:35]
  ds_read_b64_tr_b16 a[168:169], v14 offset:57344
  buffer_load_dwordx4 v21, s[12:15], s51 offen offset:3072 nt lds
  v_mfma_f32_16x16x32_bf16 v[56:59], a[84:87], a[24:27], v[56:59]
  s_nop 0
  ds_read_b64_tr_b16 a[170:171], v14 offset:61440
  ds_read_b64_tr_b16 a[172:173], v15 offset:57344
  s_add_u32 m0, s53, 0x0
  v_mfma_f32_16x16x32_bf16 v[60:63], a[100:103], a[24:27], v[60:63]
  s_nop 0
  ds_read_b64_tr_b16 a[174:175], v15 offset:61440
  ds_read_b128 a[180:183], v209 offset:1024
  s_add_u32 s51, s16, 0x0
  v_mfma_f32_16x16x32_bf16 v[56:59], a[88:91], a[44:47], v[56:59]
  ds_read_b128 a[184:187], v209 offset:2048
  ds_read_b128 a[188:191], v209 offset:3072
  v_mfma_f32_16x16x32_bf16 v[60:63], a[104:107], a[44:47], v[60:63]
  buffer_load_dwordx4 v24, s[20:23], s51 offen offset:0 lds
  ds_read_b128 a[192:195], v209 offset:4096
  v_mfma_f32_16x16x32_bf16 v[56:59], a[92:95], a[64:67], v[56:59]
  s_add_u32 s51, s16, 8192
  v_exp_f32_e64 v48, v48
  v_mfma_f32_16x16x32_bf16 v[60:63], a[108:111], a[64:67], v[60:63]
  v_exp_f32_e64 v49, v49
  v_mfma_f32_16x16x32_bf16 v[64:67], a[80:83], a[8:11], v[36:39]
  buffer_load_dwordx4 v24, s[20:23], s51 offen offset:1024 lds
  v_mfma_f32_16x16x32_bf16 v[68:71], a[96:99], a[8:11], v[36:39]
  s_add_u32 s51, s16, 16384
  v_exp_f32_e64 v50, v50
  v_mfma_f32_16x16x32_bf16 v[64:67], a[84:87], a[28:31], v[64:67]
  buffer_load_dwordx4 v24, s[20:23], s51 offen offset:2048 lds
  v_cvt_pk_bf16_f32 v88, v48, v49
  v_mfma_f32_16x16x32_bf16 v[68:71], a[100:103], a[28:31], v[68:71]
  v_exp_f32_e64 v51, v51
  v_mfma_f32_16x16x32_bf16 v[64:67], a[88:91], a[48:51], v[64:67]
  s_add_u32 s51, s16, 24576
  v_exp_f32_e64 v52, v52
  v_mfma_f32_16x16x32_bf16 v[68:71], a[104:107], a[48:51], v[68:71]
  s_waitcnt lgkmcnt(0)
  s_nop 0
  v_cvt_pk_bf16_f32 v89, v50, v51
  v_mfma_f32_16x16x32_bf16 v[64:67], a[92:95], a[68:71], v[64:67]
  v_exp_f32_e64 v53, v53
  v_mfma_f32_16x16x32_bf16 v[68:71], a[108:111], a[68:71], v[68:71]
  buffer_load_dwordx4 v24, s[20:23], s51 offen offset:3072 lds
  s_add_u32 m0, s53, 4096
  v_mfma_f32_16x16x32_bf16 a[196:199], a[216:219], v[108:111], a[196:199]
  s_add_u32 s51, s16, 36864
  v_exp_f32_e64 v54, v54
  v_mfma_f32_16x16x32_bf16 v[128:131], a[144:147], v[108:111], v[128:131]
  ds_read_b128 a[112:115], v4 offset:49152
  v_cvt_pk_bf16_f32 v90, v52, v53
  v_mfma_f32_16x16x32_bf16 v[148:151], a[148:151], v[108:111], v[148:151]
  v_exp_f32_e64 v55, v55
  v_mfma_f32_16x16x32_bf16 v[168:171], a[152:155], v[108:111], v[168:171]
  buffer_load_dwordx4 v24, s[20:23], s51 offen offset:0 lds
  s_add_u32 s51, s16, 45056
  v_cvt_pk_bf16_f32 v91, v54, v55
  v_mfma_f32_16x16x32_bf16 v[188:191], a[156:159], v[108:111], v[188:191]
  ds_write_b128 v208, v[88:91] offset:57344
  v_mfma_f32_16x16x32_bf16 v[128:131], a[160:163], a[176:179], v[128:131]
  v_exp_f32_e64 v56, v56
  v_mfma_f32_16x16x32_bf16 v[148:151], a[164:167], a[176:179], v[148:151]
  v_exp_f32_e64 v57, v57
  v_mfma_f32_16x16x32_bf16 v[168:171], a[168:171], a[176:179], v[168:171]
  buffer_load_dwordx4 v24, s[20:23], s51 offen offset:1024 lds
  ds_read_b128 a[128:131], v4 offset:53248
  s_add_u32 s51, s16, 53248
  v_mfma_f32_16x16x32_bf16 v[188:191], a[172:175], a[176:179], v[188:191]
  v_exp_f32_e64 v58, v58
  v_mfma_f32_16x16x32_bf16 v[72:75], a[80:83], a[12:15], v[40:43]
  buffer_load_dwordx4 v24, s[20:23], s51 offen offset:2048 lds
  s_add_u32 s51, s16, 61440
  v_cvt_pk_bf16_f32 v92, v56, v57
  v_mfma_f32_16x16x32_bf16 v[76:79], a[96:99], a[12:15], v[40:43]
  v_exp_f32_e64 v59, v59
  v_mfma_f32_16x16x32_bf16 v[72:75], a[84:87], a[32:35], v[72:75]
  v_exp_f32_e64 v60, v60
  v_mfma_f32_16x16x32_bf16 v[76:79], a[100:103], a[32:35], v[76:79]
  buffer_load_dwordx4 v24, s[20:23], s51 offen offset:3072 lds
  v_cvt_pk_bf16_f32 v93, v58, v59
  v_mfma_f32_16x16x32_bf16 v[72:75], a[88:91], a[52:55], v[72:75]
  v_exp_f32_e64 v61, v61
  v_mfma_f32_16x16x32_bf16 v[76:79], a[104:107], a[52:55], v[76:79]
  v_exp_f32_e64 v62, v62
  v_mfma_f32_16x16x32_bf16 v[72:75], a[92:95], a[72:75], v[72:75]
  ds_read_b128 a[116:119], v5 offset:49152
  v_cvt_pk_bf16_f32 v94, v60, v61
  v_mfma_f32_16x16x32_bf16 v[76:79], a[108:111], a[72:75], v[76:79]
  v_exp_f32_e64 v63, v63
  v_mfma_f32_16x16x32_bf16 a[200:203], a[216:219], v[112:115], a[200:203]
  s_nop 0
  s_add_u32 s16, s16, 128
  s_cmp_eq_u32 s16, 1152
  s_cselect_b32 s16, 0, s16
  v_cvt_pk_bf16_f32 v95, v62, v63
  v_mfma_f32_16x16x32_bf16 v[132:135], a[144:147], v[112:115], v[132:135]
  ds_write_b128 v208, v[92:95] offset:58368
  v_mfma_f32_16x16x32_bf16 v[152:155], a[148:151], v[112:115], v[152:155]
  v_exp_f32_e64 v64, v64
  v_mfma_f32_16x16x32_bf16 v[172:175], a[152:155], v[112:115], v[172:175]
  v_exp_f32_e64 v65, v65
  v_mfma_f32_16x16x32_bf16 v[192:195], a[156:159], v[112:115], v[192:195]
  ds_read_b128 a[132:135], v5 offset:53248
  v_exp_f32_e64 v66, v66
  v_mfma_f32_16x16x32_bf16 v[132:135], a[160:163], a[180:183], v[132:135]
  ds_read_b128 a[120:123], v6 offset:49152
  v_cvt_pk_bf16_f32 v96, v64, v65
  v_mfma_f32_16x16x32_bf16 v[152:155], a[164:167], a[180:183], v[152:155]
  v_exp_f32_e64 v67, v67
  v_mfma_f32_16x16x32_bf16 v[172:175], a[168:171], a[180:183], v[172:175]
  v_exp_f32_e64 v68, v68
  v_mfma_f32_16x16x32_bf16 v[192:195], a[172:175], a[180:183], v[192:195]
  v_cvt_pk_bf16_f32 v97, v66, v67
  v_mfma_f32_16x16x32_bf16 v[80:83], a[80:83], a[16:19], v[44:47]
  v_exp_f32_e64 v69, v69
  v_mfma_f32_16x16x32_bf16 v[84:87], a[96:99], a[16:19], v[44:47]
  v_exp_f32_e64 v70, v70
  v_mfma_f32_16x16x32_bf16 v[80:83], a[84:87], a[36:39], v[80:83]
  ds_read_b128 a[136:139], v6 offset:53248
  v_cvt_pk_bf16_f32 v98, v68, v69
  v_mfma_f32_16x16x32_bf16 v[84:87], a[100:103], a[36:39], v[84:87]
  v_exp_f32_e64 v71, v71
  v_mfma_f32_16x16x32_bf16 v[80:83], a[88:91], a[56:59], v[80:83]
  v_cvt_pk_bf16_f32 v99, v70, v71
  v_mfma_f32_16x16x32_bf16 v[84:87], a[104:107], a[56:59], v[84:87]
  ds_write_b128 v208, v[96:99] offset:59392
  v_mfma_f32_16x16x32_bf16 v[80:83], a[92:95], a[76:79], v[80:83]
  v_exp_f32_e64 v72, v72
  v_mfma_f32_16x16x32_bf16 v[84:87], a[108:111], a[76:79], v[84:87]
  v_exp_f32_e64 v73, v73
  v_mfma_f32_16x16x32_bf16 a[204:207], a[216:219], v[116:119], a[204:207]
  v_exp_f32_e64 v74, v74
  v_mfma_f32_16x16x32_bf16 v[136:139], a[144:147], v[116:119], v[136:139]
  ds_read_b128 a[124:127], v7 offset:49152
  v_cvt_pk_bf16_f32 v100, v72, v73
  v_mfma_f32_16x16x32_bf16 v[156:159], a[148:151], v[116:119], v[156:159]
  v_exp_f32_e64 v75, v75
  v_mfma_f32_16x16x32_bf16 v[176:179], a[152:155], v[116:119], v[176:179]
  v_exp_f32_e64 v76, v76
  v_mfma_f32_16x16x32_bf16 v[196:199], a[156:159], v[116:119], v[196:199]
  v_cvt_pk_bf16_f32 v101, v74, v75
  v_mfma_f32_16x16x32_bf16 v[136:139], a[160:163], a[184:187], v[136:139]
  v_exp_f32_e64 v77, v77
  v_mfma_f32_16x16x32_bf16 v[156:159], a[164:167], a[184:187], v[156:159]
  v_exp_f32_e64 v78, v78
  v_mfma_f32_16x16x32_bf16 v[176:179], a[168:171], a[184:187], v[176:179]
  ds_read_b128 a[140:143], v7 offset:53248
  v_cvt_pk_bf16_f32 v102, v76, v77
  v_mfma_f32_16x16x32_bf16 v[196:199], a[172:175], a[184:187], v[196:199]
  v_exp_f32_e64 v79, v79
  v_mfma_f32_16x16x32_bf16 a[208:211], a[216:219], v[120:123], a[208:211]
  v_cvt_pk_bf16_f32 v103, v78, v79
  v_mfma_f32_16x16x32_bf16 v[140:143], a[144:147], v[120:123], v[140:143]
  ds_write_b128 v208, v[100:103] offset:60416
  v_mfma_f32_16x16x32_bf16 v[160:163], a[148:151], v[120:123], v[160:163]
  v_exp_f32_e64 v80, v80
  v_mfma_f32_16x16x32_bf16 v[180:183], a[152:155], v[120:123], v[180:183]
  v_exp_f32_e64 v81, v81
  v_mfma_f32_16x16x32_bf16 v[200:203], a[156:159], v[120:123], v[200:203]
  v_exp_f32_e64 v82, v82
  v_mfma_f32_16x16x32_bf16 v[140:143], a[160:163], a[188:191], v[140:143]
  v_cvt_pk_bf16_f32 v104, v80, v81
  v_mfma_f32_16x16x32_bf16 v[160:163], a[164:167], a[188:191], v[160:163]
  v_exp_f32_e64 v83, v83
  v_mfma_f32_16x16x32_bf16 v[180:183], a[168:171], a[188:191], v[180:183]
  v_exp_f32_e64 v84, v84
  v_mfma_f32_16x16x32_bf16 v[200:203], a[172:175], a[188:191], v[200:203]
  v_cvt_pk_bf16_f32 v105, v82, v83
  v_mfma_f32_16x16x32_bf16 a[212:215], a[216:219], v[124:127], a[212:215]
  v_exp_f32_e64 v85, v85
  v_mfma_f32_16x16x32_bf16 v[144:147], a[144:147], v[124:127], v[144:147]
  v_exp_f32_e64 v86, v86
  v_mfma_f32_16x16x32_bf16 v[164:167], a[148:151], v[124:127], v[164:167]
  v_cvt_pk_bf16_f32 v106, v84, v85
  v_mfma_f32_16x16x32_bf16 v[184:187], a[152:155], v[124:127], v[184:187]
  v_exp_f32_e64 v87, v87
  v_mfma_f32_16x16x32_bf16 v[204:207], a[156:159], v[124:127], v[204:207]
  v_cvt_pk_bf16_f32 v107, v86, v87
  v_mfma_f32_16x16x32_bf16 v[144:147], a[160:163], a[192:195], v[144:147]
  ds_write_b128 v208, v[104:107] offset:61440
  v_mfma_f32_16x16x32_bf16 v[164:167], a[164:167], a[192:195], v[164:167]
  v_mfma_f32_16x16x32_bf16 v[184:187], a[168:171], a[192:195], v[184:187]
  v_mfma_f32_16x16x32_bf16 v[204:207], a[172:175], a[192:195], v[204:207]
  s_waitcnt vmcnt(16)
  v_cmp_ne_u32 vcc, 1, v219
  s_cbranch_vccz L_rdy_ok
  v_mov_b32 v3, 0
  s_lshl_b32 s39, s52, 2
L_rdy:
  s_sleep 2
  buffer_load_dword v219, v3, s[56:59], s39 offen offset:64 sc1
  s_waitcnt vmcnt(0)
  v_cmp_ne_u32 vcc, 1, v219
  s_cbranch_vccnz L_rdy
L_rdy_ok:
  s_waitcnt vmcnt(12) lgkmcnt(0)
  s_barrier
  s_nop 0
  v_mfma_f32_16x16x32_bf16 v[48:51], a[112:115], a[0:3], v[28:31]
  s_nop 0
  ds_read_b64_tr_b16 a[144:145], v8 offset:40960
  s_add_u32 m0, s53, 32768
  s_add_u32 s51, s16, 0x0
  v_mfma_f32_16x16x32_bf16 v[52:55], a[128:131], a[0:3], v[28:31]
  ds_read_b64_tr_b16 a[146:147], v8 offset:45056
  buffer_load_dwordx4 v24, s[20:23], s51 offen offset:0 lds
  v_mfma_f32_16x16x32_bf16 v[48:51], a[116:119], a[20:23], v[48:51]
  ds_read_b64_tr_b16 a[148:149], v9 offset:40960
  ds_read_b64_tr_b16 a[150:151], v9 offset:45056
  v_mfma_f32_16x16x32_bf16 v[52:55], a[132:135], a[20:23], v[52:55]
  ds_read_b64_tr_b16 a[152:153], v10 offset:40960
  ds_read_b64_tr_b16 a[154:155], v10 offset:45056
  s_add_u32 s51, s16, 8192
  v_mfma_f32_16x16x32_bf16 v[48:51], a[120:123], a[40:43], v[48:51]
  ds_read_b64_tr_b16 a[156:157], v11 offset:40960
  ds_read_b64_tr_b16 a[158:159], v11 offset:45056
  v_mfma_f32_16x16x32_bf16 v[52:55], a[136:139], a[40:43], v[52:55]
  ds_read_b128 a[176:179], v209 offset:57344
  buffer_load_dwordx4 v24, s[20:23], s51 offen offset:1024 lds
  v_mfma_f32_16x16x32_bf16 v[48:51], a[124:127], a[60:63], v[48:51]
  ds_read_b64_tr_b16 a[160:161], v12 offset:40960
  ds_read_b64_tr_b16 a[162:163], v12 offset:45056
  v_mfma_f32_16x16x32_bf16 v[52:55], a[140:143], a[60:63], v[52:55]
  ds_read_b64_tr_b16 a[164:165], v13 offset:40960
  ds_read_b64_tr_b16 a[166:167], v13 offset:45056
  v_mfma_f32_16x16x32_bf16 v[56:59], a[112:115], a[4:7], v[32:35]
  ds_read_b64_tr_b16 a[168:169], v14 offset:40960
  s_add_u32 s51, s16, 16384
  v_mfma_f32_16x16x32_bf16 v[60:63], a[128:131], a[4:7], v[32:35]
  ds_read_b64_tr_b16 a[170:171], v14 offset:45056
  buffer_load_dwordx4 v24, s[20:23], s51 offen offset:2048 lds
  v_mfma_f32_16x16x32_bf16 v[56:59], a[116:119], a[24:27], v[56:59]
  ds_read_b64_tr_b16 a[172:173], v15 offset:40960
  ds_read_b64_tr_b16 a[174:175], v15 offset:45056
  v_mfma_f32_16x16x32_bf16 v[60:63], a[132:135], a[24:27], v[60:63]
  ds_read_b128 a[180:183], v209 offset:58368
  ds_read_b128 a[184:187], v209 offset:59392
  v_mfma_f32_16x16x32_bf16 v[56:59], a[120:123], a[44:47], v[56:59]
  ds_read_b128 a[188:191], v209 offset:60416
  ds_read_b128 a[192:195], v209 offset:61440
  s_add_u32 s51, s16, 24576
  v_mfma_f32_16x16x32_bf16 v[60:63], a[136:139], a[44:47], v[60:63]
  buffer_load_dwordx4 v24, s[20:23], s51 offen offset:3072 lds
  v_mfma_f32_16x16x32_bf16 v[56:59], a[124:127], a[64:67], v[56:59]
  v_exp_f32_e64 v48, v48
  v_mfma_f32_16x16x32_bf16 v[60:63], a[140:143], a[64:67], v[60:63]
  v_exp_f32_e64 v49, v49
  v_mfma_f32_16x16x32_bf16 v[64:67], a[112:115], a[8:11], v[36:39]
  v_exp_f32_e64 v50, v50
  v_mfma_f32_16x16x32_bf16 v[68:71], a[128:131], a[8:11], v[36:39]
  s_add_u32 m0, s53, 36864
  s_add_u32 s51, s16, 36864
  v_cvt_pk_bf16_f32 v108, v48, v49
  v_mfma_f32_16x16x32_bf16 v[64:67], a[116:119], a[28:31], v[64:67]
  v_exp_f32_e64 v51, v51
  v_mfma_f32_16x16x32_bf16 v[68:71], a[132:135], a[28:31], v[68:71]
  v_exp_f32_e64 v52, v52
  v_mfma_f32_16x16x32_bf16 v[64:67], a[120:123], a[48:51], v[64:67]
  buffer_load_dwordx4 v24, s[20:23], s51 offen offset:0 lds
  v_cvt_pk_bf16_f32 v109, v50, v51
  v_mfma_f32_16x16x32_bf16 v[68:71], a[136:139], a[48:51], v[68:71]
  s_waitcnt lgkmcnt(0)
  s_nop 0
  v_mfma_f32_16x16x32_bf16 v[64:67], a[124:127], a[68:71], v[64:67]
  s_add_u32 s51, s16, 45056
  v_exp_f32_e64 v53, v53
  v_mfma_f32_16x16x32_bf16 v[68:71], a[140:143], a[68:71], v[68:71]
  v_exp_f32_e64 v54, v54
  v_mfma_f32_16x16x32_bf16 a[196:199], a[216:219], v[88:91], a[196:199]
  buffer_load_dwordx4 v24, s[20:23], s51 offen offset:1024 lds
  v_cvt_pk_bf16_f32 v110, v52, v53
  v_mfma_f32_16x16x32_bf16 v[128:131], a[144:147], v[88:91], v[128:131]
  v_exp_f32_e64 v55, v55
  v_mfma_f32_16x16x32_bf16 v[148:151], a[148:151], v[88:91], v[148:151]
  s_add_u32 s51, s16, 53248
  v_cvt_pk_bf16_f32 v111, v54, v55
  v_mfma_f32_16x16x32_bf16 v[168:171], a[152:155], v[88:91], v[168:171]
  ds_write_b128 v208, v[108:111] offset:0
  v_mfma_f32_16x16x32_bf16 v[188:191], a[156:159], v[88:91], v[188:191]
  v_exp_f32_e64 v56, v56
  v_mfma_f32_16x16x32_bf16 v[128:131], a[160:163], a[176:179], v[128:131]
  v_exp_f32_e64 v57, v57
  v_mfma_f32_16x16x32_bf16 v[148:151], a[164:167], a[176:179], v[148:151]
  buffer_load_dwordx4 v24, s[20:23], s51 offen offset:2048 lds
  s_add_u32 s51, s16, 61440
  v_mfma_f32_16x16x32_bf16 v[168:171], a[168:171], a[176:179], v[168:171]
  v_exp_f32_e64 v58, v58
  v_mfma_f32_16x16x32_bf16 v[188:191], a[172:175], a[176:179], v[188:191]
  buffer_load_dwordx4 v24, s[20:23], s51 offen offset:3072 lds
  v_cvt_pk_bf16_f32 v112, v56, v57
  v_mfma_f32_16x16x32_bf16 v[72:75], a[112:115], a[12:15], v[40:43]
  v_exp_f32_e64 v59, v59
  v_mfma_f32_16x16x32_bf16 v[76:79], a[128:131], a[12:15], v[40:43]
  v_exp_f32_e64 v60, v60
  v_mfma_f32_16x16x32_bf16 v[72:75], a[116:119], a[32:35], v[72:75]
  v_cvt_pk_bf16_f32 v113, v58, v59
  v_mfma_f32_16x16x32_bf16 v[76:79], a[132:135], a[32:35], v[76:79]
  v_exp_f32_e64 v61, v61
  v_mfma_f32_16x16x32_bf16 v[72:75], a[120:123], a[52:55], v[72:75]
  v_exp_f32_e64 v62, v62
  v_mfma_f32_16x16x32_bf16 v[76:79], a[136:139], a[52:55], v[76:79]
  v_cvt_pk_bf16_f32 v114, v60, v61
  v_mfma_f32_16x16x32_bf16 v[72:75], a[124:127], a[72:75], v[72:75]
  s_nop 0
  s_add_u32 s16, s16, 128
  s_cmp_eq_u32 s16, 1152
  s_cselect_b32 s16, 0, s16
  v_mfma_f32_16x16x32_bf16 v[76:79], a[140:143], a[72:75], v[76:79]
  v_exp_f32_e64 v63, v63
  v_mfma_f32_16x16x32_bf16 a[200:203], a[216:219], v[92:95], a[200:203]
  v_cvt_pk_bf16_f32 v115, v62, v63
  v_mfma_f32_16x16x32_bf16 v[132:135], a[144:147], v[92:95], v[132:135]
  ds_write_b128 v208, v[112:115] offset:1024
  v_mfma_f32_16x16x32_bf16 v[152:155], a[148:151], v[92:95], v[152:155]
  v_exp_f32_e64 v64, v64
  v_mfma_f32_16x16x32_bf16 v[172:175], a[152:155], v[92:95], v[172:175]
  v_exp_f32_e64 v65, v65
  v_mfma_f32_16x16x32_bf16 v[192:195], a[156:159], v[92:95], v[192:195]
  v_exp_f32_e64 v66, v66
  v_mfma_f32_16x16x32_bf16 v[132:135], a[160:163], a[180:183], v[132:135]
  v_cvt_pk_bf16_f32 v116, v64, v65
  v_mfma_f32_16x16x32_bf16 v[152:155], a[164:167], a[180:183], v[152:155]
  v_exp_f32_e64 v67, v67
  v_mfma_f32_16x16x32_bf16 v[172:175], a[168:171], a[180:183], v[172:175]
  v_exp_f32_e64 v68, v68
  v_mfma_f32_16x16x32_bf16 v[192:195], a[172:175], a[180:183], v[192:195]
  v_cvt_pk_bf16_f32 v117, v66, v67
  v_mfma_f32_16x16x32_bf16 v[80:83], a[112:115], a[16:19], v[44:47]
  v_exp_f32_e64 v69, v69
  v_mfma_f32_16x16x32_bf16 v[84:87], a[128:131], a[16:19], v[44:47]
  v_exp_f32_e64 v70, v70
  v_mfma_f32_16x16x32_bf16 v[80:83], a[116:119], a[36:39], v[80:83]
  v_cvt_pk_bf16_f32 v118, v68, v69
  v_mfma_f32_16x16x32_bf16 v[84:87], a[132:135], a[36:39], v[84:87]
  v_exp_f32_e64 v71, v71
  v_mfma_f32_16x16x32_bf16 v[80:83], a[120:123], a[56:59], v[80:83]
  v_cvt_pk_bf16_f32 v119, v70, v71
  v_mfma_f32_16x16x32_bf16 v[84:87], a[136:139], a[56:59], v[84:87]
  ds_write_b128 v208, v[116:119] offset:2048
  v_mfma_f32_16x16x32_bf16 v[80:83], a[124:127], a[76:79], v[80:83]
  v_exp_f32_e64 v72, v72
  v_mfma_f32_16x16x32_bf16 v[84:87], a[140:143], a[76:79], v[84:87]
  v_exp_f32_e64 v73, v73
  v_mfma_f32_16x16x32_bf16 a[204:207], a[216:219], v[96:99], a[204:207]
  v_exp_f32_e64 v74, v74
  v_mfma_f32_16x16x32_bf16 v[136:139], a[144:147], v[96:99], v[136:139]
  v_cvt_pk_bf16_f32 v120, v72, v73
  v_mfma_f32_16x16x32_bf16 v[156:159], a[148:151], v[96:99], v[156:159]
  v_exp_f32_e64 v75, v75
  v_mfma_f32_16x16x32_bf16 v[176:179], a[152:155], v[96:99], v[176:179]
  v_exp_f32_e64 v76, v76
  v_mfma_f32_16x16x32_bf16 v[196:199], a[156:159], v[96:99], v[196:199]
  v_cvt_pk_bf16_f32 v121, v74, v75
  v_mfma_f32_16x16x32_bf16 v[136:139], a[160:163], a[184:187], v[136:139]
  v_exp_f32_e64 v77, v77
  v_mfma_f32_16x16x32_bf16 v[156:159], a[164:167], a[184:187], v[156:159]
  v_exp_f32_e64 v78, v78
  v_mfma_f32_16x16x32_bf16 v[176:179], a[168:171], a[184:187], v[176:179]
  v_cvt_pk_bf16_f32 v122, v76, v77
  v_mfma_f32_16x16x32_bf16 v[196:199], a[172:175], a[184:187], v[196:199]
  v_exp_f32_e64 v79, v79
  v_mfma_f32_16x16x32_bf16 a[208:211], a[216:219], v[100:103], a[208:211]
  v_cvt_pk_bf16_f32 v123, v78, v79
  v_mfma_f32_16x16x32_bf16 v[140:143], a[144:147], v[100:103], v[140:143]
  ds_write_b128 v208, v[120:123] offset:3072
  v_mfma_f32_16x16x32_bf16 v[160:163], a[148:151], v[100:103], v[160:163]
  v_exp_f32_e64 v80, v80
  v_mfma_f32_16x16x32_bf16 v[180:183], a[152:155], v[100:103], v[180:183]
  v_exp_f32_e64 v81, v81
  v_mfma_f32_16x16x32_bf16 v[200:203], a[156:159], v[100:103], v[200:203]
  v_exp_f32_e64 v82, v82
  v_mfma_f32_16x16x32_bf16 v[140:143], a[160:163], a[188:191], v[140:143]
  v_cvt_pk_bf16_f32 v124, v80, v81
  v_mfma_f32_16x16x32_bf16 v[160:163], a[164:167], a[188:191], v[160:163]
  v_exp_f32_e64 v83, v83
  v_mfma_f32_16x16x32_bf16 v[180:183], a[168:171], a[188:191], v[180:183]
  v_exp_f32_e64 v84, v84
  v_mfma_f32_16x16x32_bf16 v[200:203], a[172:175], a[188:191], v[200:203]
  v_cvt_pk_bf16_f32 v125, v82, v83
  v_mfma_f32_16x16x32_bf16 a[212:215], a[216:219], v[104:107], a[212:215]
  v_exp_f32_e64 v85, v85
  v_mfma_f32_16x16x32_bf16 v[144:147], a[144:147], v[104:107], v[144:147]
  v_exp_f32_e64 v86, v86
  v_mfma_f32_16x16x32_bf16 v[164:167], a[148:151], v[104:107], v[164:167]
  v_cvt_pk_bf16_f32 v126, v84, v85
  v_mfma_f32_16x16x32_bf16 v[184:187], a[152:155], v[104:107], v[184:187]
  v_exp_f32_e64 v87, v87
  v_mfma_f32_16x16x32_bf16 v[204:207], a[156:159], v[104:107], v[204:207]
  v_cvt_pk_bf16_f32 v127, v86, v87
  v_accvgpr_read_b32 v240, a196
  v_mfma_f32_16x16x32_bf16 v[144:147], a[160:163], a[192:195], v[144:147]
  ds_write_b128 v208, v[124:127] offset:4096
  v_mfma_f32_16x16x32_bf16 v[164:167], a[164:167], a[192:195], v[164:167]
  v_accvgpr_read_b32 v241, a200
  v_accvgpr_read_b32 v242, a204
  v_mfma_f32_16x16x32_bf16 v[184:187], a[168:171], a[192:195], v[184:187]
  v_accvgpr_read_b32 v243, a208
  v_accvgpr_read_b32 v244, a212
  v_mfma_f32_16x16x32_bf16 v[204:207], a[172:175], a[192:195], v[204:207]
  ds_write_b128 v248, v[240:243]
  ds_write_b32 v248, v244 offset:256
  s_waitcnt vmcnt(8) lgkmcnt(0)
  s_barrier
  ds_read_b64_tr_b16 a[144:145], v8 offset:0
  ds_read_b64_tr_b16 a[146:147], v8 offset:4096
  ds_read_b64_tr_b16 a[148:149], v9 offset:0
  ds_read_b64_tr_b16 a[150:151], v9 offset:4096
  ds_read_b64_tr_b16 a[152:153], v10 offset:0
  ds_read_b64_tr_b16 a[154:155], v10 offset:4096
  ds_read_b64_tr_b16 a[156:157], v11 offset:0
  ds_read_b64_tr_b16 a[158:159], v11 offset:4096
  ds_read_b128 a[176:179], v209 offset:0
  ds_read_b64_tr_b16 a[160:161], v12 offset:0
  ds_read_b64_tr_b16 a[162:163], v12 offset:4096
  ds_read_b64_tr_b16 a[164:165], v13 offset:0
  ds_read_b64_tr_b16 a[166:167], v13 offset:4096
  ds_read_b64_tr_b16 a[168:169], v14 offset:0
  ds_read_b64_tr_b16 a[170:171], v14 offset:4096
  ds_read_b64_tr_b16 a[172:173], v15 offset:0
  ds_read_b64_tr_b16 a[174:175], v15 offset:4096
  ds_read_b128 a[180:183], v209 offset:1024
  ds_read_b128 a[184:187], v209 offset:2048
  ds_read_b128 a[188:191], v209 offset:3072
  ds_read_b128 a[192:195], v209 offset:4096
  ds_read_b128 v[240:243], v249
  ds_read_b32 v244, v249 offset:256
  s_mov_b32 s40, 1468006400
  s_mov_b64 s[62:63], 0
  s_nop 0
  v_mfma_f32_16x16x32_bf16 a[196:199], a[216:219], v[108:111], a[196:199]
  s_nop 0
  ds_read_b64_tr_b16 a[80:81], v212 offset:0
  ds_read_b64_tr_b16 a[82:83], v212 offset:2048
  s_waitcnt lgkmcnt(15)
  v_mfma_f32_16x16x32_bf16 v[128:131], a[144:147], v[108:111], v[128:131]
  ds_read_b64_tr_b16 a[84:85], v212 offset:4096
  ds_read_b64_tr_b16 a[86:87], v212 offset:6144
  v_mfma_f32_16x16x32_bf16 v[148:151], a[148:151], v[108:111], v[148:151]
  ds_read_b64_tr_b16 a[88:89], v212 offset:8192
  ds_read_b64_tr_b16 a[90:91], v212 offset:10240
  v_mfma_f32_16x16x32_bf16 v[168:171], a[152:155], v[108:111], v[168:171]
  ds_read_b64_tr_b16 a[92:93], v212 offset:12288
  v_mfma_f32_16x16x32_bf16 v[188:191], a[156:159], v[108:111], v[188:191]
  ds_read_b64_tr_b16 a[94:95], v212 offset:14336
  ds_read_b64_tr_b16 a[96:97], v212 offset:16384
  v_mfma_f32_16x16x32_bf16 a[196:199], a[216:219], a[176:179], a[196:199]
  s_nop 0
  ds_read_b64_tr_b16 a[98:99], v212 offset:18432
  s_waitcnt lgkmcnt(15)
  v_mfma_f32_16x16x32_bf16 v[128:131], a[160:163], a[176:179], v[128:131]
  ds_read_b64_tr_b16 a[100:101], v212 offset:20480
  v_mfma_f32_16x16x32_bf16 v[148:151], a[164:167], a[176:179], v[148:151]
  ds_read_b64_tr_b16 a[102:103], v212 offset:22528
  ds_read_b64_tr_b16 a[104:105], v212 offset:24576
  v_mfma_f32_16x16x32_bf16 v[168:171], a[168:171], a[176:179], v[168:171]
  ds_read_b64_tr_b16 a[106:107], v212 offset:26624
  v_mfma_f32_16x16x32_bf16 v[188:191], a[172:175], a[176:179], v[188:191]
  ds_read_b64_tr_b16 a[108:109], v212 offset:28672
  v_mfma_f32_16x16x32_bf16 a[200:203], a[216:219], v[112:115], a[200:203]
  ds_read_b64_tr_b16 a[110:111], v212 offset:30720
  v_mfma_f32_16x16x32_bf16 v[132:135], a[144:147], v[112:115], v[132:135]
  v_mfma_f32_16x16x32_bf16 v[152:155], a[148:151], v[112:115], v[152:155]
  s_nop 0
  v_accvgpr_read_b32 v220, a196
  s_waitcnt lgkmcnt(15)
  v_add_f32_e64 v220, v220, v240
  v_mfma_f32_16x16x32_bf16 v[172:175], a[152:155], v[112:115], v[172:175]
  v_cmp_nle_f32 vcc, v220, s40
  v_mfma_f32_16x16x32_bf16 v[192:195], a[156:159], v[112:115], v[192:195]
  v_rcp_f32_e64 v220, v220
  v_mfma_f32_16x16x32_bf16 a[200:203], a[216:219], a[180:183], a[200:203]
  s_nop 0
  s_or_b64 s[62:63], s[62:63], vcc
  v_mul_f32_e64 v128, v128, v220
  v_mul_f32_e64 v129, v129, v220
  v_mfma_f32_16x16x32_bf16 v[132:135], a[160:163], a[180:183], v[132:135]
  v_mul_f32_e64 v130, v130, v220
  v_mul_f32_e64 v131, v131, v220
  v_mfma_f32_16x16x32_bf16 v[152:155], a[164:167], a[180:183], v[152:155]
  v_cvt_pk_bf16_f32 v224, v128, v129
  v_cvt_pk_bf16_f32 v225, v130, v131
  v_mfma_f32_16x16x32_bf16 v[172:175], a[168:171], a[180:183], v[172:175]
  v_mul_f32_e64 v148, v148, v220
  v_mul_f32_e64 v149, v149, v220
  v_mfma_f32_16x16x32_bf16 v[192:195], a[172:175], a[180:183], v[192:195]
  v_mul_f32_e64 v150, v150, v220
  v_mul_f32_e64 v151, v151, v220
  v_mfma_f32_16x16x32_bf16 a[204:207], a[216:219], v[116:119], a[204:207]
  v_cvt_pk_bf16_f32 v226, v148, v149
  v_cvt_pk_bf16_f32 v227, v150, v151
  v_mfma_f32_16x16x32_bf16 v[136:139], a[144:147], v[116:119], v[136:139]
  v_mfma_f32_16x16x32_bf16 v[156:159], a[148:151], v[116:119], v[156:159]
  v_mfma_f32_16x16x32_bf16 v[176:179], a[152:155], v[116:119], v[176:179]
  ds_write_b128 v210, v[224:227] offset:0
  v_mfma_f32_16x16x32_bf16 v[196:199], a[156:159], v[116:119], v[196:199]
  v_mul_f32_e64 v168, v168, v220
  v_mul_f32_e64 v169, v169, v220
  v_mfma_f32_16x16x32_bf16 a[204:207], a[216:219], a[184:187], a[204:207]
  v_mul_f32_e64 v170, v170, v220
  v_mul_f32_e64 v171, v171, v220
  v_mfma_f32_16x16x32_bf16 v[136:139], a[160:163], a[184:187], v[136:139]
  v_cvt_pk_bf16_f32 v228, v168, v169
  v_cvt_pk_bf16_f32 v229, v170, v171
  v_mfma_f32_16x16x32_bf16 v[156:159], a[164:167], a[184:187], v[156:159]
  v_mul_f32_e64 v188, v188, v220
  v_mul_f32_e64 v189, v189, v220
  v_mfma_f32_16x16x32_bf16 v[176:179], a[168:171], a[184:187], v[176:179]
  v_mul_f32_e64 v190, v190, v220
  v_mul_f32_e64 v191, v191, v220
  v_mfma_f32_16x16x32_bf16 v[196:199], a[172:175], a[184:187], v[196:199]
  v_cvt_pk_bf16_f32 v230, v188, v189
  v_cvt_pk_bf16_f32 v231, v190, v191
  v_mfma_f32_16x16x32_bf16 a[208:211], a[216:219], v[120:123], a[208:211]
  v_mfma_f32_16x16x32_bf16 v[140:143], a[144:147], v[120:123], v[140:143]
  ds_write_b128 v210, v[228:231] offset:5120
  v_mfma_f32_16x16x32_bf16 v[160:163], a[148:151], v[120:123], v[160:163]
  v_accvgpr_read_b32 v222, a200
  v_add_f32_e64 v222, v222, v241
  v_mfma_f32_16x16x32_bf16 v[180:183], a[152:155], v[120:123], v[180:183]
  v_cmp_nle_f32 vcc, v222, s40
  v_mfma_f32_16x16x32_bf16 v[200:203], a[156:159], v[120:123], v[200:203]
  v_rcp_f32_e64 v222, v222
  v_mfma_f32_16x16x32_bf16 a[208:211], a[216:219], a[188:191], a[208:211]
  s_nop 0
  s_or_b64 s[62:63], s[62:63], vcc
  v_mul_f32_e64 v132, v132, v222
  v_mul_f32_e64 v133, v133, v222
  v_mfma_f32_16x16x32_bf16 v[140:143], a[160:163], a[188:191], v[140:143]
  v_mul_f32_e64 v134, v134, v222
  v_mul_f32_e64 v135, v135, v222
  v_mfma_f32_16x16x32_bf16 v[160:163], a[164:167], a[188:191], v[160:163]
  v_cvt_pk_bf16_f32 v232, v132, v133
  v_cvt_pk_bf16_f32 v233, v134, v135
  v_mfma_f32_16x16x32_bf16 v[180:183], a[168:171], a[188:191], v[180:183]
  v_mul_f32_e64 v152, v152, v222
  v_mul_f32_e64 v153, v153, v222
  v_mfma_f32_16x16x32_bf16 v[200:203], a[172:175], a[188:191], v[200:203]
  v_mul_f32_e64 v154, v154, v222
  v_mul_f32_e64 v155, v155, v222
  v_mfma_f32_16x16x32_bf16 a[212:215], a[216:219], v[124:127], a[212:215]
  v_cvt_pk_bf16_f32 v234, v152, v153
  v_cvt_pk_bf16_f32 v235, v154, v155
  v_mfma_f32_16x16x32_bf16 v[144:147], a[144:147], v[124:127], v[144:147]
  v_mfma_f32_16x16x32_bf16 v[164:167], a[148:151], v[124:127], v[164:167]
  ds_write_b128 v210, v[232:235] offset:1024
  v_mfma_f32_16x16x32_bf16 v[184:187], a[152:155], v[124:127], v[184:187]
  v_mul_f32_e64 v172, v172, v222
  v_mul_f32_e64 v173, v173, v222
  v_mfma_f32_16x16x32_bf16 v[204:207], a[156:159], v[124:127], v[204:207]
  v_mul_f32_e64 v174, v174, v222
  v_mul_f32_e64 v175, v175, v222
  v_mfma_f32_16x16x32_bf16 a[212:215], a[216:219], a[192:195], a[212:215]
  v_cvt_pk_bf16_f32 v236, v172, v173
  v_cvt_pk_bf16_f32 v237, v174, v175
  v_mfma_f32_16x16x32_bf16 v[144:147], a[160:163], a[192:195], v[144:147]
  v_mul_f32_e64 v192, v192, v222
  v_mul_f32_e64 v193, v193, v222
  v_mfma_f32_16x16x32_bf16 v[164:167], a[164:167], a[192:195], v[164:167]
  v_mul_f32_e64 v194, v194, v222
  v_mul_f32_e64 v195, v195, v222
  v_mfma_f32_16x16x32_bf16 v[184:187], a[168:171], a[192:195], v[184:187]
  v_cvt_pk_bf16_f32 v238, v192, v193
  v_cvt_pk_bf16_f32 v239, v194, v195
  v_mfma_f32_16x16x32_bf16 v[204:207], a[172:175], a[192:195], v[204:207]
  ds_write_b128 v210, v[236:239] offset:6144
  v_accvgpr_read_b32 v220, a204
  v_add_f32_e64 v220, v220, v242
  v_cmp_nle_f32 vcc, v220, s40
  v_rcp_f32_e64 v220, v220
  s_or_b64 s[62:63], s[62:63], vcc
  v_pk_mul_f32 v[136:137], v[136:137], v[220:221] op_sel_hi:[1,0]
  v_pk_mul_f32 v[138:139], v[138:139], v[220:221] op_sel_hi:[1,0]
  v_cvt_pk_bf16_f32 v224, v136, v137
  v_cvt_pk_bf16_f32 v225, v138, v139
  v_pk_mul_f32 v[156:157], v[156:157], v[220:221] op_sel_hi:[1,0]
  v_pk_mul_f32 v[158:159], v[158:159], v[220:221] op_sel_hi:[1,0]
  v_cvt_pk_bf16_f32 v226, v156, v157
  v_cvt_pk_bf16_f32 v227, v158, v159
  ds_write_b128 v210, v[224:227] offset:2048
  v_pk_mul_f32 v[176:177], v[176:177], v[220:221] op_sel_hi:[1,0]
  v_pk_mul_f32 v[178:179], v[178:179], v[220:221] op_sel_hi:[1,0]
  v_cvt_pk_bf16_f32 v228, v176, v177
  v_cvt_pk_bf16_f32 v229, v178, v179
  v_pk_mul_f32 v[196:197], v[196:197], v[220:221] op_sel_hi:[1,0]
  v_pk_mul_f32 v[198:199], v[198:199], v[220:221] op_sel_hi:[1,0]
  v_cvt_pk_bf16_f32 v230, v196, v197
  v_cvt_pk_bf16_f32 v231, v198, v199
  ds_write_b128 v210, v[228:231] offset:7168
  v_accvgpr_read_b32 v222, a208
  v_add_f32_e64 v222, v222, v243
  v_cmp_nle_f32 vcc, v222, s40
  v_rcp_f32_e64 v222, v222
  s_or_b64 s[62:63], s[62:63], vcc
  v_pk_mul_f32 v[140:141], v[140:141], v[222:223] op_sel_hi:[1,0]
  v_pk_mul_f32 v[142:143], v[142:143], v[222:223] op_sel_hi:[1,0]
  v_cvt_pk_bf16_f32 v232, v140, v141
  v_cvt_pk_bf16_f32 v233, v142, v143
  v_pk_mul_f32 v[160:161], v[160:161], v[222:223] op_sel_hi:[1,0]
  v_pk_mul_f32 v[162:163], v[162:163], v[222:223] op_sel_hi:[1,0]
  v_cvt_pk_bf16_f32 v234, v160, v161
  v_cvt_pk_bf16_f32 v235, v162, v163
  ds_write_b128 v210, v[232:235] offset:3072
  v_pk_mul_f32 v[180:181], v[180:181], v[222:223] op_sel_hi:[1,0]
  v_pk_mul_f32 v[182:183], v[182:183], v[222:223] op_sel_hi:[1,0]
  v_cvt_pk_bf16_f32 v236, v180, v181
  v_cvt_pk_bf16_f32 v237, v182, v183
  v_pk_mul_f32 v[200:201], v[200:201], v[222:223] op_sel_hi:[1,0]
  v_pk_mul_f32 v[202:203], v[202:203], v[222:223] op_sel_hi:[1,0]
  v_cvt_pk_bf16_f32 v238, v200, v201
  v_cvt_pk_bf16_f32 v239, v202, v203
  ds_write_b128 v210, v[236:239] offset:8192
  v_accvgpr_read_b32 v220, a212
  v_add_f32_e64 v220, v220, v244
  v_cmp_nle_f32 vcc, v220, s40
  v_rcp_f32_e64 v220, v220
  s_or_b64 s[62:63], s[62:63], vcc
  v_pk_mul_f32 v[144:145], v[144:145], v[220:221] op_sel_hi:[1,0]
  v_pk_mul_f32 v[146:147], v[146:147], v[220:221] op_sel_hi:[1,0]
  v_cvt_pk_bf16_f32 v224, v144, v145
  v_cvt_pk_bf16_f32 v225, v146, v147
  v_pk_mul_f32 v[164:165], v[164:165], v[220:221] op_sel_hi:[1,0]
  v_pk_mul_f32 v[166:167], v[166:167], v[220:221] op_sel_hi:[1,0]
  v_cvt_pk_bf16_f32 v226, v164, v165
  v_cvt_pk_bf16_f32 v227, v166, v167
  ds_write_b128 v210, v[224:227] offset:4096
  v_pk_mul_f32 v[184:185], v[184:185], v[220:221] op_sel_hi:[1,0]
  v_pk_mul_f32 v[186:187], v[186:187], v[220:221] op_sel_hi:[1,0]
  v_cvt_pk_bf16_f32 v228, v184, v185
  v_cvt_pk_bf16_f32 v229, v186, v187
  v_pk_mul_f32 v[204:205], v[204:205], v[220:221] op_sel_hi:[1,0]
  v_pk_mul_f32 v[206:207], v[206:207], v[220:221] op_sel_hi:[1,0]
  v_cvt_pk_bf16_f32 v230, v204, v205
  v_cvt_pk_bf16_f32 v231, v206, v207
  ds_write_b128 v210, v[228:231] offset:9216
  s_cmp_lg_u64 s[62:63], 0
  s_cselect_b32 s38, 1, 0
  v_mov_b32 v3, s38
  s_lshl_b32 s39, s32, 2
  s_add_u32 s39, s39, 149504
  v_mov_b32 v23, s39
  ds_write_b32 v23, v3
  s_waitcnt vmcnt(0) lgkmcnt(0)
  s_barrier
  v_mov_b32 v23, 149504
  ds_read_b128 v[224:227], v23
  ds_read_b128 a[144:147], v211 offset:0
  ds_read_b128 a[148:151], v211 offset:1024
  ds_read_b128 a[152:155], v211 offset:2048
  ds_read_b128 a[156:159], v211 offset:3072
  ds_read_b128 a[160:163], v211 offset:4096
  ds_read_b128 a[164:167], v211 offset:5120
  ds_read_b128 a[168:171], v211 offset:6144
  ds_read_b128 a[172:175], v211 offset:7168
  ds_read_b128 a[176:179], v211 offset:8192
  ds_read_b128 a[180:183], v211 offset:9216
  ds_read_b128 a[184:187], v211 offset:20480
  ds_read_b128 a[188:191], v211 offset:21504
  ds_read_b128 a[192:195], v211 offset:22528
  ds_read_b128 a[196:199], v211 offset:23552
  ds_read_b128 a[200:203], v211 offset:24576
  ds_read_b128 a[204:207], v211 offset:25600
  ds_read_b128 a[208:211], v211 offset:26624
  ds_read_b128 a[212:215], v211 offset:27648
  ds_read_b128 a[216:219], v211 offset:28672
  ds_read_b128 a[220:223], v211 offset:29696
  s_waitcnt lgkmcnt(15)
  v_or3_b32 v224, v224, v225, v226
  v_or_b32_e64 v224, v224, v227
  s_nop 0
  v_readfirstlane_b32 s38, v224
  s_nop 0
  s_andn2_b32 s38, s38, s50
  s_cbranch_scc1 L_fallback
  v_mfma_f32_16x16x32_bf16 v[128:131], a[80:83], a[144:147], 0
  s_nop 0
  ds_read_b128 a[0:3], v211 offset:10240
  s_add_u32 m0, s53, 65536
  s_add_u32 s51, s16, 0x0
  v_mfma_f32_16x16x32_bf16 v[132:135], a[80:83], a[148:151], 0
  buffer_load_dwordx4 v24, s[20:23], s51 offen offset:0 lds
  ds_read_b128 a[4:7], v211 offset:11264
  s_add_u32 s51, s16, 8192
  v_mfma_f32_16x16x32_bf16 v[136:139], a[80:83], a[152:155], 0
  ds_read_b128 a[8:11], v211 offset:12288
  ds_read_b128 a[12:15], v211 offset:13312
  v_mfma_f32_16x16x32_bf16 v[140:143], a[80:83], a[156:159], 0
  buffer_load_dwordx4 v24, s[20:23], s51 offen offset:1024 lds
  ds_read_b128 a[16:19], v211 offset:14336
  s_add_u32 s51, s16, 16384
  v_mfma_f32_16x16x32_bf16 v[144:147], a[80:83], a[160:163], 0
  s_nop 0
  ds_read_b128 a[20:23], v211 offset:15360
  buffer_load_dwordx4 v24, s[20:23], s51 offen offset:2048 lds
  s_waitcnt lgkmcnt(15)
  v_mfma_f32_16x16x32_bf16 v[128:131], a[84:87], a[164:167], v[128:131]
  ds_read_b128 a[24:27], v211 offset:16384
  ds_read_b128 a[28:31], v211 offset:17408
  s_add_u32 s51, s16, 24576
  v_mfma_f32_16x16x32_bf16 v[132:135], a[84:87], a[168:171], v[132:135]
  ds_read_b128 a[32:35], v211 offset:18432
  buffer_load_dwordx4 v24, s[20:23], s51 offen offset:3072 lds
  v_mfma_f32_16x16x32_bf16 v[136:139], a[84:87], a[172:175], v[136:139]
  ds_read_b128 a[36:39], v211 offset:19456
  ds_read_b128 a[40:43], v211 offset:30720
  s_add_u32 m0, s53, 69632
  v_mfma_f32_16x16x32_bf16 v[140:143], a[84:87], a[176:179], v[140:143]
  s_add_u32 s51, s16, 36864
  buffer_load_dwordx4 v24, s[20:23], s51 offen offset:0 lds
  v_mfma_f32_16x16x32_bf16 v[144:147], a[84:87], a[180:183], v[144:147]
  ds_read_b128 a[44:47], v211 offset:31744
  ds_read_b128 a[48:51], v211 offset:32768
  s_add_u32 s51, s16, 45056
  v_mfma_f32_16x16x32_bf16 v[128:131], a[88:91], a[184:187], v[128:131]
  s_nop 0
  ds_read_b128 a[52:55], v211 offset:33792
  buffer_load_dwordx4 v24, s[20:23], s51 offen offset:1024 lds
  s_waitcnt lgkmcnt(15)
  v_mfma_f32_16x16x32_bf16 v[132:135], a[88:91], a[188:191], v[132:135]
  ds_read_b128 a[56:59], v211 offset:34816
  ds_read_b128 a[60:63], v211 offset:35840
  v_mfma_f32_16x16x32_bf16 v[136:139], a[88:91], a[192:195], v[136:139]
  s_add_u32 s51, s16, 53248
  buffer_load_dwordx4 v24, s[20:23], s51 offen offset:2048 lds
  v_mfma_f32_16x16x32_bf16 v[140:143], a[88:91], a[196:199], v[140:143]
  ds_read_b128 a[64:67], v211 offset:36864
  ds_read_b128 a[68:71], v211 offset:37888
  v_mfma_f32_16x16x32_bf16 v[144:147], a[88:91], a[200:203], v[144:147]
  ds_read_b128 a[72:75], v211 offset:38912
  s_add_u32 s51, s16, 61440
  v_mfma_f32_16x16x32_bf16 v[128:131], a[92:95], a[204:207], v[128:131]
  buffer_load_dwordx4 v24, s[20:23], s51 offen offset:3072 lds
  ds_read_b128 a[76:79], v211 offset:39936
  v_mfma_f32_16x16x32_bf16 v[132:135], a[92:95], a[208:211], v[132:135]
  ds_read_b64_tr_b16 a[112:113], v212 offset:32768
  ds_read_b64_tr_b16 a[114:115], v212 offset:34816
  v_mfma_f32_16x16x32_bf16 v[136:139], a[92:95], a[212:215], v[136:139]
  s_nop 0
  s_add_u32 s16, s16, 128
  s_cmp_eq_u32 s16, 1152
  s_cselect_b32 s16, 0, s16
  v_mfma_f32_16x16x32_bf16 v[140:143], a[92:95], a[216:219], v[140:143]
  s_nop 0
  ds_read_b64_tr_b16 a[116:117], v212 offset:36864
  s_add_u32 m0, s53, 0x0
  s_add_u32 s51, s16, 0x0
  s_waitcnt lgkmcnt(15)
  v_mfma_f32_16x16x32_bf16 v[144:147], a[92:95], a[220:223], v[144:147]
  ds_read_b64_tr_b16 a[118:119], v212 offset:38912
  buffer_load_dwordx4 v24, s[20:23], s51 offen offset:0 lds
  v_mfma_f32_16x16x32_bf16 v[128:131], a[96:99], a[0:3], v[128:131]
  ds_read_b64_tr_b16 a[120:121], v212 offset:40960
  ds_read_b64_tr_b16 a[122:123], v212 offset:43008
  s_add_u32 s51, s16, 8192
  v_mfma_f32_16x16x32_bf16 v[132:135], a[96:99], a[4:7], v[132:135]
  buffer_load_dwordx4 v24, s[20:23], s51 offen offset:1024 lds
  ds_read_b64_tr_b16 a[124:125], v212 offset:45056
  v_mfma_f32_16x16x32_bf16 v[136:139], a[96:99], a[8:11], v[136:139]
  ds_read_b64_tr_b16 a[126:127], v212 offset:47104
  ds_read_b64_tr_b16 a[128:129], v212 offset:49152
  s_add_u32 s51, s16, 16384
  v_mfma_f32_16x16x32_bf16 v[140:143], a[96:99], a[12:15], v[140:143]
  buffer_load_dwordx4 v24, s[20:23], s51 offen offset:2048 lds
  ds_read_b64_tr_b16 a[130:131], v212 offset:51200
  v_mfma_f32_16x16x32_bf16 v[144:147], a[96:99], a[16:19], v[144:147]
  ds_read_b64_tr_b16 a[132:133], v212 offset:53248
  s_add_u32 s51, s16, 24576
  v_mfma_f32_16x16x32_bf16 v[128:131], a[100:103], a[20:23], v[128:131]
  buffer_load_dwordx4 v24, s[20:23], s51 offen offset:3072 lds
  ds_read_b64_tr_b16 a[134:135], v212 offset:55296
  v_mfma_f32_16x16x32_bf16 v[132:135], a[100:103], a[24:27], v[132:135]
  ds_read_b64_tr_b16 a[136:137], v212 offset:57344
  ds_read_b64_tr_b16 a[138:139], v212 offset:59392
  s_add_u32 m0, s53, 4096
  v_mfma_f32_16x16x32_bf16 v[136:139], a[100:103], a[28:31], v[136:139]
  s_nop 0
  s_add_u32 s51, s16, 36864
  buffer_load_dwordx4 v24, s[20:23], s51 offen offset:0 lds
  s_waitcnt lgkmcnt(15)
  v_mfma_f32_16x16x32_bf16 v[140:143], a[100:103], a[32:35], v[140:143]
  ds_read_b64_tr_b16 a[140:141], v212 offset:61440
  ds_read_b64_tr_b16 a[142:143], v212 offset:63488
  s_add_u32 s51, s16, 45056
  v_mfma_f32_16x16x32_bf16 v[144:147], a[100:103], a[36:39], v[144:147]
  buffer_load_dwordx4 v24, s[20:23], s51 offen offset:1024 lds
  v_mfma_f32_16x16x32_bf16 v[128:131], a[104:107], a[40:43], v[128:131]
  v_mfma_f32_16x16x32_bf16 v[132:135], a[104:107], a[44:47], v[132:135]
  s_add_u32 s51, s16, 53248
  buffer_load_dwordx4 v24, s[20:23], s51 offen offset:2048 lds
  v_mfma_f32_16x16x32_bf16 v[136:139], a[104:107], a[48:51], v[136:139]
  v_mfma_f32_16x16x32_bf16 v[140:143], a[104:107], a[52:55], v[140:143]
  s_add_u32 s51, s16, 61440
  buffer_load_dwordx4 v24, s[20:23], s51 offen offset:3072 lds
  v_mfma_f32_16x16x32_bf16 v[144:147], a[104:107], a[56:59], v[144:147]
  v_mfma_f32_16x16x32_bf16 v[128:131], a[108:111], a[60:63], v[128:131]
  s_nop 0
  s_add_u32 s16, s16, 128
  s_cmp_eq_u32 s16, 1152
  s_cselect_b32 s16, 0, s16
  v_mfma_f32_16x16x32_bf16 v[132:135], a[108:111], a[64:67], v[132:135]
  v_mfma_f32_16x16x32_bf16 v[136:139], a[108:111], a[68:71], v[136:139]
  v_mfma_f32_16x16x32_bf16 v[140:143], a[108:111], a[72:75], v[140:143]
  s_nop 0
  s_waitcnt lgkmcnt(15)
  v_mfma_f32_16x16x32_bf16 v[144:147], a[108:111], a[76:79], v[144:147]
  s_waitcnt vmcnt(8) lgkmcnt(0)
  s_barrier
  v_mfma_f32_16x16x32_bf16 v[148:151], a[112:115], a[144:147], 0
  s_nop 0
  ds_read_b64_tr_b16 a[80:81], v213 offset:0
  s_add_u32 m0, s53, 32768
  s_add_u32 s51, s16, 0x0
  v_mfma_f32_16x16x32_bf16 v[152:155], a[112:115], a[148:151], 0
  buffer_load_dwordx4 v24, s[20:23], s51 offen offset:0 lds
  ds_read_b64_tr_b16 a[82:83], v213 offset:2048
  s_add_u32 s51, s16, 8192
  v_mfma_f32_16x16x32_bf16 v[156:159], a[112:115], a[152:155], 0
  buffer_load_dwordx4 v24, s[20:23], s51 offen offset:1024 lds
  ds_read_b64_tr_b16 a[84:85], v213 offset:4096
  v_mfma_f32_16x16x32_bf16 v[160:163], a[112:115], a[156:159], 0
  v_mfma_f32_16x16x32_bf16 v[164:167], a[112:115], a[160:163], 0
  s_add_u32 s51, s16, 16384
  ds_read_b64_tr_b16 a[86:87], v213 offset:6144
  v_mfma_f32_16x16x32_bf16 v[148:151], a[116:119], a[164:167], v[148:151]
  buffer_load_dwordx4 v24, s[20:23], s51 offen offset:2048 lds
  v_mfma_f32_16x16x32_bf16 v[152:155], a[116:119], a[168:171], v[152:155]
  ds_read_b64_tr_b16 a[88:89], v213 offset:8192
  v_mfma_f32_16x16x32_bf16 v[156:159], a[116:119], a[172:175], v[156:159]
  s_add_u32 s51, s16, 24576
  buffer_load_dwordx4 v24, s[20:23], s51 offen offset:3072 lds
  v_mfma_f32_16x16x32_bf16 v[160:163], a[116:119], a[176:179], v[160:163]
  ds_read_b64_tr_b16 a[90:91], v213 offset:10240
  v_mfma_f32_16x16x32_bf16 v[164:167], a[116:119], a[180:183], v[164:167]
  s_add_u32 m0, s53, 36864
  v_mfma_f32_16x16x32_bf16 v[148:151], a[120:123], a[184:187], v[148:151]
  s_add_u32 s51, s16, 36864
  ds_read_b64_tr_b16 a[92:93], v213 offset:12288
  v_mfma_f32_16x16x32_bf16 v[152:155], a[120:123], a[188:191], v[152:155]
  buffer_load_dwordx4 v24, s[20:23], s51 offen offset:0 lds
  v_mfma_f32_16x16x32_bf16 v[156:159], a[120:123], a[192:195], v[156:159]
  ds_read_b64_tr_b16 a[94:95], v213 offset:14336
  s_add_u32 s51, s16, 45056
  v_mfma_f32_16x16x32_bf16 v[160:163], a[120:123], a[196:199], v[160:163]
  buffer_load_dwordx4 v24, s[20:23], s51 offen offset:1024 lds
  ds_read_b64_tr_b16 a[96:97], v213 offset:16384
  v_mfma_f32_16x16x32_bf16 v[164:167], a[120:123], a[200:203], v[164:167]
  v_mfma_f32_16x16x32_bf16 v[148:151], a[124:127], a[204:207], v[148:151]
  s_add_u32 s51, s16, 53248
  buffer_load_dwordx4 v24, s[20:23], s51 offen offset:2048 lds
  v_mfma_f32_16x16x32_bf16 v[152:155], a[124:127], a[208:211], v[152:155]
  ds_read_b64_tr_b16 a[98:99], v213 offset:18432
  v_mfma_f32_16x16x32_bf16 v[156:159], a[124:127], a[212:215], v[156:159]
  ds_read_b64_tr_b16 a[100:101], v213 offset:20480
  v_mfma_f32_16x16x32_bf16 v[160:163], a[124:127], a[216:219], v[160:163]
  s_add_u32 s51, s16, 61440
  buffer_load_dwordx4 v24, s[20:23], s51 offen offset:3072 lds
  v_mfma_f32_16x16x32_bf16 v[164:167], a[124:127], a[220:223], v[164:167]
  ds_read_b64_tr_b16 a[102:103], v213 offset:22528
  v_mfma_f32_16x16x32_bf16 v[148:151], a[128:131], a[0:3], v[148:151]
  s_nop 0
  s_add_u32 s16, s16, 128
  s_cmp_eq_u32 s16, 1152
  s_cselect_b32 s16, 0, s16
  v_mfma_f32_16x16x32_bf16 v[152:155], a[128:131], a[4:7], v[152:155]
  ds_read_b64_tr_b16 a[104:105], v213 offset:24576
  v_mfma_f32_16x16x32_bf16 v[156:159], a[128:131], a[8:11], v[156:159]
  v_mfma_f32_16x16x32_bf16 v[160:163], a[128:131], a[12:15], v[160:163]
  ds_read_b64_tr_b16 a[106:107], v213 offset:26624
  v_mfma_f32_16x16x32_bf16 v[164:167], a[128:131], a[16:19], v[164:167]
  v_cvt_pk_bf16_f32 v28, v128, v129
  v_cvt_pk_bf16_f32 v29, v130, v131
  v_mfma_f32_16x16x32_bf16 v[148:151], a[132:135], a[20:23], v[148:151]
  ds_read_b64_tr_b16 a[108:109], v213 offset:28672
  v_cvt_pk_bf16_f32 v30, v132, v133
  v_mfma_f32_16x16x32_bf16 v[152:155], a[132:135], a[24:27], v[152:155]
  v_cvt_pk_bf16_f32 v31, v134, v135
  v_mfma_f32_16x16x32_bf16 v[156:159], a[132:135], a[28:31], v[156:159]
  ds_read_b64_tr_b16 a[110:111], v213 offset:30720
  v_mfma_f32_16x16x32_bf16 v[160:163], a[132:135], a[32:35], v[160:163]
  s_nop 0
  s_mov_b32 s3, 0
  v_mfma_f32_16x16x32_bf16 v[164:167], a[132:135], a[36:39], v[164:167]
  v_mfma_f32_16x16x32_bf16 v[148:151], a[136:139], a[40:43], v[148:151]
  buffer_store_dwordx4 v[28:31], v217, s[24:27], s3 offen offset:0 sc1
  v_mfma_f32_16x16x32_bf16 v[152:155], a[136:139], a[44:47], v[152:155]
  v_cvt_pk_bf16_f32 v32, v136, v137
  v_cvt_pk_bf16_f32 v33, v138, v139
  v_mfma_f32_16x16x32_bf16 v[156:159], a[136:139], a[48:51], v[156:159]
  v_cvt_pk_bf16_f32 v34, v140, v141
  v_mfma_f32_16x16x32_bf16 v[160:163], a[136:139], a[52:55], v[160:163]
  v_cvt_pk_bf16_f32 v35, v142, v143
  v_mfma_f32_16x16x32_bf16 v[164:167], a[136:139], a[56:59], v[164:167]
  s_nop 0
  s_mov_b32 s3, 0
  v_mfma_f32_16x16x32_bf16 v[148:151], a[140:143], a[60:63], v[148:151]
  v_mfma_f32_16x16x32_bf16 v[152:155], a[140:143], a[64:67], v[152:155]
  v_mfma_f32_16x16x32_bf16 v[156:159], a[140:143], a[68:71], v[156:159]
  buffer_store_dwordx4 v[32:35], v217, s[24:27], s3 offen offset:1024 sc1
  v_mfma_f32_16x16x32_bf16 v[160:163], a[140:143], a[72:75], v[160:163]
  v_cvt_pk_bf16_f32 v36, v144, v145
  v_cvt_pk_bf16_f32 v37, v146, v147
  v_mfma_f32_16x16x32_bf16 v[164:167], a[140:143], a[76:79], v[164:167]
  s_waitcnt vmcnt(10) lgkmcnt(0)
  s_barrier
  v_mfma_f32_16x16x32_bf16 v[128:131], a[80:83], a[144:147], 0
  s_nop 0
  ds_read_b64_tr_b16 a[112:113], v212 offset:0
  s_add_u32 m0, s53, 98304
  s_add_u32 s51, s16, 0x0
  v_mfma_f32_16x16x32_bf16 v[132:135], a[80:83], a[148:151], 0
  buffer_load_dwordx4 v24, s[20:23], s51 offen offset:0 lds
  ds_read_b64_tr_b16 a[114:115], v212 offset:2048
  s_add_u32 s51, s16, 8192
  v_mfma_f32_16x16x32_bf16 v[136:139], a[80:83], a[152:155], 0
  buffer_load_dwordx4 v24, s[20:23], s51 offen offset:1024 lds
  ds_read_b64_tr_b16 a[116:117], v212 offset:4096
  v_mfma_f32_16x16x32_bf16 v[140:143], a[80:83], a[156:159], 0
  v_mfma_f32_16x16x32_bf16 v[144:147], a[80:83], a[160:163], 0
  s_add_u32 s51, s16, 16384
  ds_read_b64_tr_b16 a[118:119], v212 offset:6144
  v_mfma_f32_16x16x32_bf16 v[128:131], a[84:87], a[164:167], v[128:131]
  buffer_load_dwordx4 v24, s[20:23], s51 offen offset:2048 lds
  v_mfma_f32_16x16x32_bf16 v[132:135], a[84:87], a[168:171], v[132:135]
  ds_read_b64_tr_b16 a[120:121], v212 offset:8192
  v_mfma_f32_16x16x32_bf16 v[136:139], a[84:87], a[172:175], v[136:139]
  s_add_u32 s51, s16, 24576
  buffer_load_dwordx4 v24, s[20:23], s51 offen offset:3072 lds
  v_mfma_f32_16x16x32_bf16 v[140:143], a[84:87], a[176:179], v[140:143]
  ds_read_b64_tr_b16 a[122:123], v212 offset:10240
  v_mfma_f32_16x16x32_bf16 v[144:147], a[84:87], a[180:183], v[144:147]
  s_add_u32 m0, s53, 102400
  v_mfma_f32_16x16x32_bf16 v[128:131], a[88:91], a[184:187], v[128:131]
  s_add_u32 s51, s16, 36864
  ds_read_b64_tr_b16 a[124:125], v212 offset:12288
  v_mfma_f32_16x16x32_bf16 v[132:135], a[88:91], a[188:191], v[132:135]
  buffer_load_dwordx4 v24, s[20:23], s51 offen offset:0 lds
  v_mfma_f32_16x16x32_bf16 v[136:139], a[88:91], a[192:195], v[136:139]
  ds_read_b64_tr_b16 a[126:127], v212 offset:14336
  s_add_u32 s51, s16, 45056
  v_mfma_f32_16x16x32_bf16 v[140:143], a[88:91], a[196:199], v[140:143]
  buffer_load_dwordx4 v24, s[20:23], s51 offen offset:1024 lds
  ds_read_b64_tr_b16 a[128:129], v212 offset:16384
  v_mfma_f32_16x16x32_bf16 v[144:147], a[88:91], a[200:203], v[144:147]
  v_mfma_f32_16x16x32_bf16 v[128:131], a[92:95], a[204:207], v[128:131]
  s_add_u32 s51, s16, 53248
  buffer_load_dwordx4 v24, s[20:23], s51 offen offset:2048 lds
  v_mfma_f32_16x16x32_bf16 v[132:135], a[92:95], a[208:211], v[132:135]
  ds_read_b64_tr_b16 a[130:131], v212 offset:18432
  v_mfma_f32_16x16x32_bf16 v[136:139], a[92:95], a[212:215], v[136:139]
  ds_read_b64_tr_b16 a[132:133], v212 offset:20480
  v_mfma_f32_16x16x32_bf16 v[140:143], a[92:95], a[216:219], v[140:143]
  s_add_u32 s51, s16, 61440
  buffer_load_dwordx4 v24, s[20:23], s51 offen offset:3072 lds
  v_mfma_f32_16x16x32_bf16 v[144:147], a[92:95], a[220:223], v[144:147]
  ds_read_b64_tr_b16 a[134:135], v212 offset:22528
  v_mfma_f32_16x16x32_bf16 v[128:131], a[96:99], a[0:3], v[128:131]
  s_nop 0
  s_add_u32 s16, s16, 128
  s_cmp_eq_u32 s16, 1152
  s_cselect_b32 s16, 0, s16
  v_mfma_f32_16x16x32_bf16 v[132:135], a[96:99], a[4:7], v[132:135]
  ds_read_b64_tr_b16 a[136:137], v212 offset:24576
  v_mfma_f32_16x16x32_bf16 v[136:139], a[96:99], a[8:11], v[136:139]
  v_mfma_f32_16x16x32_bf16 v[140:143], a[96:99], a[12:15], v[140:143]
  ds_read_b64_tr_b16 a[138:139], v212 offset:26624
  v_mfma_f32_16x16x32_bf16 v[144:147], a[96:99], a[16:19], v[144:147]
  v_cvt_pk_bf16_f32 v38, v148, v149
  v_cvt_pk_bf16_f32 v39, v150, v151
  v_mfma_f32_16x16x32_bf16 v[128:131], a[100:103], a[20:23], v[128:131]
  s_nop 0
  ds_read_b64_tr_b16 a[140:141], v212 offset:28672
  s_mov_b32 s3, 0
  v_mfma_f32_16x16x32_bf16 v[132:135], a[100:103], a[24:27], v[132:135]
  v_mfma_f32_16x16x32_bf16 v[136:139], a[100:103], a[28:31], v[136:139]
  buffer_store_dwordx4 v[36:39], v217, s[24:27], s3 offen offset:2048 sc1
  v_mfma_f32_16x16x32_bf16 v[140:143], a[100:103], a[32:35], v[140:143]
  ds_read_b64_tr_b16 a[142:143], v212 offset:30720
  v_cvt_pk_bf16_f32 v40, v152, v153
  v_mfma_f32_16x16x32_bf16 v[144:147], a[100:103], a[36:39], v[144:147]
  v_cvt_pk_bf16_f32 v41, v154, v155
  v_cvt_pk_bf16_f32 v42, v156, v157
  v_mfma_f32_16x16x32_bf16 v[128:131], a[104:107], a[40:43], v[128:131]
  v_cvt_pk_bf16_f32 v43, v158, v159
  v_mfma_f32_16x16x32_bf16 v[132:135], a[104:107], a[44:47], v[132:135]
  s_nop 0
  s_mov_b32 s3, 0
  v_mfma_f32_16x16x32_bf16 v[136:139], a[104:107], a[48:51], v[136:139]
  v_mfma_f32_16x16x32_bf16 v[140:143], a[104:107], a[52:55], v[140:143]
  buffer_store_dwordx4 v[40:43], v217, s[24:27], s3 offen offset:3072 sc1
  v_mfma_f32_16x16x32_bf16 v[144:147], a[104:107], a[56:59], v[144:147]
  v_cvt_pk_bf16_f32 v44, v160, v161
  v_cvt_pk_bf16_f32 v45, v162, v163
  v_mfma_f32_16x16x32_bf16 v[128:131], a[108:111], a[60:63], v[128:131]
  v_cvt_pk_bf16_f32 v46, v164, v165
  v_mfma_f32_16x16x32_bf16 v[132:135], a[108:111], a[64:67], v[132:135]
  v_cvt_pk_bf16_f32 v47, v166, v167
  v_mfma_f32_16x16x32_bf16 v[136:139], a[108:111], a[68:71], v[136:139]
  s_mov_b32 s3, 4096
  v_mfma_f32_16x16x32_bf16 v[140:143], a[108:111], a[72:75], v[140:143]
  v_mfma_f32_16x16x32_bf16 v[144:147], a[108:111], a[76:79], v[144:147]
  buffer_store_dwordx4 v[44:47], v217, s[24:27], s3 offen offset:0 sc1
  s_waitcnt vmcnt(13) lgkmcnt(0)
  s_barrier
  v_mfma_f32_16x16x32_bf16 v[148:151], a[112:115], a[144:147], 0
  s_nop 0
  ds_read_b64_tr_b16 a[80:81], v212 offset:32768
  s_add_u32 m0, s53, 65536
  s_add_u32 s51, s16, 0x0
  v_mfma_f32_16x16x32_bf16 v[152:155], a[112:115], a[148:151], 0
  buffer_load_dwordx4 v24, s[20:23], s51 offen offset:0 lds
  ds_read_b64_tr_b16 a[82:83], v212 offset:34816
  s_add_u32 s51, s16, 8192
  v_mfma_f32_16x16x32_bf16 v[156:159], a[112:115], a[152:155], 0
  buffer_load_dwordx4 v24, s[20:23], s51 offen offset:1024 lds
  ds_read_b64_tr_b16 a[84:85], v212 offset:36864
  v_mfma_f32_16x16x32_bf16 v[160:163], a[112:115], a[156:159], 0
  v_mfma_f32_16x16x32_bf16 v[164:167], a[112:115], a[160:163], 0
  s_add_u32 s51, s16, 16384
  ds_read_b64_tr_b16 a[86:87], v212 offset:38912
  v_mfma_f32_16x16x32_bf16 v[148:151], a[116:119], a[164:167], v[148:151]
  buffer_load_dwordx4 v24, s[20:23], s51 offen offset:2048 lds
  v_mfma_f32_16x16x32_bf16 v[152:155], a[116:119], a[168:171], v[152:155]
  ds_read_b64_tr_b16 a[88:89], v212 offset:40960
  v_mfma_f32_16x16x32_bf16 v[156:159], a[116:119], a[172:175], v[156:159]
  s_add_u32 s51, s16, 24576
  buffer_load_dwordx4 v24, s[20:23], s51 offen offset:3072 lds
  v_mfma_f32_16x16x32_bf16 v[160:163], a[116:119], a[176:179], v[160:163]
  ds_read_b64_tr_b16 a[90:91], v212 offset:43008
  v_mfma_f32_16x16x32_bf16 v[164:167], a[116:119], a[180:183], v[164:167]
  s_add_u32 m0, s53, 69632
  v_mfma_f32_16x16x32_bf16 v[148:151], a[120:123], a[184:187], v[148:151]
  s_add_u32 s51, s16, 36864
  ds_read_b64_tr_b16 a[92:93], v212 offset:45056
  v_mfma_f32_16x16x32_bf16 v[152:155], a[120:123], a[188:191], v[152:155]
  buffer_load_dwordx4 v24, s[20:23], s51 offen offset:0 lds
  v_mfma_f32_16x16x32_bf16 v[156:159], a[120:123], a[192:195], v[156:159]
  ds_read_b64_tr_b16 a[94:95], v212 offset:47104
  s_add_u32 s51, s16, 45056
  v_mfma_f32_16x16x32_bf16 v[160:163], a[120:123], a[196:199], v[160:163]
  buffer_load_dwordx4 v24, s[20:23], s51 offen offset:1024 lds
  ds_read_b64_tr_b16 a[96:97], v212 offset:49152
  v_mfma_f32_16x16x32_bf16 v[164:167], a[120:123], a[200:203], v[164:167]
  v_mfma_f32_16x16x32_bf16 v[148:151], a[124:127], a[204:207], v[148:151]
  s_add_u32 s51, s16, 53248
  buffer_load_dwordx4 v24, s[20:23], s51 offen offset:2048 lds
  v_mfma_f32_16x16x32_bf16 v[152:155], a[124:127], a[208:211], v[152:155]
  ds_read_b64_tr_b16 a[98:99], v212 offset:51200
  v_mfma_f32_16x16x32_bf16 v[156:159], a[124:127], a[212:215], v[156:159]
  ds_read_b64_tr_b16 a[100:101], v212 offset:53248
  v_mfma_f32_16x16x32_bf16 v[160:163], a[124:127], a[216:219], v[160:163]
  s_add_u32 s51, s16, 61440
  buffer_load_dwordx4 v24, s[20:23], s51 offen offset:3072 lds
  v_mfma_f32_16x16x32_bf16 v[164:167], a[124:127], a[220:223], v[164:167]
  ds_read_b64_tr_b16 a[102:103], v212 offset:55296
  v_mfma_f32_16x16x32_bf16 v[148:151], a[128:131], a[0:3], v[148:151]
  s_nop 0
  s_add_u32 s16, s16, 128
  s_cmp_eq_u32 s16, 1152
  s_cselect_b32 s16, 0, s16
  v_mfma_f32_16x16x32_bf16 v[152:155], a[128:131], a[4:7], v[152:155]
  ds_read_b64_tr_b16 a[104:105], v212 offset:57344
  v_mfma_f32_16x16x32_bf16 v[156:159], a[128:131], a[8:11], v[156:159]
  v_mfma_f32_16x16x32_bf16 v[160:163], a[128:131], a[12:15], v[160:163]
  ds_read_b64_tr_b16 a[106:107], v212 offset:59392
  v_mfma_f32_16x16x32_bf16 v[164:167], a[128:131], a[16:19], v[164:167]
  v_cvt_pk_bf16_f32 v48, v128, v129
  v_cvt_pk_bf16_f32 v49, v130, v131
  v_mfma_f32_16x16x32_bf16 v[148:151], a[132:135], a[20:23], v[148:151]
  ds_read_b64_tr_b16 a[108:109], v212 offset:61440
  v_cvt_pk_bf16_f32 v50, v132, v133
  v_mfma_f32_16x16x32_bf16 v[152:155], a[132:135], a[24:27], v[152:155]
  v_cvt_pk_bf16_f32 v51, v134, v135
  v_mfma_f32_16x16x32_bf16 v[156:159], a[132:135], a[28:31], v[156:159]
  ds_read_b64_tr_b16 a[110:111], v212 offset:63488
  v_mfma_f32_16x16x32_bf16 v[160:163], a[132:135], a[32:35], v[160:163]
  s_mov_b32 s3, 4096
  v_mfma_f32_16x16x32_bf16 v[164:167], a[132:135], a[36:39], v[164:167]
  v_mfma_f32_16x16x32_bf16 v[148:151], a[136:139], a[40:43], v[148:151]
  buffer_store_dwordx4 v[48:51], v217, s[24:27], s3 offen offset:1024 sc1
  v_mfma_f32_16x16x32_bf16 v[152:155], a[136:139], a[44:47], v[152:155]
  v_cvt_pk_bf16_f32 v28, v136, v137
  v_cvt_pk_bf16_f32 v29, v138, v139
  v_mfma_f32_16x16x32_bf16 v[156:159], a[136:139], a[48:51], v[156:159]
  v_cvt_pk_bf16_f32 v30, v140, v141
  v_mfma_f32_16x16x32_bf16 v[160:163], a[136:139], a[52:55], v[160:163]
  v_cvt_pk_bf16_f32 v31, v142, v143
  v_mfma_f32_16x16x32_bf16 v[164:167], a[136:139], a[56:59], v[164:167]
  s_mov_b32 s3, 4096
  v_mfma_f32_16x16x32_bf16 v[148:151], a[140:143], a[60:63], v[148:151]
  v_mfma_f32_16x16x32_bf16 v[152:155], a[140:143], a[64:67], v[152:155]
  v_mfma_f32_16x16x32_bf16 v[156:159], a[140:143], a[68:71], v[156:159]
  buffer_store_dwordx4 v[28:31], v217, s[24:27], s3 offen offset:2048 sc1
  v_mfma_f32_16x16x32_bf16 v[160:163], a[140:143], a[72:75], v[160:163]
  v_cvt_pk_bf16_f32 v32, v144, v145
  v_cvt_pk_bf16_f32 v33, v146, v147
  v_mfma_f32_16x16x32_bf16 v[164:167], a[140:143], a[76:79], v[164:167]
  s_waitcnt vmcnt(13) lgkmcnt(0)
  s_barrier
  v_mfma_f32_16x16x32_bf16 v[128:131], a[80:83], a[144:147], 0
  ds_read_b64_tr_b16 a[112:113], v213 offset:32768
  s_add_u32 m0, s53, 0x0
  s_add_u32 s51, s16, 0x0
  v_mfma_f32_16x16x32_bf16 v[132:135], a[80:83], a[148:151], 0
  buffer_load_dwordx4 v24, s[20:23], s51 offen offset:0 lds
  ds_read_b64_tr_b16 a[114:115], v213 offset:34816
  s_add_u32 s51, s16, 8192
  v_mfma_f32_16x16x32_bf16 v[136:139], a[80:83], a[152:155], 0
  buffer_load_dwordx4 v24, s[20:23], s51 offen offset:1024 lds
  ds_read_b64_tr_b16 a[116:117], v213 offset:36864
  v_mfma_f32_16x16x32_bf16 v[140:143], a[80:83], a[156:159], 0
  v_mfma_f32_16x16x32_bf16 v[144:147], a[80:83], a[160:163], 0
  s_add_u32 s51, s16, 16384
  ds_read_b64_tr_b16 a[118:119], v213 offset:38912
  v_mfma_f32_16x16x32_bf16 v[128:131], a[84:87], a[164:167], v[128:131]
  buffer_load_dwordx4 v24, s[20:23], s51 offen offset:2048 lds
  v_mfma_f32_16x16x32_bf16 v[132:135], a[84:87], a[168:171], v[132:135]
  ds_read_b64_tr_b16 a[120:121], v213 offset:40960
  v_mfma_f32_16x16x32_bf16 v[136:139], a[84:87], a[172:175], v[136:139]
  s_add_u32 s51, s16, 24576
  buffer_load_dwordx4 v24, s[20:23], s51 offen offset:3072 lds
  v_mfma_f32_16x16x32_bf16 v[140:143], a[84:87], a[176:179], v[140:143]
  ds_read_b64_tr_b16 a[122:123], v213 offset:43008
  v_mfma_f32_16x16x32_bf16 v[144:147], a[84:87], a[180:183], v[144:147]
  s_add_u32 m0, s53, 4096
  v_mfma_f32_16x16x32_bf16 v[128:131], a[88:91], a[184:187], v[128:131]
  s_add_u32 s51, s16, 36864
  ds_read_b64_tr_b16 a[124:125], v213 offset:45056
  v_mfma_f32_16x16x32_bf16 v[132:135], a[88:91], a[188:191], v[132:135]
  buffer_load_dwordx4 v24, s[20:23], s51 offen offset:0 lds
  v_mfma_f32_16x16x32_bf16 v[136:139], a[88:91], a[192:195], v[136:139]
  ds_read_b64_tr_b16 a[126:127], v213 offset:47104
  s_add_u32 s51, s16, 45056
  v_mfma_f32_16x16x32_bf16 v[140:143], a[88:91], a[196:199], v[140:143]
  buffer_load_dwordx4 v24, s[20:23], s51 offen offset:1024 lds
  ds_read_b64_tr_b16 a[128:129], v213 offset:49152
  v_mfma_f32_16x16x32_bf16 v[144:147], a[88:91], a[200:203], v[144:147]
  v_mfma_f32_16x16x32_bf16 v[128:131], a[92:95], a[204:207], v[128:131]
  s_add_u32 s51, s16, 53248
  buffer_load_dwordx4 v24, s[20:23], s51 offen offset:2048 lds
  v_mfma_f32_16x16x32_bf16 v[132:135], a[92:95], a[208:211], v[132:135]
  ds_read_b64_tr_b16 a[130:131], v213 offset:51200
  v_mfma_f32_16x16x32_bf16 v[136:139], a[92:95], a[212:215], v[136:139]
  ds_read_b64_tr_b16 a[132:133], v213 offset:53248
  v_mfma_f32_16x16x32_bf16 v[140:143], a[92:95], a[216:219], v[140:143]
  s_add_u32 s51, s16, 61440
  buffer_load_dwordx4 v24, s[20:23], s51 offen offset:3072 lds
  v_mfma_f32_16x16x32_bf16 v[144:147], a[92:95], a[220:223], v[144:147]
  ds_read_b64_tr_b16 a[134:135], v213 offset:55296
  v_mfma_f32_16x16x32_bf16 v[128:131], a[96:99], a[0:3], v[128:131]
  s_nop 0
  s_add_u32 s16, s16, 128
  s_cmp_eq_u32 s16, 1152
  s_cselect_b32 s16, 0, s16
  v_mfma_f32_16x16x32_bf16 v[132:135], a[96:99], a[4:7], v[132:135]
  ds_read_b64_tr_b16 a[136:137], v213 offset:57344
  v_mfma_f32_16x16x32_bf16 v[136:139], a[96:99], a[8:11], v[136:139]
  v_mfma_f32_16x16x32_bf16 v[140:143], a[96:99], a[12:15], v[140:143]
  ds_read_b64_tr_b16 a[138:139], v213 offset:59392
  v_mfma_f32_16x16x32_bf16 v[144:147], a[96:99], a[16:19], v[144:147]
  v_cvt_pk_bf16_f32 v34, v148, v149
  v_cvt_pk_bf16_f32 v35, v150, v151
  v_mfma_f32_16x16x32_bf16 v[128:131], a[100:103], a[20:23], v[128:131]
  ds_read_b64_tr_b16 a[140:141], v213 offset:61440
  s_mov_b32 s3, 4096
  v_mfma_f32_16x16x32_bf16 v[132:135], a[100:103], a[24:27], v[132:135]
  v_mfma_f32_16x16x32_bf16 v[136:139], a[100:103], a[28:31], v[136:139]
  buffer_store_dwordx4 v[32:35], v217, s[24:27], s3 offen offset:3072 sc1
  v_mfma_f32_16x16x32_bf16 v[140:143], a[100:103], a[32:35], v[140:143]
  ds_read_b64_tr_b16 a[142:143], v213 offset:63488
  v_cvt_pk_bf16_f32 v36, v152, v153
  v_mfma_f32_16x16x32_bf16 v[144:147], a[100:103], a[36:39], v[144:147]
  v_cvt_pk_bf16_f32 v37, v154, v155
  v_cvt_pk_bf16_f32 v38, v156, v157
  v_mfma_f32_16x16x32_bf16 v[128:131], a[104:107], a[40:43], v[128:131]
  v_cvt_pk_bf16_f32 v39, v158, v159
  v_mfma_f32_16x16x32_bf16 v[132:135], a[104:107], a[44:47], v[132:135]
  s_mov_b32 s3, 8192
  v_mfma_f32_16x16x32_bf16 v[136:139], a[104:107], a[48:51], v[136:139]
  v_mfma_f32_16x16x32_bf16 v[140:143], a[104:107], a[52:55], v[140:143]
  buffer_store_dwordx4 v[36:39], v217, s[24:27], s3 offen offset:0 sc1
  v_mfma_f32_16x16x32_bf16 v[144:147], a[104:107], a[56:59], v[144:147]
  v_cvt_pk_bf16_f32 v40, v160, v161
  v_cvt_pk_bf16_f32 v41, v162, v163
  v_mfma_f32_16x16x32_bf16 v[128:131], a[108:111], a[60:63], v[128:131]
  v_cvt_pk_bf16_f32 v42, v164, v165
  v_mfma_f32_16x16x32_bf16 v[132:135], a[108:111], a[64:67], v[132:135]
  v_cvt_pk_bf16_f32 v43, v166, v167
  v_mfma_f32_16x16x32_bf16 v[136:139], a[108:111], a[68:71], v[136:139]
  s_mov_b32 s3, 8192
  v_mfma_f32_16x16x32_bf16 v[140:143], a[108:111], a[72:75], v[140:143]
  v_mfma_f32_16x16x32_bf16 v[144:147], a[108:111], a[76:79], v[144:147]
  buffer_store_dwordx4 v[40:43], v217, s[24:27], s3 offen offset:1024 sc1
  s_waitcnt vmcnt(13) lgkmcnt(0)
  s_barrier
  v_mfma_f32_16x16x32_bf16 v[148:151], a[112:115], a[144:147], 0
  s_nop 0
  ds_read_b64_tr_b16 a[80:81], v213 offset:0
  s_add_u32 m0, s53, 32768
  s_add_u32 s51, s16, 0x0
  v_mfma_f32_16x16x32_bf16 v[152:155], a[112:115], a[148:151], 0
  buffer_load_dwordx4 v24, s[20:23], s51 offen offset:0 lds
  ds_read_b64_tr_b16 a[82:83], v213 offset:2048
  s_add_u32 s51, s16, 8192
  v_mfma_f32_16x16x32_bf16 v[156:159], a[112:115], a[152:155], 0
  buffer_load_dwordx4 v24, s[20:23], s51 offen offset:1024 lds
  ds_read_b64_tr_b16 a[84:85], v213 offset:4096
  v_mfma_f32_16x16x32_bf16 v[160:163], a[112:115], a[156:159], 0
  v_mfma_f32_16x16x32_bf16 v[164:167], a[112:115], a[160:163], 0
  s_add_u32 s51, s16, 16384
  ds_read_b64_tr_b16 a[86:87], v213 offset:6144
  v_mfma_f32_16x16x32_bf16 v[148:151], a[116:119], a[164:167], v[148:151]
  buffer_load_dwordx4 v24, s[20:23], s51 offen offset:2048 lds
  v_mfma_f32_16x16x32_bf16 v[152:155], a[116:119], a[168:171], v[152:155]
  ds_read_b64_tr_b16 a[88:89], v213 offset:8192
  v_mfma_f32_16x16x32_bf16 v[156:159], a[116:119], a[172:175], v[156:159]
  s_add_u32 s51, s16, 24576
  buffer_load_dwordx4 v24, s[20:23], s51 offen offset:3072 lds
  v_mfma_f32_16x16x32_bf16 v[160:163], a[116:119], a[176:179], v[160:163]
  ds_read_b64_tr_b16 a[90:91], v213 offset:10240
  v_mfma_f32_16x16x32_bf16 v[164:167], a[116:119], a[180:183], v[164:167]
  s_add_u32 m0, s53, 36864
  v_mfma_f32_16x16x32_bf16 v[148:151], a[120:123], a[184:187], v[148:151]
  s_add_u32 s51, s16, 36864
  ds_read_b64_tr_b16 a[92:93], v213 offset:12288
  v_mfma_f32_16x16x32_bf16 v[152:155], a[120:123], a[188:191], v[152:155]
  buffer_load_dwordx4 v24, s[20:23], s51 offen offset:0 lds
  v_mfma_f32_16x16x32_bf16 v[156:159], a[120:123], a[192:195], v[156:159]
  ds_read_b64_tr_b16 a[94:95], v213 offset:14336
  s_add_u32 s51, s16, 45056
  v_mfma_f32_16x16x32_bf16 v[160:163], a[120:123], a[196:199], v[160:163]
  buffer_load_dwordx4 v24, s[20:23], s51 offen offset:1024 lds
  ds_read_b64_tr_b16 a[96:97], v213 offset:16384
  v_mfma_f32_16x16x32_bf16 v[164:167], a[120:123], a[200:203], v[164:167]
  v_mfma_f32_16x16x32_bf16 v[148:151], a[124:127], a[204:207], v[148:151]
  s_add_u32 s51, s16, 53248
  buffer_load_dwordx4 v24, s[20:23], s51 offen offset:2048 lds
  v_mfma_f32_16x16x32_bf16 v[152:155], a[124:127], a[208:211], v[152:155]
  ds_read_b64_tr_b16 a[98:99], v213 offset:18432
  v_mfma_f32_16x16x32_bf16 v[156:159], a[124:127], a[212:215], v[156:159]
  ds_read_b64_tr_b16 a[100:101], v213 offset:20480
  v_mfma_f32_16x16x32_bf16 v[160:163], a[124:127], a[216:219], v[160:163]
  s_add_u32 s51, s16, 61440
  buffer_load_dwordx4 v24, s[20:23], s51 offen offset:3072 lds
  v_mfma_f32_16x16x32_bf16 v[164:167], a[124:127], a[220:223], v[164:167]
  ds_read_b64_tr_b16 a[102:103], v213 offset:22528
  v_mfma_f32_16x16x32_bf16 v[148:151], a[128:131], a[0:3], v[148:151]
  s_nop 0
  s_add_u32 s16, s16, 128
  s_cmp_eq_u32 s16, 1152
  s_cselect_b32 s16, 0, s16
  v_mfma_f32_16x16x32_bf16 v[152:155], a[128:131], a[4:7], v[152:155]
  ds_read_b64_tr_b16 a[104:105], v213 offset:24576
  v_mfma_f32_16x16x32_bf16 v[156:159], a[128:131], a[8:11], v[156:159]
  v_mfma_f32_16x16x32_bf16 v[160:163], a[128:131], a[12:15], v[160:163]
  ds_read_b64_tr_b16 a[106:107], v213 offset:26624
  v_mfma_f32_16x16x32_bf16 v[164:167], a[128:131], a[16:19], v[164:167]
  v_cvt_pk_bf16_f32 v44, v128, v129
  v_cvt_pk_bf16_f32 v45, v130, v131
  v_mfma_f32_16x16x32_bf16 v[148:151], a[132:135], a[20:23], v[148:151]
  ds_read_b64_tr_b16 a[108:109], v213 offset:28672
  v_cvt_pk_bf16_f32 v46, v132, v133
  v_mfma_f32_16x16x32_bf16 v[152:155], a[132:135], a[24:27], v[152:155]
  v_cvt_pk_bf16_f32 v47, v134, v135
  v_mfma_f32_16x16x32_bf16 v[156:159], a[132:135], a[28:31], v[156:159]
  ds_read_b64_tr_b16 a[110:111], v213 offset:30720
  v_mfma_f32_16x16x32_bf16 v[160:163], a[132:135], a[32:35], v[160:163]
  s_mov_b32 s3, 8192
  v_mfma_f32_16x16x32_bf16 v[164:167], a[132:135], a[36:39], v[164:167]
  v_mfma_f32_16x16x32_bf16 v[148:151], a[136:139], a[40:43], v[148:151]
  buffer_store_dwordx4 v[44:47], v217, s[24:27], s3 offen offset:2048 sc1
  v_mfma_f32_16x16x32_bf16 v[152:155], a[136:139], a[44:47], v[152:155]
  v_cvt_pk_bf16_f32 v48, v136, v137
  v_cvt_pk_bf16_f32 v49, v138, v139
  v_mfma_f32_16x16x32_bf16 v[156:159], a[136:139], a[48:51], v[156:159]
  v_cvt_pk_bf16_f32 v50, v140, v141
  v_mfma_f32_16x16x32_bf16 v[160:163], a[136:139], a[52:55], v[160:163]
  v_cvt_pk_bf16_f32 v51, v142, v143
  v_mfma_f32_16x16x32_bf16 v[164:167], a[136:139], a[56:59], v[164:167]
  s_mov_b32 s3, 8192
  v_mfma_f32_16x16x32_bf16 v[148:151], a[140:143], a[60:63], v[148:151]
  v_mfma_f32_16x16x32_bf16 v[152:155], a[140:143], a[64:67], v[152:155]
  v_mfma_f32_16x16x32_bf16 v[156:159], a[140:143], a[68:71], v[156:159]
  buffer_store_dwordx4 v[48:51], v217, s[24:27], s3 offen offset:3072 sc1
  v_mfma_f32_16x16x32_bf16 v[160:163], a[140:143], a[72:75], v[160:163]
  v_cvt_pk_bf16_f32 v28, v144, v145
  v_cvt_pk_bf16_f32 v29, v146, v147
  v_mfma_f32_16x16x32_bf16 v[164:167], a[140:143], a[76:79], v[164:167]
  s_waitcnt vmcnt(13) lgkmcnt(0)
  s_barrier
  v_mfma_f32_16x16x32_bf16 v[128:131], a[80:83], a[144:147], 0
  ds_read_b64_tr_b16 a[112:113], v212 offset:0
  ds_read_b64_tr_b16 a[114:115], v212 offset:2048
  v_mfma_f32_16x16x32_bf16 v[132:135], a[80:83], a[148:151], 0
  v_mov_b32 v3, 0
  v_mov_b32 v250, 1
  s_and_b32 s38, s36, 1
  s_lshl_b32 s38, s38, 11
  s_mov_b64 exec, 1
  buffer_atomic_add v250, v3, s[64:67], s38 offen offset:64 sc0
  s_mov_b64 exec, -1
  v_mfma_f32_16x16x32_bf16 v[136:139], a[80:83], a[152:155], 0
  ds_read_b64_tr_b16 a[116:117], v212 offset:4096
  v_mfma_f32_16x16x32_bf16 v[140:143], a[80:83], a[156:159], 0
  v_mfma_f32_16x16x32_bf16 v[144:147], a[80:83], a[160:163], 0
  ds_read_b64_tr_b16 a[118:119], v212 offset:6144
  v_mfma_f32_16x16x32_bf16 v[128:131], a[84:87], a[164:167], v[128:131]
  v_mfma_f32_16x16x32_bf16 v[132:135], a[84:87], a[168:171], v[132:135]
  ds_read_b64_tr_b16 a[120:121], v212 offset:8192
  v_mfma_f32_16x16x32_bf16 v[136:139], a[84:87], a[172:175], v[136:139]
  v_mfma_f32_16x16x32_bf16 v[140:143], a[84:87], a[176:179], v[140:143]
  ds_read_b64_tr_b16 a[122:123], v212 offset:10240
  v_mfma_f32_16x16x32_bf16 v[144:147], a[84:87], a[180:183], v[144:147]
  v_mfma_f32_16x16x32_bf16 v[128:131], a[88:91], a[184:187], v[128:131]
  ds_read_b64_tr_b16 a[124:125], v212 offset:12288
  v_mfma_f32_16x16x32_bf16 v[132:135], a[88:91], a[188:191], v[132:135]
  v_mfma_f32_16x16x32_bf16 v[136:139], a[88:91], a[192:195], v[136:139]
  ds_read_b64_tr_b16 a[126:127], v212 offset:14336
  v_mfma_f32_16x16x32_bf16 v[140:143], a[88:91], a[196:199], v[140:143]
  ds_read_b64_tr_b16 a[128:129], v212 offset:16384
  v_mfma_f32_16x16x32_bf16 v[144:147], a[88:91], a[200:203], v[144:147]
  v_mfma_f32_16x16x32_bf16 v[128:131], a[92:95], a[204:207], v[128:131]
  ds_read_b64_tr_b16 a[130:131], v212 offset:18432
  v_mfma_f32_16x16x32_bf16 v[132:135], a[92:95], a[208:211], v[132:135]
  v_mfma_f32_16x16x32_bf16 v[136:139], a[92:95], a[212:215], v[136:139]
  ds_read_b64_tr_b16 a[132:133], v212 offset:20480
  v_mfma_f32_16x16x32_bf16 v[140:143], a[92:95], a[216:219], v[140:143]
  v_mfma_f32_16x16x32_bf16 v[144:147], a[92:95], a[220:223], v[144:147]
  ds_read_b64_tr_b16 a[134:135], v212 offset:22528
  v_mfma_f32_16x16x32_bf16 v[128:131], a[96:99], a[0:3], v[128:131]
  v_mfma_f32_16x16x32_bf16 v[132:135], a[96:99], a[4:7], v[132:135]
  ds_read_b64_tr_b16 a[136:137], v212 offset:24576
  v_mfma_f32_16x16x32_bf16 v[136:139], a[96:99], a[8:11], v[136:139]
  v_mfma_f32_16x16x32_bf16 v[140:143], a[96:99], a[12:15], v[140:143]
  ds_read_b64_tr_b16 a[138:139], v212 offset:26624
  v_mfma_f32_16x16x32_bf16 v[144:147], a[96:99], a[16:19], v[144:147]
  v_cvt_pk_bf16_f32 v30, v148, v149
  v_cvt_pk_bf16_f32 v31, v150, v151
  v_mfma_f32_16x16x32_bf16 v[128:131], a[100:103], a[20:23], v[128:131]
  ds_read_b64_tr_b16 a[140:141], v212 offset:28672
  s_mov_b32 s3, 12288
  v_mfma_f32_16x16x32_bf16 v[132:135], a[100:103], a[24:27], v[132:135]
  v_mfma_f32_16x16x32_bf16 v[136:139], a[100:103], a[28:31], v[136:139]
  buffer_store_dwordx4 v[28:31], v217, s[24:27], s3 offen offset:0 sc1
  v_mfma_f32_16x16x32_bf16 v[140:143], a[100:103], a[32:35], v[140:143]
  ds_read_b64_tr_b16 a[142:143], v212 offset:30720
  v_cvt_pk_bf16_f32 v32, v152, v153
  v_mfma_f32_16x16x32_bf16 v[144:147], a[100:103], a[36:39], v[144:147]
  v_cvt_pk_bf16_f32 v33, v154, v155
  v_cvt_pk_bf16_f32 v34, v156, v157
  v_mfma_f32_16x16x32_bf16 v[128:131], a[104:107], a[40:43], v[128:131]
  v_cvt_pk_bf16_f32 v35, v158, v159
  v_mfma_f32_16x16x32_bf16 v[132:135], a[104:107], a[44:47], v[132:135]
  s_mov_b32 s3, 12288
  v_mfma_f32_16x16x32_bf16 v[136:139], a[104:107], a[48:51], v[136:139]
  v_mfma_f32_16x16x32_bf16 v[140:143], a[104:107], a[52:55], v[140:143]
  buffer_store_dwordx4 v[32:35], v217, s[24:27], s3 offen offset:1024 sc1
  v_mfma_f32_16x16x32_bf16 v[144:147], a[104:107], a[56:59], v[144:147]
  v_cvt_pk_bf16_f32 v36, v160, v161
  v_cvt_pk_bf16_f32 v37, v162, v163
  v_mfma_f32_16x16x32_bf16 v[128:131], a[108:111], a[60:63], v[128:131]
  v_cvt_pk_bf16_f32 v38, v164, v165
  v_mfma_f32_16x16x32_bf16 v[132:135], a[108:111], a[64:67], v[132:135]
  v_cvt_pk_bf16_f32 v39, v166, v167
  v_mfma_f32_16x16x32_bf16 v[136:139], a[108:111], a[68:71], v[136:139]
  s_mov_b32 s3, 12288
  v_mfma_f32_16x16x32_bf16 v[140:143], a[108:111], a[72:75], v[140:143]
  v_mfma_f32_16x16x32_bf16 v[144:147], a[108:111], a[76:79], v[144:147]
  buffer_store_dwordx4 v[36:39], v217, s[24:27], s3 offen offset:2048 sc1
  s_waitcnt vmcnt(6) lgkmcnt(0)
  s_barrier
  v_mfma_f32_16x16x32_bf16 v[148:151], a[112:115], a[144:147], 0
  ds_read_b64_tr_b16 a[80:81], v212 offset:32768
  v_and_b32_e64 v1, 15, v0
  v_mfma_f32_16x16x32_bf16 v[152:155], a[112:115], a[148:151], 0
  ds_read_b64_tr_b16 a[82:83], v212 offset:34816
  v_lshlrev_b32_e64 v4, 2, v1
  v_mfma_f32_16x16x32_bf16 v[156:159], a[112:115], a[152:155], 0
  s_nop 0
  s_lshl_b32 s38, s37, 7
  v_cvt_pk_bf16_f32 v40, v128, v129
  v_cvt_pk_bf16_f32 v41, v130, v131
  v_mfma_f32_16x16x32_bf16 v[160:163], a[112:115], a[156:159], 0
  ds_read_b64_tr_b16 a[84:85], v212 offset:36864
  v_add_u32_e64 v4, s38, v4
  v_mfma_f32_16x16x32_bf16 v[164:167], a[112:115], a[160:163], 0
  v_lshrrev_b32_e64 v2, 4, v0
  v_cvt_pk_bf16_f32 v42, v132, v133
  v_mfma_f32_16x16x32_bf16 v[148:151], a[116:119], a[164:167], v[148:151]
  ds_read_b64_tr_b16 a[86:87], v212 offset:38912
  v_lshrrev_b32_e64 v6, 2, v1
  v_mfma_f32_16x16x32_bf16 v[152:155], a[116:119], a[168:171], v[152:155]
  ds_read_b64_tr_b16 a[88:89], v212 offset:40960
  v_cvt_pk_bf16_f32 v43, v134, v135
  v_mfma_f32_16x16x32_bf16 v[156:159], a[116:119], a[172:175], v[156:159]
  s_mov_b32 s3, 12288
  v_cmp_eq_u32 vcc, v6, v2
  v_and_b32 v6, 1, v0
  v_mfma_f32_16x16x32_bf16 v[160:163], a[116:119], a[176:179], v[160:163]
  ds_read_b64_tr_b16 a[90:91], v212 offset:43008
  v_mfma_f32_16x16x32_bf16 v[164:167], a[116:119], a[180:183], v[164:167]
  buffer_store_dwordx4 v[40:43], v217, s[24:27], s3 offen offset:3072 sc1
  v_mfma_f32_16x16x32_bf16 v[148:151], a[120:123], a[184:187], v[148:151]
  v_lshlrev_b32_e64 v6, 4, v6
  v_cvt_pk_bf16_f32 v44, v136, v137
  v_mfma_f32_16x16x32_bf16 v[152:155], a[120:123], a[188:191], v[152:155]
  ds_read_b64_tr_b16 a[92:93], v212 offset:45056
  v_mov_b32 v7, 0x3f80
  v_mfma_f32_16x16x32_bf16 v[156:159], a[120:123], a[192:195], v[156:159]
  v_cvt_pk_bf16_f32 v45, v138, v139
  v_lshlrev_b32_e64 v6, v6, v7
  v_mfma_f32_16x16x32_bf16 v[160:163], a[120:123], a[196:199], v[160:163]
  ds_read_b64_tr_b16 a[94:95], v212 offset:47104
  v_cvt_pk_bf16_f32 v46, v140, v141
  v_mfma_f32_16x16x32_bf16 v[164:167], a[120:123], a[200:203], v[164:167]
  ds_read_b64_tr_b16 a[96:97], v212 offset:49152
  v_cndmask_b32_e64 v6, 0, v6, vcc
  v_mfma_f32_16x16x32_bf16 v[148:151], a[124:127], a[204:207], v[148:151]
  v_and_b32_e64 v7, 2, v0
  v_cvt_pk_bf16_f32 v47, v142, v143
  v_mfma_f32_16x16x32_bf16 v[152:155], a[124:127], a[208:211], v[152:155]
  s_nop 0
  ds_read_b64_tr_b16 a[98:99], v212 offset:51200
  s_mov_b32 s3, 16384
  v_cmp_eq_u32 vcc, 0, v7
  v_mfma_f32_16x16x32_bf16 v[156:159], a[124:127], a[212:215], v[156:159]
  ds_read_b64_tr_b16 a[100:101], v212 offset:53248
  v_mov_b32_e64 v10, 0
  v_mfma_f32_16x16x32_bf16 v[160:163], a[124:127], a[216:219], v[160:163]
  buffer_store_dwordx4 v[44:47], v217, s[24:27], s3 offen offset:0 sc1
  v_mfma_f32_16x16x32_bf16 v[164:167], a[124:127], a[220:223], v[164:167]
  v_cvt_pk_bf16_f32 v48, v144, v145
  v_mov_b32_e64 v11, 0
  v_mfma_f32_16x16x32_bf16 v[148:151], a[128:131], a[0:3], v[148:151]
  v_cndmask_b32_e64 v8, 0, v6, vcc
  v_cvt_pk_bf16_f32 v49, v146, v147
  v_mfma_f32_16x16x32_bf16 v[152:155], a[128:131], a[4:7], v[152:155]
  ds_read_b64_tr_b16 a[102:103], v212 offset:55296
  v_cndmask_b32 v9, v6, 0, vcc
  v_mfma_f32_16x16x32_bf16 v[156:159], a[128:131], a[8:11], v[156:159]
  ds_read_b64_tr_b16 a[104:105], v212 offset:57344
  v_mov_b32_e64 v12, 0
  v_mfma_f32_16x16x32_bf16 v[160:163], a[128:131], a[12:15], v[160:163]
  ds_read_b64_tr_b16 a[106:107], v212 offset:59392
  v_mov_b32_e64 v13, 0
  v_mfma_f32_16x16x32_bf16 v[164:167], a[128:131], a[16:19], v[164:167]
  v_mov_b32_e64 v14, v8
  v_mfma_f32_16x16x32_bf16 v[148:151], a[132:135], a[20:23], v[148:151]
  ds_read_b64_tr_b16 a[108:109], v212 offset:61440
  v_mov_b32_e64 v15, v9
  v_mfma_f32_16x16x32_bf16 v[152:155], a[132:135], a[24:27], v[152:155]
  v_add_u32 v16, 0x10000, v22
  v_mfma_f32_16x16x32_bf16 v[156:159], a[132:135], a[28:31], v[156:159]
  ds_read_b64_tr_b16 a[110:111], v212 offset:63488
  v_mfma_f32_16x16x32_bf16 v[160:163], a[132:135], a[32:35], v[160:163]
  v_mul_u32_u24 v1, 2304, v1
  v_mfma_f32_16x16x32_bf16 v[164:167], a[132:135], a[36:39], v[164:167]
  v_lshl_add_u32 v1, v2, 3, v1
  v_mfma_f32_16x16x32_bf16 v[148:151], a[136:139], a[40:43], v[148:151]
  s_mul_i32 s49, s36, 184320
  v_mfma_f32_16x16x32_bf16 v[152:155], a[136:139], a[44:47], v[152:155]
  s_mul_i32 s38, s35, 1152
  v_mfma_f32_16x16x32_bf16 v[156:159], a[136:139], a[48:51], v[156:159]
  v_mfma_f32_16x16x32_bf16 v[160:163], a[136:139], a[52:55], v[160:163]
  s_nop 0
  s_add_u32 s49, s49, s38
  v_mfma_f32_16x16x32_bf16 v[164:167], a[136:139], a[56:59], v[164:167]
  s_nop 0
  s_lshl_b32 s38, s32, 4
  v_mfma_f32_16x16x32_bf16 v[148:151], a[140:143], a[60:63], v[148:151]
  s_nop 0
  s_add_u32 s48, s38, s37
  v_mfma_f32_16x16x32_bf16 v[152:155], a[140:143], a[64:67], v[152:155]
  v_mfma_f32_16x16x32_bf16 v[156:159], a[140:143], a[68:71], v[156:159]
  v_mfma_f32_16x16x32_bf16 v[160:163], a[140:143], a[72:75], v[160:163]
  v_mfma_f32_16x16x32_bf16 v[164:167], a[140:143], a[76:79], v[164:167]
  s_waitcnt lgkmcnt(0)
  s_barrier
  v_mfma_f32_16x16x32_bf16 v[128:131], a[80:83], a[144:147], 0
  v_mfma_f32_16x16x32_bf16 v[132:135], a[80:83], a[148:151], 0
  v_mfma_f32_16x16x32_bf16 v[136:139], a[80:83], a[152:155], 0
  v_cvt_pk_bf16_f32 v50, v148, v149
  v_cvt_pk_bf16_f32 v51, v150, v151
  v_mfma_f32_16x16x32_bf16 v[140:143], a[80:83], a[156:159], 0
  s_mov_b32 s3, 16384
  v_mfma_f32_16x16x32_bf16 v[144:147], a[80:83], a[160:163], 0
  v_mfma_f32_16x16x32_bf16 v[128:131], a[84:87], a[164:167], v[128:131]
  v_mfma_f32_16x16x32_bf16 v[132:135], a[84:87], a[168:171], v[132:135]
  buffer_store_dwordx4 v[48:51], v217, s[24:27], s3 offen offset:1024 sc1
  v_mfma_f32_16x16x32_bf16 v[136:139], a[84:87], a[172:175], v[136:139]
  v_cvt_pk_bf16_f32 v28, v152, v153
  v_cvt_pk_bf16_f32 v29, v154, v155
  v_mfma_f32_16x16x32_bf16 v[140:143], a[84:87], a[176:179], v[140:143]
  v_cvt_pk_bf16_f32 v30, v156, v157
  v_mfma_f32_16x16x32_bf16 v[144:147], a[84:87], a[180:183], v[144:147]
  v_mfma_f32_16x16x32_bf16 v[128:131], a[88:91], a[184:187], v[128:131]
  v_cvt_pk_bf16_f32 v31, v158, v159
  v_mfma_f32_16x16x32_bf16 v[132:135], a[88:91], a[188:191], v[132:135]
  s_mov_b32 s3, 16384
  v_mfma_f32_16x16x32_bf16 v[136:139], a[88:91], a[192:195], v[136:139]
  v_mfma_f32_16x16x32_bf16 v[140:143], a[88:91], a[196:199], v[140:143]
  buffer_store_dwordx4 v[28:31], v217, s[24:27], s3 offen offset:2048 sc1
  v_mfma_f32_16x16x32_bf16 v[144:147], a[88:91], a[200:203], v[144:147]
  v_cvt_pk_bf16_f32 v32, v160, v161
  v_cvt_pk_bf16_f32 v33, v162, v163
  v_mfma_f32_16x16x32_bf16 v[128:131], a[92:95], a[204:207], v[128:131]
  v_mfma_f32_16x16x32_bf16 v[132:135], a[92:95], a[208:211], v[132:135]
  v_cvt_pk_bf16_f32 v34, v164, v165
  v_mfma_f32_16x16x32_bf16 v[136:139], a[92:95], a[212:215], v[136:139]
  v_cvt_pk_bf16_f32 v35, v166, v167
  v_mfma_f32_16x16x32_bf16 v[140:143], a[92:95], a[216:219], v[140:143]
  v_mfma_f32_16x16x32_bf16 v[144:147], a[92:95], a[220:223], v[144:147]
  s_mov_b32 s3, 16384
  v_mfma_f32_16x16x32_bf16 v[128:131], a[96:99], a[0:3], v[128:131]
  v_mfma_f32_16x16x32_bf16 v[132:135], a[96:99], a[4:7], v[132:135]
  buffer_store_dwordx4 v[32:35], v217, s[24:27], s3 offen offset:3072 sc1
  v_mfma_f32_16x16x32_bf16 v[136:139], a[96:99], a[8:11], v[136:139]
  v_mfma_f32_16x16x32_bf16 v[140:143], a[96:99], a[12:15], v[140:143]
  v_mfma_f32_16x16x32_bf16 v[144:147], a[96:99], a[16:19], v[144:147]
  v_mfma_f32_16x16x32_bf16 v[128:131], a[100:103], a[20:23], v[128:131]
  v_mfma_f32_16x16x32_bf16 v[132:135], a[100:103], a[24:27], v[132:135]
  v_mfma_f32_16x16x32_bf16 v[136:139], a[100:103], a[28:31], v[136:139]
  v_mfma_f32_16x16x32_bf16 v[140:143], a[100:103], a[32:35], v[140:143]
  v_mfma_f32_16x16x32_bf16 v[144:147], a[100:103], a[36:39], v[144:147]
  v_mfma_f32_16x16x32_bf16 v[128:131], a[104:107], a[40:43], v[128:131]
  v_mfma_f32_16x16x32_bf16 v[132:135], a[104:107], a[44:47], v[132:135]
  v_mfma_f32_16x16x32_bf16 v[136:139], a[104:107], a[48:51], v[136:139]
  v_mfma_f32_16x16x32_bf16 v[140:143], a[104:107], a[52:55], v[140:143]
  v_mfma_f32_16x16x32_bf16 v[144:147], a[104:107], a[56:59], v[144:147]
  v_mfma_f32_16x16x32_bf16 v[128:131], a[108:111], a[60:63], v[128:131]
  v_mfma_f32_16x16x32_bf16 v[132:135], a[108:111], a[64:67], v[132:135]
  v_mfma_f32_16x16x32_bf16 v[136:139], a[108:111], a[68:71], v[136:139]
  v_mfma_f32_16x16x32_bf16 v[140:143], a[108:111], a[72:75], v[140:143]
  v_mfma_f32_16x16x32_bf16 v[144:147], a[108:111], a[76:79], v[144:147]
  s_nop 3
  v_cvt_pk_bf16_f32 v36, v128, v129
  v_cvt_pk_bf16_f32 v37, v130, v131
  v_cvt_pk_bf16_f32 v38, v132, v133
  v_cvt_pk_bf16_f32 v39, v134, v135
  s_mov_b32 s3, 20480
  buffer_store_dwordx4 v[36:39], v217, s[24:27], s3 offen offset:0 sc1
  v_cvt_pk_bf16_f32 v40, v136, v137
  v_cvt_pk_bf16_f32 v41, v138, v139
  v_cvt_pk_bf16_f32 v42, v140, v141
  v_cvt_pk_bf16_f32 v43, v142, v143
  s_mov_b32 s3, 20480
  buffer_store_dwordx4 v[40:43], v217, s[24:27], s3 offen offset:1024 sc1
  v_cvt_pk_bf16_f32 v44, v144, v145
  v_cvt_pk_bf16_f32 v45, v146, v147
  s_mov_b32 s3, 20480
  buffer_store_dwordx4 v[44:47], v217, s[24:27], s3 offen offset:2048 sc1
  s_and_b32 s51, s36, 1
  s_lshl_b32 s51, s51, 11
  buffer_load_dword v5, v4, s[64:67], s51 offen sc1
  s_lshl_b32 s63, 1, s37
  s_waitcnt vmcnt(12)
  v_readfirstlane_b32 s48, v250
  v_add_u32 v16, 47104, v22
  s_lshl_b32 s54, s48, 10
  s_and_b32 s38, s36, 1
  s_mul_i32 s38, s38, 1507328
  s_add_u32 s54, s54, s38
  s_mov_b32 s18, s36
  s_cmp_lt_u32 s48, 46
  s_cselect_b32 s42, 1, 0
  s_mov_b32 s17, s18
  s_mul_hi_u32 s38, s48, 186737709
  s_mul_i32 s39, s38, 23
  s_sub_u32 s71, s48, s39
  s_lshl_b32 s38, s38, 5
  s_add_u32 s70, s49, s38
  s_lshl_b32 s71, s71, 1
  s_mul_hi_u32 s38, s71, 858993460
  s_mul_i32 s39, s38, 5
  s_sub_u32 s39, s71, s39
  s_mul_i32 s39, s39, 36864
  s_add_u32 s60, s70, s39
  s_add_u32 s38, s38, s17
  s_sub_u32 s39, s38, 9
  s_cmp_ge_u32 s38, 9
  s_cselect_b32 s38, s39, s38
  s_lshl_b32 s38, s38, 7
  s_add_u32 s60, s60, s38
  s_add_u32 s71, s71, 1
  s_mul_hi_u32 s38, s71, 858993460
  s_mul_i32 s39, s38, 5
  s_sub_u32 s39, s71, s39
  s_mul_i32 s39, s39, 36864
  s_add_u32 s61, s70, s39
  s_add_u32 s38, s38, s17
  s_sub_u32 s39, s38, 9
  s_cmp_ge_u32 s38, 9
  s_cselect_b32 s38, s39, s38
  s_lshl_b32 s38, s38, 7
  s_add_u32 s61, s61, s38
  s_cmp_ge_u32 s71, 45
  s_cselect_b32 s61, 0x10000000, s61
  s_cmp_ge_u32 s48, 92
  s_cselect_b32 s60, 0x10000000, s60
  s_cselect_b32 s61, 0x10000000, s61
  s_add_u32 s55, s48, 46
  s_mul_hi_u32 s38, s55, 186737709
  s_mul_i32 s39, s38, 23
  s_sub_u32 s71, s55, s39
  s_lshl_b32 s38, s38, 5
  s_add_u32 s70, s49, s38
  s_lshl_b32 s71, s71, 1
  s_mul_hi_u32 s38, s71, 858993460
  s_mul_i32 s39, s38, 5
  s_sub_u32 s39, s71, s39
  s_mul_i32 s39, s39, 36864
  s_add_u32 s40, s70, s39
  s_add_u32 s38, s38, s17
  s_sub_u32 s39, s38, 9
  s_cmp_ge_u32 s38, 9
  s_cselect_b32 s38, s39, s38
  s_lshl_b32 s38, s38, 7
  s_add_u32 s40, s40, s38
  s_add_u32 s71, s71, 1
  s_mul_hi_u32 s38, s71, 858993460
  s_mul_i32 s39, s38, 5
  s_sub_u32 s39, s71, s39
  s_mul_i32 s39, s39, 36864
  s_add_u32 s41, s70, s39
  s_add_u32 s38, s38, s17
  s_sub_u32 s39, s38, 9
  s_cmp_ge_u32 s38, 9
  s_cselect_b32 s38, s39, s38
  s_lshl_b32 s38, s38, 7
  s_add_u32 s41, s41, s38
  s_cmp_ge_u32 s71, 45
  s_cselect_b32 s41, 0x10000000, s41
  s_cmp_ge_u32 s55, 92
  s_cselect_b32 s40, 0x10000000, s40
  s_cselect_b32 s41, 0x10000000, s41
  s_mov_b32 s62, 0xffff
  v_mov_b32 v192, 0
  v_mov_b32 v193, 0
  v_mov_b32 v194, 0
  v_mov_b32 v195, 0
  v_mov_b32 v196, 0
  v_mov_b32 v197, 0
  v_mov_b32 v198, 0
  v_mov_b32 v199, 0
  v_mov_b32 v200, 0
  v_mov_b32 v201, 0
  v_mov_b32 v202, 0
  v_mov_b32 v203, 0
  v_mov_b32 v204, 0
  v_mov_b32 v205, 0
  v_mov_b32 v206, 0
  v_mov_b32 v207, 0
  s_waitcnt vmcnt(0) lgkmcnt(0)
  s_barrier
  v_lshlrev_b32 v3, 7, v0
  v_mov_b32 v23, 1
  s_lshl_b32 s38, s37, 2
  s_and_b32 s39, s36, 1
  s_lshl_b32 s39, s39, 11
  s_add_u32 s38, s38, s39
  s_cmp_eq_u32 s32, 0
  s_cselect_b32 s70, 65535, 0
  s_mov_b32 s71, 0
  s_mov_b64 exec, s[70:71]
  buffer_store_dword v23, v3, s[64:67], s38 offen sc1
  s_mov_b64 exec, -1
  s_cmp_ge_u32 s48, 46
  s_cbranch_scc1 L_fin
L_red:
  v_cmp_eq_u32 vcc, 1, v5
  s_or_b32 s63, s63, vcc_lo
  s_and_b32 s63, s63, s62
  s_cbranch_scc0 L_red_poll
  s_andn2_b32 s62, s62, s63
  s_bcnt1_i32_b32 s39, s63
  s_cmp_lg_u32 s42, 0
  s_cbranch_scc1 L_red2
  s_ff1_i32_b32 s38, s63
  s_bitset0_b32 s63, s38
  s_mul_i32 s3, s38, 94208
  s_add_u32 s3, s3, s54
  buffer_load_dwordx4 v[64:67], v22, s[28:31], s3 offen sc1
  s_cmp_eq_u32 s63, 0
  s_cbranch_scc1 L_ri0
  s_ff1_i32_b32 s38, s63
  s_bitset0_b32 s63, s38
  s_mul_i32 s3, s38, 94208
  s_add_u32 s3, s3, s54
  buffer_load_dwordx4 v[68:71], v22, s[28:31], s3 offen sc1
  s_cmp_eq_u32 s63, 0
  s_cbranch_scc1 L_ri0
  s_ff1_i32_b32 s38, s63
  s_bitset0_b32 s63, s38
  s_mul_i32 s3, s38, 94208
  s_add_u32 s3, s3, s54
  buffer_load_dwordx4 v[72:75], v22, s[28:31], s3 offen sc1
  s_cmp_eq_u32 s63, 0
  s_cbranch_scc1 L_ri0
  s_ff1_i32_b32 s38, s63
  s_bitset0_b32 s63, s38
  s_mul_i32 s3, s38, 94208
  s_add_u32 s3, s3, s54
  buffer_load_dwordx4 v[76:79], v22, s[28:31], s3 offen sc1
  s_cmp_eq_u32 s63, 0
  s_cbranch_scc1 L_ri0
  s_ff1_i32_b32 s38, s63
  s_bitset0_b32 s63, s38
  s_mul_i32 s3, s38, 94208
  s_add_u32 s3, s3, s54
  buffer_load_dwordx4 v[80:83], v22, s[28:31], s3 offen sc1
  s_cmp_eq_u32 s63, 0
  s_cbranch_scc1 L_ri0
  s_ff1_i32_b32 s38, s63
  s_bitset0_b32 s63, s38
  s_mul_i32 s3, s38, 94208
  s_add_u32 s3, s3, s54
  buffer_load_dwordx4 v[84:87], v22, s[28:31], s3 offen sc1
  s_cmp_eq_u32 s63, 0
  s_cbranch_scc1 L_ri0
  s_ff1_i32_b32 s38, s63
  s_bitset0_b32 s63, s38
  s_mul_i32 s3, s38, 94208
  s_add_u32 s3, s3, s54
  buffer_load_dwordx4 v[88:91], v22, s[28:31], s3 offen sc1
  s_cmp_eq_u32 s63, 0
  s_cbranch_scc1 L_ri0
  s_ff1_i32_b32 s38, s63
  s_bitset0_b32 s63, s38
  s_mul_i32 s3, s38, 94208
  s_add_u32 s3, s3, s54
  buffer_load_dwordx4 v[92:95], v22, s[28:31], s3 offen sc1
  s_cmp_eq_u32 s63, 0
  s_cbranch_scc1 L_ri0
  s_ff1_i32_b32 s38, s63
  s_bitset0_b32 s63, s38
  s_mul_i32 s3, s38, 94208
  s_add_u32 s3, s3, s54
  buffer_load_dwordx4 v[96:99], v22, s[28:31], s3 offen sc1
  s_cmp_eq_u32 s63, 0
  s_cbranch_scc1 L_ri0
  s_ff1_i32_b32 s38, s63
  s_bitset0_b32 s63, s38
  s_mul_i32 s3, s38, 94208
  s_add_u32 s3, s3, s54
  buffer_load_dwordx4 v[100:103], v22, s[28:31], s3 offen sc1
  s_cmp_eq_u32 s63, 0
  s_cbranch_scc1 L_ri0
  s_ff1_i32_b32 s38, s63
  s_bitset0_b32 s63, s38
  s_mul_i32 s3, s38, 94208
  s_add_u32 s3, s3, s54
  buffer_load_dwordx4 v[104:107], v22, s[28:31], s3 offen sc1
  s_cmp_eq_u32 s63, 0
  s_cbranch_scc1 L_ri0
  s_ff1_i32_b32 s38, s63
  s_bitset0_b32 s63, s38
  s_mul_i32 s3, s38, 94208
  s_add_u32 s3, s3, s54
  buffer_load_dwordx4 v[108:111], v22, s[28:31], s3 offen sc1
  s_cmp_eq_u32 s63, 0
  s_cbranch_scc1 L_ri0
  s_ff1_i32_b32 s38, s63
  s_bitset0_b32 s63, s38
  s_mul_i32 s3, s38, 94208
  s_add_u32 s3, s3, s54
  buffer_load_dwordx4 v[112:115], v22, s[28:31], s3 offen sc1
  s_cmp_eq_u32 s63, 0
  s_cbranch_scc1 L_ri0
  s_ff1_i32_b32 s38, s63
  s_bitset0_b32 s63, s38
  s_mul_i32 s3, s38, 94208
  s_add_u32 s3, s3, s54
  buffer_load_dwordx4 v[116:119], v22, s[28:31], s3 offen sc1
  s_cmp_eq_u32 s63, 0
  s_cbranch_scc1 L_ri0
  s_ff1_i32_b32 s38, s63
  s_bitset0_b32 s63, s38
  s_mul_i32 s3, s38, 94208
  s_add_u32 s3, s3, s54
  buffer_load_dwordx4 v[120:123], v22, s[28:31], s3 offen sc1
  s_cmp_eq_u32 s63, 0
  s_cbranch_scc1 L_ri0
  s_ff1_i32_b32 s38, s63
  s_bitset0_b32 s63, s38
  s_mul_i32 s3, s38, 94208
  s_add_u32 s3, s3, s54
  buffer_load_dwordx4 v[124:127], v22, s[28:31], s3 offen sc1
L_ri0:
  buffer_load_dword v5, v4, s[64:67], s51 offen sc1
  s_waitcnt vmcnt(1)
  s_nop 0
  v_mfma_f32_16x16x32_bf16 v[192:195], v[8:11], v[64:67], v[192:195]
  v_mfma_f32_16x16x32_bf16 v[196:199], v[12:15], v[64:67], v[196:199]
  s_cmp_eq_u32 s39, 1
  s_cbranch_scc1 L_rd
  v_mfma_f32_16x16x32_bf16 v[192:195], v[8:11], v[68:71], v[192:195]
  v_mfma_f32_16x16x32_bf16 v[196:199], v[12:15], v[68:71], v[196:199]
  s_cmp_eq_u32 s39, 2
  s_cbranch_scc1 L_rd
  v_mfma_f32_16x16x32_bf16 v[192:195], v[8:11], v[72:75], v[192:195]
  v_mfma_f32_16x16x32_bf16 v[196:199], v[12:15], v[72:75], v[196:199]
  s_cmp_eq_u32 s39, 3
  s_cbranch_scc1 L_rd
  v_mfma_f32_16x16x32_bf16 v[192:195], v[8:11], v[76:79], v[192:195]
  v_mfma_f32_16x16x32_bf16 v[196:199], v[12:15], v[76:79], v[196:199]
  s_cmp_eq_u32 s39, 4
  s_cbranch_scc1 L_rd
  v_mfma_f32_16x16x32_bf16 v[192:195], v[8:11], v[80:83], v[192:195]
  v_mfma_f32_16x16x32_bf16 v[196:199], v[12:15], v[80:83], v[196:199]
  s_cmp_eq_u32 s39, 5
  s_cbranch_scc1 L_rd
  v_mfma_f32_16x16x32_bf16 v[192:195], v[8:11], v[84:87], v[192:195]
  v_mfma_f32_16x16x32_bf16 v[196:199], v[12:15], v[84:87], v[196:199]
  s_cmp_eq_u32 s39, 6
  s_cbranch_scc1 L_rd
  v_mfma_f32_16x16x32_bf16 v[192:195], v[8:11], v[88:91], v[192:195]
  v_mfma_f32_16x16x32_bf16 v[196:199], v[12:15], v[88:91], v[196:199]
  s_cmp_eq_u32 s39, 7
  s_cbranch_scc1 L_rd
  v_mfma_f32_16x16x32_bf16 v[192:195], v[8:11], v[92:95], v[192:195]
  v_mfma_f32_16x16x32_bf16 v[196:199], v[12:15], v[92:95], v[196:199]
  s_cmp_eq_u32 s39, 8
  s_cbranch_scc1 L_rd
  v_mfma_f32_16x16x32_bf16 v[192:195], v[8:11], v[96:99], v[192:195]
  v_mfma_f32_16x16x32_bf16 v[196:199], v[12:15], v[96:99], v[196:199]
  s_cmp_eq_u32 s39, 9
  s_cbranch_scc1 L_rd
  v_mfma_f32_16x16x32_bf16 v[192:195], v[8:11], v[100:103], v[192:195]
  v_mfma_f32_16x16x32_bf16 v[196:199], v[12:15], v[100:103], v[196:199]
  s_cmp_eq_u32 s39, 10
  s_cbranch_scc1 L_rd
  v_mfma_f32_16x16x32_bf16 v[192:195], v[8:11], v[104:107], v[192:195]
  v_mfma_f32_16x16x32_bf16 v[196:199], v[12:15], v[104:107], v[196:199]
  s_cmp_eq_u32 s39, 11
  s_cbranch_scc1 L_rd
  v_mfma_f32_16x16x32_bf16 v[192:195], v[8:11], v[108:111], v[192:195]
  v_mfma_f32_16x16x32_bf16 v[196:199], v[12:15], v[108:111], v[196:199]
  s_cmp_eq_u32 s39, 12
  s_cbranch_scc1 L_rd
  v_mfma_f32_16x16x32_bf16 v[192:195], v[8:11], v[112:115], v[192:195]
  v_mfma_f32_16x16x32_bf16 v[196:199], v[12:15], v[112:115], v[196:199]
  s_cmp_eq_u32 s39, 13
  s_cbranch_scc1 L_rd
  v_mfma_f32_16x16x32_bf16 v[192:195], v[8:11], v[116:119], v[192:195]
  v_mfma_f32_16x16x32_bf16 v[196:199], v[12:15], v[116:119], v[196:199]
  s_cmp_eq_u32 s39, 14
  s_cbranch_scc1 L_rd
  v_mfma_f32_16x16x32_bf16 v[192:195], v[8:11], v[120:123], v[192:195]
  v_mfma_f32_16x16x32_bf16 v[196:199], v[12:15], v[120:123], v[196:199]
  s_cmp_eq_u32 s39, 15
  s_cbranch_scc1 L_rd
  v_mfma_f32_16x16x32_bf16 v[192:195], v[8:11], v[124:127], v[192:195]
  v_mfma_f32_16x16x32_bf16 v[196:199], v[12:15], v[124:127], v[196:199]
  s_branch L_rd
L_red2:
  s_ff1_i32_b32 s38, s63
  s_bitset0_b32 s63, s38
  s_mul_i32 s3, s38, 94208
  s_add_u32 s3, s3, s54
  buffer_load_dwordx4 v[64:67], v22, s[28:31], s3 offen sc1
  buffer_load_dwordx4 v[128:131], v16, s[28:31], s3 offen sc1
  s_cmp_eq_u32 s63, 0
  s_cbranch_scc1 L_ri1
  s_ff1_i32_b32 s38, s63
  s_bitset0_b32 s63, s38
  s_mul_i32 s3, s38, 94208
  s_add_u32 s3, s3, s54
  buffer_load_dwordx4 v[68:71], v22, s[28:31], s3 offen sc1
  buffer_load_dwordx4 v[132:135], v16, s[28:31], s3 offen sc1
  s_cmp_eq_u32 s63, 0
  s_cbranch_scc1 L_ri1
  s_ff1_i32_b32 s38, s63
  s_bitset0_b32 s63, s38
  s_mul_i32 s3, s38, 94208
  s_add_u32 s3, s3, s54
  buffer_load_dwordx4 v[72:75], v22, s[28:31], s3 offen sc1
  buffer_load_dwordx4 v[136:139], v16, s[28:31], s3 offen sc1
  s_cmp_eq_u32 s63, 0
  s_cbranch_scc1 L_ri1
  s_ff1_i32_b32 s38, s63
  s_bitset0_b32 s63, s38
  s_mul_i32 s3, s38, 94208
  s_add_u32 s3, s3, s54
  buffer_load_dwordx4 v[76:79], v22, s[28:31], s3 offen sc1
  buffer_load_dwordx4 v[140:143], v16, s[28:31], s3 offen sc1
  s_cmp_eq_u32 s63, 0
  s_cbranch_scc1 L_ri1
  s_ff1_i32_b32 s38, s63
  s_bitset0_b32 s63, s38
  s_mul_i32 s3, s38, 94208
  s_add_u32 s3, s3, s54
  buffer_load_dwordx4 v[80:83], v22, s[28:31], s3 offen sc1
  buffer_load_dwordx4 v[144:147], v16, s[28:31], s3 offen sc1
  s_cmp_eq_u32 s63, 0
  s_cbranch_scc1 L_ri1
  s_ff1_i32_b32 s38, s63
  s_bitset0_b32 s63, s38
  s_mul_i32 s3, s38, 94208
  s_add_u32 s3, s3, s54
  buffer_load_dwordx4 v[84:87], v22, s[28:31], s3 offen sc1
  buffer_load_dwordx4 v[148:151], v16, s[28:31], s3 offen sc1
  s_cmp_eq_u32 s63, 0
  s_cbranch_scc1 L_ri1
  s_ff1_i32_b32 s38, s63
  s_bitset0_b32 s63, s38
  s_mul_i32 s3, s38, 94208
  s_add_u32 s3, s3, s54
  buffer_load_dwordx4 v[88:91], v22, s[28:31], s3 offen sc1
  buffer_load_dwordx4 v[152:155], v16, s[28:31], s3 offen sc1
  s_cmp_eq_u32 s63, 0
  s_cbranch_scc1 L_ri1
  s_ff1_i32_b32 s38, s63
  s_bitset0_b32 s63, s38
  s_mul_i32 s3, s38, 94208
  s_add_u32 s3, s3, s54
  buffer_load_dwordx4 v[92:95], v22, s[28:31], s3 offen sc1
  buffer_load_dwordx4 v[156:159], v16, s[28:31], s3 offen sc1
  s_cmp_eq_u32 s63, 0
  s_cbranch_scc1 L_ri1
  s_ff1_i32_b32 s38, s63
  s_bitset0_b32 s63, s38
  s_mul_i32 s3, s38, 94208
  s_add_u32 s3, s3, s54
  buffer_load_dwordx4 v[96:99], v22, s[28:31], s3 offen sc1
  buffer_load_dwordx4 v[160:163], v16, s[28:31], s3 offen sc1
  s_cmp_eq_u32 s63, 0
  s_cbranch_scc1 L_ri1
  s_ff1_i32_b32 s38, s63
  s_bitset0_b32 s63, s38
  s_mul_i32 s3, s38, 94208
  s_add_u32 s3, s3, s54
  buffer_load_dwordx4 v[100:103], v22, s[28:31], s3 offen sc1
  buffer_load_dwordx4 v[164:167], v16, s[28:31], s3 offen sc1
  s_cmp_eq_u32 s63, 0
  s_cbranch_scc1 L_ri1
  s_ff1_i32_b32 s38, s63
  s_bitset0_b32 s63, s38
  s_mul_i32 s3, s38, 94208
  s_add_u32 s3, s3, s54
  buffer_load_dwordx4 v[104:107], v22, s[28:31], s3 offen sc1
  buffer_load_dwordx4 v[168:171], v16, s[28:31], s3 offen sc1
  s_cmp_eq_u32 s63, 0
  s_cbranch_scc1 L_ri1
  s_ff1_i32_b32 s38, s63
  s_bitset0_b32 s63, s38
  s_mul_i32 s3, s38, 94208
  s_add_u32 s3, s3, s54
  buffer_load_dwordx4 v[108:111], v22, s[28:31], s3 offen sc1
  buffer_load_dwordx4 v[172:175], v16, s[28:31], s3 offen sc1
  s_cmp_eq_u32 s63, 0
  s_cbranch_scc1 L_ri1
  s_ff1_i32_b32 s38, s63
  s_bitset0_b32 s63, s38
  s_mul_i32 s3, s38, 94208
  s_add_u32 s3, s3, s54
  buffer_load_dwordx4 v[112:115], v22, s[28:31], s3 offen sc1
  buffer_load_dwordx4 v[176:179], v16, s[28:31], s3 offen sc1
  s_cmp_eq_u32 s63, 0
  s_cbranch_scc1 L_ri1
  s_ff1_i32_b32 s38, s63
  s_bitset0_b32 s63, s38
  s_mul_i32 s3, s38, 94208
  s_add_u32 s3, s3, s54
  buffer_load_dwordx4 v[116:119], v22, s[28:31], s3 offen sc1
  buffer_load_dwordx4 v[180:183], v16, s[28:31], s3 offen sc1
  s_cmp_eq_u32 s63, 0
  s_cbranch_scc1 L_ri1
  s_ff1_i32_b32 s38, s63
  s_bitset0_b32 s63, s38
  s_mul_i32 s3, s38, 94208
  s_add_u32 s3, s3, s54
  buffer_load_dwordx4 v[120:123], v22, s[28:31], s3 offen sc1
  buffer_load_dwordx4 v[184:187], v16, s[28:31], s3 offen sc1
  s_cmp_eq_u32 s63, 0
  s_cbranch_scc1 L_ri1
  s_ff1_i32_b32 s38, s63
  s_bitset0_b32 s63, s38
  s_mul_i32 s3, s38, 94208
  s_add_u32 s3, s3, s54
  buffer_load_dwordx4 v[124:127], v22, s[28:31], s3 offen sc1
  buffer_load_dwordx4 v[188:191], v16, s[28:31], s3 offen sc1
L_ri1:
  buffer_load_dword v5, v4, s[64:67], s51 offen sc1
  s_waitcnt vmcnt(1)
  v_mfma_f32_16x16x32_bf16 v[192:195], v[8:11], v[64:67], v[192:195]
  v_mfma_f32_16x16x32_bf16 v[196:199], v[12:15], v[64:67], v[196:199]
  v_mfma_f32_16x16x32_bf16 v[200:203], v[8:11], v[128:131], v[200:203]
  v_mfma_f32_16x16x32_bf16 v[204:207], v[12:15], v[128:131], v[204:207]
  s_cmp_eq_u32 s39, 1
  s_cbranch_scc1 L_rd
  v_mfma_f32_16x16x32_bf16 v[192:195], v[8:11], v[68:71], v[192:195]
  v_mfma_f32_16x16x32_bf16 v[196:199], v[12:15], v[68:71], v[196:199]
  v_mfma_f32_16x16x32_bf16 v[200:203], v[8:11], v[132:135], v[200:203]
  v_mfma_f32_16x16x32_bf16 v[204:207], v[12:15], v[132:135], v[204:207]
  s_cmp_eq_u32 s39, 2
  s_cbranch_scc1 L_rd
  v_mfma_f32_16x16x32_bf16 v[192:195], v[8:11], v[72:75], v[192:195]
  v_mfma_f32_16x16x32_bf16 v[196:199], v[12:15], v[72:75], v[196:199]
  v_mfma_f32_16x16x32_bf16 v[200:203], v[8:11], v[136:139], v[200:203]
  v_mfma_f32_16x16x32_bf16 v[204:207], v[12:15], v[136:139], v[204:207]
  s_cmp_eq_u32 s39, 3
  s_cbranch_scc1 L_rd
  v_mfma_f32_16x16x32_bf16 v[192:195], v[8:11], v[76:79], v[192:195]
  v_mfma_f32_16x16x32_bf16 v[196:199], v[12:15], v[76:79], v[196:199]
  v_mfma_f32_16x16x32_bf16 v[200:203], v[8:11], v[140:143], v[200:203]
  v_mfma_f32_16x16x32_bf16 v[204:207], v[12:15], v[140:143], v[204:207]
  s_cmp_eq_u32 s39, 4
  s_cbranch_scc1 L_rd
  v_mfma_f32_16x16x32_bf16 v[192:195], v[8:11], v[80:83], v[192:195]
  v_mfma_f32_16x16x32_bf16 v[196:199], v[12:15], v[80:83], v[196:199]
  v_mfma_f32_16x16x32_bf16 v[200:203], v[8:11], v[144:147], v[200:203]
  v_mfma_f32_16x16x32_bf16 v[204:207], v[12:15], v[144:147], v[204:207]
  s_cmp_eq_u32 s39, 5
  s_cbranch_scc1 L_rd
  v_mfma_f32_16x16x32_bf16 v[192:195], v[8:11], v[84:87], v[192:195]
  v_mfma_f32_16x16x32_bf16 v[196:199], v[12:15], v[84:87], v[196:199]
  v_mfma_f32_16x16x32_bf16 v[200:203], v[8:11], v[148:151], v[200:203]
  v_mfma_f32_16x16x32_bf16 v[204:207], v[12:15], v[148:151], v[204:207]
  s_cmp_eq_u32 s39, 6
  s_cbranch_scc1 L_rd
  v_mfma_f32_16x16x32_bf16 v[192:195], v[8:11], v[88:91], v[192:195]
  v_mfma_f32_16x16x32_bf16 v[196:199], v[12:15], v[88:91], v[196:199]
  v_mfma_f32_16x16x32_bf16 v[200:203], v[8:11], v[152:155], v[200:203]
  v_mfma_f32_16x16x32_bf16 v[204:207], v[12:15], v[152:155], v[204:207]
  s_cmp_eq_u32 s39, 7
  s_cbranch_scc1 L_rd
  v_mfma_f32_16x16x32_bf16 v[192:195], v[8:11], v[92:95], v[192:195]
  v_mfma_f32_16x16x32_bf16 v[196:199], v[12:15], v[92:95], v[196:199]
  v_mfma_f32_16x16x32_bf16 v[200:203], v[8:11], v[156:159], v[200:203]
  v_mfma_f32_16x16x32_bf16 v[204:207], v[12:15], v[156:159], v[204:207]
  s_cmp_eq_u32 s39, 8
  s_cbranch_scc1 L_rd
  v_mfma_f32_16x16x32_bf16 v[192:195], v[8:11], v[96:99], v[192:195]
  v_mfma_f32_16x16x32_bf16 v[196:199], v[12:15], v[96:99], v[196:199]
  v_mfma_f32_16x16x32_bf16 v[200:203], v[8:11], v[160:163], v[200:203]
  v_mfma_f32_16x16x32_bf16 v[204:207], v[12:15], v[160:163], v[204:207]
  s_cmp_eq_u32 s39, 9
  s_cbranch_scc1 L_rd
  v_mfma_f32_16x16x32_bf16 v[192:195], v[8:11], v[100:103], v[192:195]
  v_mfma_f32_16x16x32_bf16 v[196:199], v[12:15], v[100:103], v[196:199]
  v_mfma_f32_16x16x32_bf16 v[200:203], v[8:11], v[164:167], v[200:203]
  v_mfma_f32_16x16x32_bf16 v[204:207], v[12:15], v[164:167], v[204:207]
  s_cmp_eq_u32 s39, 10
  s_cbranch_scc1 L_rd
  v_mfma_f32_16x16x32_bf16 v[192:195], v[8:11], v[104:107], v[192:195]
  v_mfma_f32_16x16x32_bf16 v[196:199], v[12:15], v[104:107], v[196:199]
  v_mfma_f32_16x16x32_bf16 v[200:203], v[8:11], v[168:171], v[200:203]
  v_mfma_f32_16x16x32_bf16 v[204:207], v[12:15], v[168:171], v[204:207]
  s_cmp_eq_u32 s39, 11
  s_cbranch_scc1 L_rd
  v_mfma_f32_16x16x32_bf16 v[192:195], v[8:11], v[108:111], v[192:195]
  v_mfma_f32_16x16x32_bf16 v[196:199], v[12:15], v[108:111], v[196:199]
  v_mfma_f32_16x16x32_bf16 v[200:203], v[8:11], v[172:175], v[200:203]
  v_mfma_f32_16x16x32_bf16 v[204:207], v[12:15], v[172:175], v[204:207]
  s_cmp_eq_u32 s39, 12
  s_cbranch_scc1 L_rd
  v_mfma_f32_16x16x32_bf16 v[192:195], v[8:11], v[112:115], v[192:195]
  v_mfma_f32_16x16x32_bf16 v[196:199], v[12:15], v[112:115], v[196:199]
  v_mfma_f32_16x16x32_bf16 v[200:203], v[8:11], v[176:179], v[200:203]
  v_mfma_f32_16x16x32_bf16 v[204:207], v[12:15], v[176:179], v[204:207]
  s_cmp_eq_u32 s39, 13
  s_cbranch_scc1 L_rd
  v_mfma_f32_16x16x32_bf16 v[192:195], v[8:11], v[116:119], v[192:195]
  v_mfma_f32_16x16x32_bf16 v[196:199], v[12:15], v[116:119], v[196:199]
  v_mfma_f32_16x16x32_bf16 v[200:203], v[8:11], v[180:183], v[200:203]
  v_mfma_f32_16x16x32_bf16 v[204:207], v[12:15], v[180:183], v[204:207]
  s_cmp_eq_u32 s39, 14
  s_cbranch_scc1 L_rd
  v_mfma_f32_16x16x32_bf16 v[192:195], v[8:11], v[120:123], v[192:195]
  v_mfma_f32_16x16x32_bf16 v[196:199], v[12:15], v[120:123], v[196:199]
  v_mfma_f32_16x16x32_bf16 v[200:203], v[8:11], v[184:187], v[200:203]
  v_mfma_f32_16x16x32_bf16 v[204:207], v[12:15], v[184:187], v[204:207]
  s_cmp_eq_u32 s39, 15
  s_cbranch_scc1 L_rd
  v_mfma_f32_16x16x32_bf16 v[192:195], v[8:11], v[124:127], v[192:195]
  v_mfma_f32_16x16x32_bf16 v[196:199], v[12:15], v[124:127], v[196:199]
  v_mfma_f32_16x16x32_bf16 v[200:203], v[8:11], v[188:191], v[200:203]
  v_mfma_f32_16x16x32_bf16 v[204:207], v[12:15], v[188:191], v[204:207]
L_rd:
  s_cmp_eq_u32 s62, 0
  s_cbranch_scc1 L_rout
  s_waitcnt vmcnt(0)
  s_branch L_red
L_red_poll:
  s_sleep 4
  buffer_load_dword v5, v4, s[64:67], s51 offen sc1
  s_waitcnt vmcnt(0)
  s_branch L_red
L_rout:
  s_nop 7
  v_cvt_pk_bf16_f32 v28, v192, v193
  v_cvt_pk_bf16_f32 v29, v194, v195
  v_cvt_pk_bf16_f32 v30, v196, v197
  v_cvt_pk_bf16_f32 v31, v198, v199
  v_cvt_pk_bf16_f32 v32, v200, v201
  v_cvt_pk_bf16_f32 v33, v202, v203
  v_cvt_pk_bf16_f32 v34, v204, v205
  v_cvt_pk_bf16_f32 v35, v206, v207
  buffer_store_dwordx2 v[28:29], v1, s[44:47], s60 offen sc1
  buffer_store_dwordx2 v[30:31], v1, s[44:47], s61 offen sc1
  buffer_store_dwordx2 v[32:33], v1, s[44:47], s40 offen sc1
  buffer_store_dwordx2 v[34:35], v1, s[44:47], s41 offen sc1
L_fin:
L_end:
  s_endpgm
L_fallback:
  s_waitcnt vmcnt(0) lgkmcnt(0)
  s_barrier
  v_and_b32 v1, 15, v0
  v_lshrrev_b32 v2, 4, v0
  v_lshlrev_b32 v3, 8, v1
  v_lshl_add_u32 v3, v2, 5, v3
  s_mov_b32 s38, 0
  s_mov_b32 s39, 0xff800000
  v_mov_b32 v224, s39
  v_mov_b32 v225, s39
  v_mov_b32 v226, s39
  v_mov_b32 v227, s39
  v_mov_b32 v228, s39
L_fb_loop:
  buffer_load_dwordx4 v[88:91], v3, s[8:11], s38 offen offset:0
  buffer_load_dwordx4 v[92:95], v3, s[8:11], s38 offen offset:16
  buffer_load_dwordx4 v[96:99], v3, s[8:11], s38 offen offset:128
  buffer_load_dwordx4 v[100:103], v3, s[8:11], s38 offen offset:144
  s_waitcnt vmcnt(0) lgkmcnt(0)
  s_nop 0
  v_mfma_f32_16x16x32_bf16 v[48:51], v[88:91], a[0:3], 0
  v_mfma_f32_16x16x32_bf16 v[56:59], v[88:91], a[4:7], 0
  v_mfma_f32_16x16x32_bf16 v[64:67], v[88:91], a[8:11], 0
  v_mfma_f32_16x16x32_bf16 v[72:75], v[88:91], a[12:15], 0
  v_mfma_f32_16x16x32_bf16 v[80:83], v[88:91], a[16:19], 0
  v_mfma_f32_16x16x32_bf16 v[48:51], v[92:95], a[20:23], v[48:51]
  v_mfma_f32_16x16x32_bf16 v[56:59], v[92:95], a[24:27], v[56:59]
  v_mfma_f32_16x16x32_bf16 v[64:67], v[92:95], a[28:31], v[64:67]
  v_mfma_f32_16x16x32_bf16 v[72:75], v[92:95], a[32:35], v[72:75]
  v_mfma_f32_16x16x32_bf16 v[80:83], v[92:95], a[36:39], v[80:83]
  v_mfma_f32_16x16x32_bf16 v[48:51], v[96:99], a[40:43], v[48:51]
  v_mfma_f32_16x16x32_bf16 v[56:59], v[96:99], a[44:47], v[56:59]
  v_mfma_f32_16x16x32_bf16 v[64:67], v[96:99], a[48:51], v[64:67]
  v_mfma_f32_16x16x32_bf16 v[72:75], v[96:99], a[52:55], v[72:75]
  v_mfma_f32_16x16x32_bf16 v[80:83], v[96:99], a[56:59], v[80:83]
  v_mfma_f32_16x16x32_bf16 v[48:51], v[100:103], a[60:63], v[48:51]
  v_mfma_f32_16x16x32_bf16 v[56:59], v[100:103], a[64:67], v[56:59]
  v_mfma_f32_16x16x32_bf16 v[64:67], v[100:103], a[68:71], v[64:67]
  v_mfma_f32_16x16x32_bf16 v[72:75], v[100:103], a[72:75], v[72:75]
  v_mfma_f32_16x16x32_bf16 v[80:83], v[100:103], a[76:79], v[80:83]
  s_nop 7
  v_max3_f32 v224, v224, v48, v49
  v_max3_f32 v224, v224, v50, v51
  v_max3_f32 v225, v225, v56, v57
  v_max3_f32 v225, v225, v58, v59
  v_max3_f32 v226, v226, v64, v65
  v_max3_f32 v226, v226, v66, v67
  v_max3_f32 v227, v227, v72, v73
  v_max3_f32 v227, v227, v74, v75
  v_max3_f32 v228, v228, v80, v81
  v_max3_f32 v228, v228, v82, v83
  s_add_u32 s38, s38, 4096
  s_cmp_lt_u32 s38, 262144
  s_cbranch_scc1 L_fb_loop
  v_mov_b32 v232, v224
  v_mov_b32 v233, v225
  v_mov_b32 v234, v226
  v_mov_b32 v235, v227
  v_mov_b32 v236, v228
  v_permlane32_swap_b32 v224, v232
  v_permlane32_swap_b32 v225, v233
  v_permlane32_swap_b32 v226, v234
  v_permlane32_swap_b32 v227, v235
  v_permlane32_swap_b32 v228, v236
  v_max_f32 v224, v224, v232
  v_max_f32 v225, v225, v233
  v_max_f32 v226, v226, v234
  v_max_f32 v227, v227, v235
  v_max_f32 v228, v228, v236
  v_mov_b32 v232, v224
  v_mov_b32 v233, v225
  v_mov_b32 v234, v226
  v_mov_b32 v235, v227
  v_mov_b32 v236, v228
  v_permlane16_swap_b32 v224, v232
  v_permlane16_swap_b32 v225, v233
  v_permlane16_swap_b32 v226, v234
  v_permlane16_swap_b32 v227, v235
  v_permlane16_swap_b32 v228, v236
  v_max_f32 v224, v224, v232
  v_max_f32 v225, v225, v233
  v_max_f32 v226, v226, v234
  v_max_f32 v227, v227, v235
  v_max_f32 v228, v228, v236
  v_sub_f32 v28, 0, v224
  v_sub_f32 v29, 0, v224
  v_sub_f32 v30, 0, v224
  v_sub_f32 v31, 0, v224
  v_sub_f32 v32, 0, v225
  v_sub_f32 v33, 0, v225
  v_sub_f32 v34, 0, v225
  v_sub_f32 v35, 0, v225
  v_sub_f32 v36, 0, v226
  v_sub_f32 v37, 0, v226
  v_sub_f32 v38, 0, v226
  v_sub_f32 v39, 0, v226
  v_sub_f32 v40, 0, v227
  v_sub_f32 v41, 0, v227
  v_sub_f32 v42, 0, v227
  v_sub_f32 v43, 0, v227
  v_sub_f32 v44, 0, v228
  v_sub_f32 v45, 0, v228
  v_sub_f32 v46, 0, v228
  v_sub_f32 v47, 0, v228
  v_mov_b32 v3, 0x3f803f80
  v_accvgpr_write_b32 a216, v3
  v_accvgpr_write_b32 a217, v3
  v_accvgpr_write_b32 a218, v3
  v_accvgpr_write_b32 a219, v3
  s_mov_b32 s50, 1
  s_add_u32 m0, s43, 0x0
  s_add_u32 s51, s49, 0
  s_and_b32 s51, s51, 0x3ffff
  buffer_load_dwordx4 v16, s[8:11], s51 offen offset:0 nt lds
  buffer_load_dwordx4 v17, s[8:11], s51 offen offset:1024 nt lds
  buffer_load_dwordx4 v18, s[8:11], s51 offen offset:2048 nt lds
  buffer_load_dwordx4 v19, s[8:11], s51 offen offset:3072 nt lds
  s_add_u32 m0, s43, 16384
  s_add_u32 s51, s49, 16384
  s_and_b32 s51, s51, 0x3ffff
  buffer_load_dwordx4 v16, s[8:11], s51 offen offset:0 nt lds
  buffer_load_dwordx4 v17, s[8:11], s51 offen offset:1024 nt lds
  buffer_load_dwordx4 v18, s[8:11], s51 offen offset:2048 nt lds
  buffer_load_dwordx4 v19, s[8:11], s51 offen offset:3072 nt lds
  s_add_u32 m0, s43, 65536
  s_add_u32 s51, s49, 0
  s_and_b32 s51, s51, 0x3ffff
  buffer_load_dwordx4 v20, s[12:15], s51 offen offset:0 nt lds
  buffer_load_dwordx4 v21, s[12:15], s51 offen offset:1024 nt lds
  buffer_load_dwordx4 v20, s[12:15], s51 offen offset:2048 nt lds
  buffer_load_dwordx4 v21, s[12:15], s51 offen offset:3072 nt lds
  s_add_u32 m0, s43, 32768
  s_add_u32 s51, s49, 32768
  s_and_b32 s51, s51, 0x3ffff
  buffer_load_dwordx4 v16, s[8:11], s51 offen offset:0 nt lds
  buffer_load_dwordx4 v17, s[8:11], s51 offen offset:1024 nt lds
  buffer_load_dwordx4 v18, s[8:11], s51 offen offset:2048 nt lds
  buffer_load_dwordx4 v19, s[8:11], s51 offen offset:3072 nt lds
  s_add_u32 m0, s43, 122880
  s_add_u32 s51, s49, 16384
  s_and_b32 s51, s51, 0x3ffff
  buffer_load_dwordx4 v20, s[12:15], s51 offen offset:0 nt lds
  buffer_load_dwordx4 v21, s[12:15], s51 offen offset:1024 nt lds
  buffer_load_dwordx4 v20, s[12:15], s51 offen offset:2048 nt lds
  buffer_load_dwordx4 v21, s[12:15], s51 offen offset:3072 nt lds
  s_waitcnt vmcnt(0) lgkmcnt(0)
  s_barrier
  ds_read_b128 a[80:83], v4 offset:0
  ds_read_b128 a[96:99], v4 offset:4096
  ds_read_b128 a[84:87], v5 offset:0
  ds_read_b128 a[100:103], v5 offset:4096
  ds_read_b128 a[88:91], v6 offset:0
  ds_read_b128 a[104:107], v6 offset:4096
  ds_read_b128 a[92:95], v7 offset:0
  ds_read_b128 a[108:111], v7 offset:4096
  ds_read_b128 a[112:115], v4 offset:16384
  ds_read_b128 a[128:131], v4 offset:20480
  ds_read_b128 a[116:119], v5 offset:16384
  ds_read_b128 a[132:135], v5 offset:20480
  ds_read_b128 a[120:123], v6 offset:16384
  ds_read_b128 a[136:139], v6 offset:20480
  ds_read_b128 a[124:127], v7 offset:16384
  ds_read_b128 a[140:143], v7 offset:20480
  s_waitcnt vmcnt(0) lgkmcnt(0)
  s_barrier
  s_branch L_att
.section .rodata,"a"
.p2align 6
.amdhsa_kernel concat_heads__gqa_block_cached__gqa_block_cached__near_ridge_kernel
  .amdhsa_next_free_vgpr 512
  .amdhsa_next_free_sgpr 102
  .amdhsa_accum_offset 256
  .amdhsa_group_segment_fixed_size 0
  .amdhsa_kernarg_size 104
  .amdhsa_user_sgpr_count 2
  .amdhsa_user_sgpr_kernarg_segment_ptr 1
  .amdhsa_system_sgpr_workgroup_id_x 1
  .amdhsa_float_denorm_mode_32 3
.end_amdhsa_kernel
```
